```python
import torch

def _softmax(x, axis=-1):
    return torch.softmax(x, dim=axis)
def _gelu(x):
    return torch.nn.functional.gelu(x, approximate="tanh")
def _silu(x):
    return torch.nn.functional.silu(x)
def _sigmoid(x):
    return torch.sigmoid(x)
def _layernorm(x, axis=-1, eps=1e-5):
    m = x.mean(dim=axis, keepdim=True)
    v = x.var(dim=axis, keepdim=True, unbiased=False)
    return (x - m) / torch.sqrt(v + eps)
def _scatter_add(tgt, idx, src, axis=0):
    return tgt.clone().index_add_(axis, idx, src)
def _segment_sum(src, seg, n):
    out = torch.zeros((n,) + src.shape[1:], dtype=src.dtype)
    return out.index_add_(0, seg, src)
def _pad(x, pw):
    flat = tuple(v for pair in reversed(pw) for v in pair)
    return torch.nn.functional.pad(x, flat)

kernel_name = 'parallel_sum__compressed_kv_cla__dense_activation_squared_relu__prompt'

def setup_inputs():

    _w = (lambda a: (lambda t: t.to(torch.bfloat16) if t.is_floating_point() else t)(torch.as_tensor(a)))
    def _A_setup():
        B, H, Sq, Sk, D, M = 1, 16, 2048, 2048, 256, 448
        Dc = 4 * D
        return {
            "x": _w((lambda *s: torch.randn(*s, dtype=torch.bfloat16) * 0.05)(B, Sq, M)),
            "c_kv": _w((lambda *s: torch.randn(*s, dtype=torch.bfloat16) * 1.6)(B, Sk, Dc)),
            "w_q": _w((lambda *s: torch.randn(*s, dtype=torch.bfloat16) * 0.8)(M, H, D) * (M ** -0.5)),
            "w_uk": _w((lambda *s: torch.randn(*s, dtype=torch.bfloat16) * 0.8)(Dc, H, D) * (Dc ** -0.5)),
            "w_uv": _w((lambda *s: torch.randn(*s, dtype=torch.bfloat16) * 1.6)(Dc, H, D) * (Dc ** -0.5)),
            "w_o": _w((lambda *s: torch.randn(*s, dtype=torch.bfloat16) * 1.6)(H, D, M) * ((H * D) ** -0.5)),
        }
    _A_in = _A_setup()

    def _B_setup():
        B, S, D, F = 1, 2048, 448, 1792
        return {
            "x": _w((lambda *s: torch.randn(*s, dtype=torch.bfloat16) * 0.05)(B, S, D)),
            "w1": _w((lambda *s: torch.randn(*s, dtype=torch.bfloat16) * 0.05)(D, F)),
            "b1": _w((lambda *s: torch.randn(*s, dtype=torch.bfloat16) * 0.2)(F)),
            "w2": _w((lambda *s: torch.randn(*s, dtype=torch.bfloat16) * 0.05)(F, D)),
            "b2": _w((lambda *s: torch.randn(*s, dtype=torch.bfloat16) * 0.8)(D)),
        }
    _B_in = _B_setup()

    return {
        "A_x": _A_in["x"],
        "A_c_kv": _A_in["c_kv"],
        "A_w_q": _A_in["w_q"],
        "A_w_uk": _A_in["w_uk"],
        "A_w_uv": _A_in["w_uv"],
        "A_w_o": _A_in["w_o"],
        "B_x": _B_in["x"],
        "B_w1": _B_in["w1"],
        "B_b1": _B_in["b1"],
        "B_w2": _B_in["w2"],
        "B_b2": _B_in["b2"],
    }

def reference(A_x, A_c_kv, A_w_q, A_w_uk, A_w_uv, A_w_o, B_x, B_w1, B_b1, B_w2, B_b2):
    def _A_ref(x, c_kv, w_q, w_uk, w_uv, w_o):
        B, Sq, M = x.shape[0], x.shape[1], x.shape[2]
        Sk = c_kv.shape[1]
        H, D = w_q.shape[1], w_q.shape[2]
        q = torch.einsum("bqm,mhd->bhqd", x, w_q)
        k = torch.einsum("bkc,chd->bhkd", c_kv, w_uk)
        v = torch.einsum("bkc,chd->bhkd", c_kv, w_uv)
        scores = torch.einsum("bhqd,bhkd->bhqk", q, k) * (D ** -0.5)
        off = Sk - Sq
        qi = torch.arange(Sq)[:, None]
        kj = torch.arange(Sk)[None, :]
        cmask = kj <= (qi + off)
        scores = torch.where(cmask[None, None], scores, -1e9)
        p = _softmax(scores, axis=-1)
        ctx = torch.einsum("bhqk,bhkd->bhqd", p, v)
        return torch.einsum("bhqd,hdm->bqm", ctx, w_o)

    def _B_ref(x, w1, b1, w2, b2):
        h = torch.einsum("bsd,df->bsf", x, w1) + b1
        zero = torch.zeros_like(h)
        r = torch.where(h > zero, h, zero)
        h = r * r
        out = torch.einsum("bsf,fd->bsd", h, w2) + b2
        return out

    x = A_x
    xn = _layernorm(x, axis=-1)
    return x + _A_ref(xn, A_c_kv, A_w_q, A_w_uk, A_w_uv, A_w_o) + _B_ref(xn, B_w1, B_b1, B_w2, B_b2)
```

```asm
; @launch grid=(256,1,1) block=(256,1,1) lds=163840
.amdgcn_target "amdgcn-amd-amdhsa--gfx950"
.text
.globl parallel_sum__compressed_kv_cla__dense_activation_squared_relu__prompt_kernel
.p2align 8
.type parallel_sum__compressed_kv_cla__dense_activation_squared_relu__prompt_kernel,@function
parallel_sum__compressed_kv_cla__dense_activation_squared_relu__prompt_kernel:
    s_cmp_ge_u32 s2, 256
    s_cbranch_scc1 L_end
    s_getpc_b64 s[98:99]
L_pc:
    s_lshr_b32 s3, s2, 3
    v_lshrrev_b32 v16, 3, v0
    v_lshlrev_b32 v16, 5, v16
    v_add_u32 v16, s3, v16
    v_lshlrev_b32 v16, 7, v16
    v_min_u32 v16, L_end - L_pc, v16
    global_load_dword v25, v16, s[98:99]
    s_load_dwordx4 s[84:87], s[0:1], 0
    s_load_dwordx4 s[88:91], s[0:1], 24
    s_load_dwordx2 s[92:93], s[0:1], 104
    s_load_dwordx2 s[94:95], s[0:1], 64
    s_load_dwordx2 s[100:101], s[0:1], 96
    v_and_b32 v1, 63, v0
    v_lshrrev_b32 v26, 6, v0
    s_and_b32 s40, s2, 7
    v_readfirstlane_b32 s24, v26
    s_lshl_b32 s40, s40, 1
    s_lshr_b32 s28, s2, 4
    s_bfe_u32 s41, s2, 0x10003
    s_add_u32 s27, s40, s41
    s_bfe_u32 s45, s2, 0x30003
    s_bfe_u32 s41, s2, 0x10006
    s_add_u32 s44, s40, s41
    s_lshr_b32 s52, s2, 7
    s_lshr_b32 s46, s24, 1
    s_and_b32 s47, s24, 1
    s_and_b32 s25, s24, 1
    s_lshl_b32 s31, s24, 13
    s_add_u32 s55, s31, 65536
    s_lshl_b32 s32, s24, 12
    s_mov_b32 s56, s32
    v_lshrrev_b32 v28, 5, v1
    s_lshl_b32 s40, s24, 3
    v_add_u32 v29, s40, v28
    v_lshlrev_b32 v29, 13, v29
    s_lshl_b32 s40, s44, 9
    v_add_u32 v29, s40, v29
    v_lshlrev_b32 v28, 1, v28
    v_and_b32 v30, 31, v1
    v_xor_b32 v28, v28, v30
    s_lshl_b32 s40, s25, 3
    v_xor_b32 v28, s40, v28
    v_xor_b32 v30, 4, v28
    v_lshl_add_u32 v28, v28, 4, v29
    v_lshl_add_u32 v30, v30, 4, v29
    v_add_u32 v10, 0, v28
    v_add_u32 v11, 15360, v30
    v_add_u32 v12, 30720, v28
    v_add_u32 v13, 46080, v30
    s_lshl_b32 s40, s45, 8
    s_lshl_b32 s41, s24, 6
    s_add_u32 s40, s40, s41
    v_lshrrev_b32 v28, 3, v1
    v_add_u32 v28, s40, v28
    v_lshlrev_b32 v28, 11, v28
    v_lshrrev_b32 v29, 4, v1
    v_and_b32 v30, 7, v1
    v_xor_b32 v29, v29, v30
    v_xor_b32 v30, 4, v29
    v_lshl_add_u32 v29, v29, 4, v28
    v_lshl_add_u32 v30, v30, 4, v28
    v_add_u32 v2, 0, v29
    v_add_u32 v3, 15360, v30
    v_add_u32 v4, 30720, v29
    v_add_u32 v5, 46080, v30
    v_add_u32 v6, 65536, v29
    v_add_u32 v7, 80896, v30
    v_add_u32 v8, 96256, v29
    v_add_u32 v9, 111616, v30
    s_lshl_b32 s49, s2, 3
    s_lshl_b32 s41, s24, 1
    s_add_u32 s49, s49, s41
    s_mul_i32 s50, s49, 896
    v_lshlrev_b32 v27, 4, v1
    v_mov_b32 v100, 0
    v_mov_b32 v101, 0
    v_mov_b32 v102, 0
    v_mov_b32 v103, 0
    v_mov_b32 v104, 0
    v_mov_b32 v105, 0
    v_mov_b32 v106, 0
    v_mov_b32 v107, 0
    s_mov_b32 s34, -1
    s_mov_b32 s35, 0x00ffffff
    s_mov_b32 s53, 0
    s_mov_b32 s54, 0
    s_waitcnt lgkmcnt(0)
    s_mov_b32 s8, s86
    s_and_b32 s9, s87, 0xffff
    s_mov_b32 s10, 4194304
    s_mov_b32 s11, 0x00020000
    s_cmp_eq_u32 s52, 0
    s_cselect_b32 s88, s88, s90
    s_cselect_b32 s89, s89, s91
    s_mov_b32 s12, s88
    s_and_b32 s13, s89, 0xffff
    s_mov_b32 s14, 8388608
    s_mov_b32 s15, 0x00020000
    s_mov_b32 s16, s84
    s_and_b32 s17, s85, 0xffff
    s_mov_b32 s18, 1835008
    s_mov_b32 s19, 0x00020000
    s_mov_b64 exec, s[34:35]
    buffer_load_dwordx4 v[100:103], v27, s[16:19], s50 offen
    buffer_load_dwordx4 v[104:107], v27, s[16:19], s50 offen offset:896
    s_mov_b64 exec, -1
    s_add_u32 m0, s56, 0
    s_nop 0
    buffer_load_dwordx4 v10, s[12:15], s54 offen lds
    buffer_load_dwordx4 v11, s[12:15], s54 offen offset:1024 lds
    buffer_load_dwordx4 v12, s[12:15], s54 offen offset:2048 lds
    buffer_load_dwordx4 v13, s[12:15], s54 offen offset:3072 lds
    s_add_u32 s54, s54, 262144
    s_add_u32 m0, s56, 16384
    s_nop 0
    buffer_load_dwordx4 v10, s[12:15], s54 offen lds
    buffer_load_dwordx4 v11, s[12:15], s54 offen offset:1024 lds
    buffer_load_dwordx4 v12, s[12:15], s54 offen offset:2048 lds
    buffer_load_dwordx4 v13, s[12:15], s54 offen offset:3072 lds
    s_add_u32 s54, s54, 262144
    s_add_u32 m0, s55, 0
    s_nop 0
    buffer_load_dwordx4 v2, s[8:11], s53 offen offset:0 lds
    buffer_load_dwordx4 v3, s[8:11], s53 offen offset:1024 lds
    buffer_load_dwordx4 v4, s[8:11], s53 offen offset:2048 lds
    buffer_load_dwordx4 v5, s[8:11], s53 offen offset:3072 lds
    s_add_u32 m0, s55, 4096
    s_nop 0
    buffer_load_dwordx4 v6, s[8:11], s53 offen offset:0 lds
    buffer_load_dwordx4 v7, s[8:11], s53 offen offset:1024 lds
    buffer_load_dwordx4 v8, s[8:11], s53 offen offset:2048 lds
    buffer_load_dwordx4 v9, s[8:11], s53 offen offset:3072 lds
    s_add_u32 s53, s53, 128
    s_mov_b32 s4, s92
    s_and_b32 s5, s93, 0xffff
    s_mov_b32 s6, 268435456
    s_mov_b32 s7, 0x00020000
    s_mov_b32 s20, s94
    s_and_b32 s21, s95, 0xffff
    s_mov_b32 s22, 3584
    s_mov_b32 s23, 0x00020000
    s_load_dwordx2 s[84:85], s[0:1], 16
    s_load_dwordx2 s[86:87], s[0:1], 56
    s_load_dwordx2 s[88:89], s[0:1], 40
    s_load_dwordx2 s[90:91], s[0:1], 72
    v_and_b32 v28, 15, v1
    s_lshl_b32 s40, s46, 7
    v_add_u32 v29, s40, v28
    v_lshlrev_b32 v29, 7, v29
    v_add_u32 v29, 65536, v29
    v_lshrrev_b32 v28, 1, v28
    v_lshrrev_b32 v30, 4, v1
    v_xor_b32 v28, v28, v30
    v_lshl_add_u32 v14, v28, 4, v29
    v_xor_b32 v28, 4, v28
    v_lshl_add_u32 v15, v28, 4, v29
    s_lshl_b32 s41, s47, 8
    v_bfe_u32 v28, v1, 2, 2
    v_lshrrev_b32 v29, 4, v1
    v_lshl_add_u32 v29, v29, 3, v28
    v_lshlrev_b32 v29, 9, v29
    v_and_b32 v31, 3, v1
    v_lshl_add_u32 v29, v31, 3, v29
    v_add_u32 v29, s41, v29
    v_bfe_u32 v28, v1, 2, 3
    v_xor_b32 v31, 0, v28
    v_lshl_add_u32 v16, v31, 5, v29
    v_xor_b32 v31, 1, v28
    v_lshl_add_u32 v17, v31, 5, v29
    v_xor_b32 v31, 2, v28
    v_lshl_add_u32 v18, v31, 5, v29
    v_xor_b32 v31, 3, v28
    v_lshl_add_u32 v19, v31, 5, v29
    v_xor_b32 v31, 4, v28
    v_lshl_add_u32 v20, v31, 5, v29
    v_xor_b32 v31, 5, v28
    v_lshl_add_u32 v21, v31, 5, v29
    v_xor_b32 v31, 6, v28
    v_lshl_add_u32 v22, v31, 5, v29
    v_xor_b32 v31, 7, v28
    v_lshl_add_u32 v23, v31, 5, v29
    s_lshl_b32 s40, s44, 6
    s_lshl_b32 s41, s45, 3
    s_add_u32 s40, s40, s41
    s_lshl_b32 s41, s46, 2
    s_add_u32 s40, s40, s41
    s_lshl_b32 s40, s40, 15
    s_lshl_b32 s41, s52, 14
    s_add_u32 s40, s40, s41
    s_add_u32 s40, s40, 2097152
    s_add_u32 s41, s52, 12
    s_lshl_b32 s41, s47, s41
    s_add_u32 s60, s40, s41
    s_cmp_eq_u32 s52, 0
    s_cselect_b32 s96, 8, 4
    s_cselect_b32 s36, 24, 28
    s_lshl_b32 s96, s96, 10
    s_lshl_b32 s36, s36, 10
    s_lshl_b32 s97, s44, 7
    s_add_u32 s97, s97, 83886080
    s_lshr_b32 s26, s24, 1
    s_lshl_b32 s40, s28, 1
    s_sub_u32 s30, 62, s40
    s_add_u32 s30, s30, s25
    s_add_u32 s41, s40, s25
    s_cmp_eq_u32 s26, 0
    s_cselect_b32 s29, s30, s41
    s_lshl_b32 s33, s24, 11
    s_add_u32 s33, s33, 16384
    s_lshl_b32 s40, s27, 21
    s_add_u32 s40, s40, 2097152
    s_lshl_b32 s41, s25, 13
    s_add_u32 s38, s40, s41
    s_add_u32 s39, s38, 16384
    s_lshl_b32 s41, s28, 16
    s_add_u32 s41, s41, 65536
    s_cmp_eq_u32 s26, 0
    s_cselect_b32 s41, 1, s41
    s_add_u32 s44, s38, s41
    s_add_u32 s45, s39, s41
    s_add_u32 s46, s38, 1081344
    s_add_u32 s47, s39, 1081344
    s_mov_b32 s37, 163840
    s_mul_i32 s51, s29, 28672
    s_waitcnt vmcnt(16)
    v_lshlrev_b32 v110, 16, v100
    v_and_b32 v111, 0xffff0000, v100
    v_lshlrev_b32 v112, 16, v101
    v_and_b32 v113, 0xffff0000, v101
    v_lshlrev_b32 v114, 16, v102
    v_and_b32 v115, 0xffff0000, v102
    v_lshlrev_b32 v116, 16, v103
    v_and_b32 v117, 0xffff0000, v103
    v_add_f32 v130, v110, v111
    v_add_f32 v130, v130, v112
    v_add_f32 v130, v130, v113
    v_add_f32 v130, v130, v114
    v_add_f32 v130, v130, v115
    v_add_f32 v130, v130, v116
    v_add_f32 v130, v130, v117
    v_lshlrev_b32 v120, 16, v104
    v_and_b32 v121, 0xffff0000, v104
    v_lshlrev_b32 v122, 16, v105
    v_and_b32 v123, 0xffff0000, v105
    v_lshlrev_b32 v124, 16, v106
    v_and_b32 v125, 0xffff0000, v106
    v_lshlrev_b32 v126, 16, v107
    v_and_b32 v127, 0xffff0000, v107
    v_add_f32 v131, v120, v121
    v_add_f32 v131, v131, v122
    v_add_f32 v131, v131, v123
    v_add_f32 v131, v131, v124
    v_add_f32 v131, v131, v125
    v_add_f32 v131, v131, v126
    v_add_f32 v131, v131, v127
    s_nop 1
    v_add_f32_dpp v130, v130, v130 row_shr:1 row_mask:0xf bank_mask:0xf bound_ctrl:0
    v_add_f32_dpp v131, v131, v131 row_shr:1 row_mask:0xf bank_mask:0xf bound_ctrl:0
    s_nop 0
    v_add_f32_dpp v130, v130, v130 row_shr:2 row_mask:0xf bank_mask:0xf bound_ctrl:0
    v_add_f32_dpp v131, v131, v131 row_shr:2 row_mask:0xf bank_mask:0xf bound_ctrl:0
    s_nop 0
    v_add_f32_dpp v130, v130, v130 row_shr:4 row_mask:0xf bank_mask:0xf bound_ctrl:0
    v_add_f32_dpp v131, v131, v131 row_shr:4 row_mask:0xf bank_mask:0xf bound_ctrl:0
    s_nop 0
    v_add_f32_dpp v130, v130, v130 row_shr:8 row_mask:0xf bank_mask:0xf bound_ctrl:0
    v_add_f32_dpp v131, v131, v131 row_shr:8 row_mask:0xf bank_mask:0xf bound_ctrl:0
    s_nop 0
    v_add_f32_dpp v130, v130, v130 row_bcast:15 row_mask:0xa bank_mask:0xf
    v_add_f32_dpp v131, v131, v131 row_bcast:15 row_mask:0xa bank_mask:0xf
    s_nop 0
    v_add_f32_dpp v130, v130, v130 row_bcast:31 row_mask:0xc bank_mask:0xf
    v_add_f32_dpp v131, v131, v131 row_bcast:31 row_mask:0xc bank_mask:0xf
    s_nop 0
    v_readlane_b32 s40, v130, 63
    v_readlane_b32 s41, v131, 63
    s_nop 1
    v_mov_b32 v132, s40
    v_mul_f32 v132, 0x3b124925, v132
    v_mov_b32 v130, 0
    v_mov_b32 v133, s41
    v_mul_f32 v133, 0x3b124925, v133
    v_mov_b32 v131, 0
    s_mov_b64 exec, s[34:35]
    v_sub_f32 v136, v110, v132
    v_fmac_f32 v130, v136, v136
    v_sub_f32 v137, v120, v133
    v_fmac_f32 v131, v137, v137
    v_sub_f32 v136, v111, v132
    v_fmac_f32 v130, v136, v136
    v_sub_f32 v137, v121, v133
    v_fmac_f32 v131, v137, v137
    v_sub_f32 v136, v112, v132
    v_fmac_f32 v130, v136, v136
    v_sub_f32 v137, v122, v133
    v_fmac_f32 v131, v137, v137
    v_sub_f32 v136, v113, v132
    v_fmac_f32 v130, v136, v136
    v_sub_f32 v137, v123, v133
    v_fmac_f32 v131, v137, v137
    v_sub_f32 v136, v114, v132
    v_fmac_f32 v130, v136, v136
    v_sub_f32 v137, v124, v133
    v_fmac_f32 v131, v137, v137
    v_sub_f32 v136, v115, v132
    v_fmac_f32 v130, v136, v136
    v_sub_f32 v137, v125, v133
    v_fmac_f32 v131, v137, v137
    v_sub_f32 v136, v116, v132
    v_fmac_f32 v130, v136, v136
    v_sub_f32 v137, v126, v133
    v_fmac_f32 v131, v137, v137
    v_sub_f32 v136, v117, v132
    v_fmac_f32 v130, v136, v136
    v_sub_f32 v137, v127, v133
    v_fmac_f32 v131, v137, v137
    s_mov_b64 exec, -1
    s_nop 1
    v_add_f32_dpp v130, v130, v130 row_shr:1 row_mask:0xf bank_mask:0xf bound_ctrl:0
    v_add_f32_dpp v131, v131, v131 row_shr:1 row_mask:0xf bank_mask:0xf bound_ctrl:0
    s_nop 0
    v_add_f32_dpp v130, v130, v130 row_shr:2 row_mask:0xf bank_mask:0xf bound_ctrl:0
    v_add_f32_dpp v131, v131, v131 row_shr:2 row_mask:0xf bank_mask:0xf bound_ctrl:0
    s_nop 0
    v_add_f32_dpp v130, v130, v130 row_shr:4 row_mask:0xf bank_mask:0xf bound_ctrl:0
    v_add_f32_dpp v131, v131, v131 row_shr:4 row_mask:0xf bank_mask:0xf bound_ctrl:0
    s_nop 0
    v_add_f32_dpp v130, v130, v130 row_shr:8 row_mask:0xf bank_mask:0xf bound_ctrl:0
    v_add_f32_dpp v131, v131, v131 row_shr:8 row_mask:0xf bank_mask:0xf bound_ctrl:0
    s_nop 0
    v_add_f32_dpp v130, v130, v130 row_bcast:15 row_mask:0xa bank_mask:0xf
    v_add_f32_dpp v131, v131, v131 row_bcast:15 row_mask:0xa bank_mask:0xf
    s_nop 0
    v_add_f32_dpp v130, v130, v130 row_bcast:31 row_mask:0xc bank_mask:0xf
    v_add_f32_dpp v131, v131, v131 row_bcast:31 row_mask:0xc bank_mask:0xf
    s_nop 0
    v_readlane_b32 s40, v130, 63
    v_readlane_b32 s41, v131, 63
    s_nop 1
    v_mov_b32 v134, s40
    v_mov_b32 v135, s41
    v_mul_f32 v134, 0x3b124925, v134
    v_mul_f32 v135, 0x3b124925, v135
    v_cvt_pk_bf16_f32 v136, v132, v134
    v_cvt_pk_bf16_f32 v137, v133, v135
    v_lshlrev_b32 v132, 16, v136
    v_lshlrev_b32 v133, 16, v137
    v_and_b32 v134, 0xffff0000, v136
    v_and_b32 v135, 0xffff0000, v137
    v_add_f32 v134, 0x3727c5ac, v134
    v_add_f32 v135, 0x3727c5ac, v135
    v_cvt_pk_bf16_f32 v136, v134, v134
    v_cvt_pk_bf16_f32 v137, v135, v135
    v_lshlrev_b32 v134, 16, v136
    v_lshlrev_b32 v135, 16, v137
    v_sqrt_f32 v134, v134
    v_sqrt_f32 v135, v135
    v_cvt_pk_bf16_f32 v136, v134, v134
    v_cvt_pk_bf16_f32 v137, v135, v135
    v_lshlrev_b32 v134, 16, v136
    v_lshlrev_b32 v135, 16, v137
    v_rcp_f32 v134, v134
    v_rcp_f32 v135, v135
    v_sub_f32 v110, v110, v132
    v_sub_f32 v111, v111, v132
    v_sub_f32 v112, v112, v132
    v_sub_f32 v113, v113, v132
    v_sub_f32 v114, v114, v132
    v_sub_f32 v115, v115, v132
    v_sub_f32 v116, v116, v132
    v_sub_f32 v117, v117, v132
    v_cvt_pk_bf16_f32 v136, v110, v111
    v_lshlrev_b32 v110, 16, v136
    v_and_b32 v111, 0xffff0000, v136
    v_cvt_pk_bf16_f32 v136, v112, v113
    v_lshlrev_b32 v112, 16, v136
    v_and_b32 v113, 0xffff0000, v136
    v_cvt_pk_bf16_f32 v136, v114, v115
    v_lshlrev_b32 v114, 16, v136
    v_and_b32 v115, 0xffff0000, v136
    v_cvt_pk_bf16_f32 v136, v116, v117
    v_lshlrev_b32 v116, 16, v136
    v_and_b32 v117, 0xffff0000, v136
    v_mul_f32 v110, v110, v134
    v_mul_f32 v111, v111, v134
    v_mul_f32 v112, v112, v134
    v_mul_f32 v113, v113, v134
    v_mul_f32 v114, v114, v134
    v_mul_f32 v115, v115, v134
    v_mul_f32 v116, v116, v134
    v_mul_f32 v117, v117, v134
    v_cvt_pk_bf16_f32 v100, v110, v111
    v_cvt_pk_bf16_f32 v101, v112, v113
    v_cvt_pk_bf16_f32 v102, v114, v115
    v_cvt_pk_bf16_f32 v103, v116, v117
    v_sub_f32 v120, v120, v133
    v_sub_f32 v121, v121, v133
    v_sub_f32 v122, v122, v133
    v_sub_f32 v123, v123, v133
    v_sub_f32 v124, v124, v133
    v_sub_f32 v125, v125, v133
    v_sub_f32 v126, v126, v133
    v_sub_f32 v127, v127, v133
    v_cvt_pk_bf16_f32 v137, v120, v121
    v_lshlrev_b32 v120, 16, v137
    v_and_b32 v121, 0xffff0000, v137
    v_cvt_pk_bf16_f32 v137, v122, v123
    v_lshlrev_b32 v122, 16, v137
    v_and_b32 v123, 0xffff0000, v137
    v_cvt_pk_bf16_f32 v137, v124, v125
    v_lshlrev_b32 v124, 16, v137
    v_and_b32 v125, 0xffff0000, v137
    v_cvt_pk_bf16_f32 v137, v126, v127
    v_lshlrev_b32 v126, 16, v137
    v_and_b32 v127, 0xffff0000, v137
    v_mul_f32 v120, v120, v135
    v_mul_f32 v121, v121, v135
    v_mul_f32 v122, v122, v135
    v_mul_f32 v123, v123, v135
    v_mul_f32 v124, v124, v135
    v_mul_f32 v125, v125, v135
    v_mul_f32 v126, v126, v135
    v_mul_f32 v127, v127, v135
    v_cvt_pk_bf16_f32 v104, v120, v121
    v_cvt_pk_bf16_f32 v105, v122, v123
    v_cvt_pk_bf16_f32 v106, v124, v125
    v_cvt_pk_bf16_f32 v107, v126, v127
    s_add_u32 m0, s56, 32768
    s_nop 0
    buffer_load_dwordx4 v10, s[12:15], s54 offen lds
    buffer_load_dwordx4 v11, s[12:15], s54 offen offset:1024 lds
    buffer_load_dwordx4 v12, s[12:15], s54 offen offset:2048 lds
    buffer_load_dwordx4 v13, s[12:15], s54 offen offset:3072 lds
    s_add_u32 s54, s54, 262144
    s_add_u32 m0, s56, 49152
    s_nop 0
    buffer_load_dwordx4 v10, s[12:15], s54 offen lds
    buffer_load_dwordx4 v11, s[12:15], s54 offen offset:1024 lds
    buffer_load_dwordx4 v12, s[12:15], s54 offen offset:2048 lds
    buffer_load_dwordx4 v13, s[12:15], s54 offen offset:3072 lds
    s_add_u32 s54, s54, 262144
    s_add_u32 m0, s55, 32768
    s_nop 0
    buffer_load_dwordx4 v2, s[8:11], s53 offen offset:0 lds
    buffer_load_dwordx4 v3, s[8:11], s53 offen offset:1024 lds
    buffer_load_dwordx4 v4, s[8:11], s53 offen offset:2048 lds
    buffer_load_dwordx4 v5, s[8:11], s53 offen offset:3072 lds
    s_add_u32 m0, s55, 32768+4096
    s_nop 0
    buffer_load_dwordx4 v6, s[8:11], s53 offen offset:0 lds
    buffer_load_dwordx4 v7, s[8:11], s53 offen offset:1024 lds
    buffer_load_dwordx4 v8, s[8:11], s53 offen offset:2048 lds
    buffer_load_dwordx4 v9, s[8:11], s53 offen offset:3072 lds
    s_add_u32 s53, s53, 128
    s_lshl_b32 s40, s2, 7
    s_add_u32 s40, s40, 83886080
    s_lshl_b32 s41, s24, 5
    s_add_u32 s41, s41, s2
    s_cmp_lt_u32 s41, 32
    s_cselect_b32 s40, s40, 0x40000000
    v_mov_b32 v96, 0
    v_mov_b32 v97, 0
    v_mov_b32 v98, 0
    v_mov_b32 v99, 0
    s_mov_b64 exec, 0xff
    buffer_store_dwordx4 v[96:99], v27, s[4:7], s40 offen sc1
    s_mov_b64 exec, -1
    s_lshr_b32 s40, s49, 5
    s_mul_i32 s40, s40, 28672
    s_bfe_u32 s41, s49, 0x10004
    s_lshl_b32 s41, s41, 10
    s_add_u32 s40, s40, s41
    s_and_b32 s41, s49, 15
    s_lshl_b32 s41, s41, 4
    s_add_u32 s40, s40, s41
    v_lshrrev_b32 v28, 2, v1
    v_lshlrev_b32 v28, 11, v28
    v_and_b32 v29, 3, v1
    v_lshl_add_u32 v28, v29, 8, v28
    s_mov_b64 exec, s[34:35]
    buffer_store_dwordx4 v[100:103], v28, s[4:7], s40 offen sc1
    buffer_store_dwordx4 v[104:107], v28, s[4:7], s40 offen offset:16 sc1
    s_mov_b64 exec, -1
    s_waitcnt lgkmcnt(0)
    s_mov_b32 s16, s84
    s_and_b32 s17, s85, 0xffff
    s_mov_b32 s18, 3670016
    s_mov_b32 s19, 0x00020000
    s_lshl_b32 s61, s27, 8
    s_cmp_ge_u32 s27, 14
    s_cselect_b32 s61, 0x40000000, s61
    s_mov_b32 s62, s51
    s_sub_u32 s40, s28, 14
    s_cselect_b32 s40, s28, s40
    s_lshl_b32 s49, s40, 18
    s_mul_i32 s41, s40, 114688
    s_add_u32 s50, s61, s41
    s_lshl_b32 s41, s40, 11
    s_add_u32 s51, s51, s41
    s_mov_b32 s43, 0
    s_mov_b32 s57, 0
    s_mov_b32 s58, 32768
    s_add_u32 s59, s55, 65536
    s_mov_b32 s34, 0xffff0000
    s_mov_b32 s35, 32768
    s_bfe_u32 s40, s2, 0x20003
    s_lshl_b32 s99, 8, s40
    s_or_b32 s99, s99, 27140
    s_waitcnt vmcnt(19)
    s_barrier
    ds_read_b128 a[160:163], v14 offset:0
    ds_read_b128 a[164:167], v15 offset:0
    ds_read_b64_tr_b16 a[0:1], v16 offset:0
    ds_read_b64_tr_b16 a[2:3], v16 offset:2048
    ds_read_b64_tr_b16 a[4:5], v16 offset:16384
    ds_read_b64_tr_b16 a[6:7], v16 offset:18432
    ds_read_b64_tr_b16 a[8:9], v17 offset:0
    ds_read_b64_tr_b16 a[10:11], v17 offset:2048
    ds_read_b64_tr_b16 a[12:13], v17 offset:16384
    ds_read_b64_tr_b16 a[14:15], v17 offset:18432
    ds_read_b64_tr_b16 a[16:17], v18 offset:0
    ds_read_b64_tr_b16 a[18:19], v18 offset:2048
    ds_read_b64_tr_b16 a[20:21], v18 offset:16384
    ds_read_b64_tr_b16 a[22:23], v18 offset:18432
    ds_read_b64_tr_b16 a[24:25], v19 offset:0
    ds_read_b64_tr_b16 a[26:27], v19 offset:2048
    ds_read_b64_tr_b16 a[28:29], v19 offset:16384
    ds_read_b64_tr_b16 a[30:31], v19 offset:18432
    ds_read_b64_tr_b16 a[32:33], v20 offset:0
    ds_read_b64_tr_b16 a[34:35], v20 offset:2048
    ds_read_b64_tr_b16 a[36:37], v20 offset:16384
    ds_read_b64_tr_b16 a[38:39], v20 offset:18432
    ds_read_b64_tr_b16 a[40:41], v21 offset:0
    ds_read_b64_tr_b16 a[42:43], v21 offset:2048
    ds_read_b64_tr_b16 a[44:45], v21 offset:16384
    ds_read_b64_tr_b16 a[46:47], v21 offset:18432
    ds_read_b64_tr_b16 a[48:49], v22 offset:0
    ds_read_b64_tr_b16 a[50:51], v22 offset:2048
    ds_read_b64_tr_b16 a[52:53], v22 offset:16384
    ds_read_b64_tr_b16 a[54:55], v22 offset:18432
    ds_read_b64_tr_b16 a[56:57], v23 offset:0
    ds_read_b64_tr_b16 a[58:59], v23 offset:2048
    ds_read_b64_tr_b16 a[60:61], v23 offset:16384
    ds_read_b64_tr_b16 a[62:63], v23 offset:18432
    s_cmp_eq_u32 s52, 0
    s_cbranch_scc0 L_gV
    s_waitcnt lgkmcnt(15)
    v_mfma_f32_16x16x32_bf16 v[32:35], a[0:3], a[160:163], 0
    v_mfma_f32_16x16x32_bf16 v[32:35], a[4:7], a[164:167], v[32:35]
    v_mfma_f32_16x16x32_bf16 v[36:39], a[12:15], a[164:167], 0
    v_mfma_f32_16x16x32_bf16 v[36:39], a[8:11], a[160:163], v[36:39]
    v_mfma_f32_16x16x32_bf16 v[40:43], a[16:19], a[160:163], 0
    v_mfma_f32_16x16x32_bf16 v[40:43], a[20:23], a[164:167], v[40:43]
    s_mov_b32 m0, s59
    s_nop 0
    buffer_load_dwordx4 v2, s[8:11], s53 offen offset:0 lds
    v_mfma_f32_16x16x32_bf16 v[44:47], a[28:31], a[164:167], 0
    v_mfma_f32_16x16x32_bf16 v[44:47], a[24:27], a[160:163], v[44:47]
    s_waitcnt lgkmcnt(8)
    v_mfma_f32_16x16x32_bf16 v[48:51], a[32:35], a[160:163], 0
    ds_read_b128 a[168:171], v14 offset:2048
    v_mfma_f32_16x16x32_bf16 v[48:51], a[36:39], a[164:167], v[48:51]
    v_mfma_f32_16x16x32_bf16 v[52:55], a[44:47], a[164:167], 0
    ds_read_b128 a[172:175], v15 offset:2048
    v_mfma_f32_16x16x32_bf16 v[52:55], a[40:43], a[160:163], v[52:55]
    buffer_load_dwordx4 v3, s[8:11], s53 offen offset:1024 lds
    s_waitcnt lgkmcnt(2)
    v_mfma_f32_16x16x32_bf16 v[56:59], a[48:51], a[160:163], 0
    v_mfma_f32_16x16x32_bf16 v[56:59], a[52:55], a[164:167], v[56:59]
    v_mfma_f32_16x16x32_bf16 v[60:63], a[60:63], a[164:167], 0
    v_mfma_f32_16x16x32_bf16 v[60:63], a[56:59], a[160:163], v[60:63]
    s_waitcnt lgkmcnt(0)
    s_barrier
    v_mfma_f32_16x16x32_bf16 v[64:67], a[0:3], a[168:171], 0
    v_mfma_f32_16x16x32_bf16 v[64:67], a[4:7], a[172:175], v[64:67]
    ds_read_b128 a[160:163], v14 offset:4096
    buffer_load_dwordx4 v4, s[8:11], s53 offen offset:2048 lds
    v_mfma_f32_16x16x32_bf16 v[68:71], a[12:15], a[172:175], 0
    v_mfma_f32_16x16x32_bf16 v[68:71], a[8:11], a[168:171], v[68:71]
    ds_read_b128 a[164:167], v15 offset:4096
    v_mfma_f32_16x16x32_bf16 v[72:75], a[16:19], a[168:171], 0
    v_mfma_f32_16x16x32_bf16 v[72:75], a[20:23], a[172:175], v[72:75]
    v_mfma_f32_16x16x32_bf16 v[76:79], a[28:31], a[172:175], 0
    v_mfma_f32_16x16x32_bf16 v[76:79], a[24:27], a[168:171], v[76:79]
    buffer_load_dwordx4 v5, s[8:11], s53 offen offset:3072 lds
    v_mfma_f32_16x16x32_bf16 v[80:83], a[32:35], a[168:171], 0
    v_mfma_f32_16x16x32_bf16 v[80:83], a[36:39], a[172:175], v[80:83]
    v_mfma_f32_16x16x32_bf16 v[84:87], a[44:47], a[172:175], 0
    v_mfma_f32_16x16x32_bf16 v[84:87], a[40:43], a[168:171], v[84:87]
    v_mfma_f32_16x16x32_bf16 v[88:91], a[48:51], a[168:171], 0
    v_mfma_f32_16x16x32_bf16 v[88:91], a[52:55], a[172:175], v[88:91]
    v_mfma_f32_16x16x32_bf16 v[92:95], a[60:63], a[172:175], 0
    s_mov_b32 m0, s56
    s_nop 0
    buffer_load_dwordx4 v10, s[12:15], s54 offen lds
    v_mfma_f32_16x16x32_bf16 v[92:95], a[56:59], a[168:171], v[92:95]
    s_waitcnt lgkmcnt(0)
    v_mfma_f32_16x16x32_bf16 v[96:99], a[0:3], a[160:163], 0
    v_mfma_f32_16x16x32_bf16 v[96:99], a[4:7], a[164:167], v[96:99]
    ds_read_b128 a[168:171], v14 offset:6144
    v_mfma_f32_16x16x32_bf16 v[100:103], a[12:15], a[164:167], 0
    v_mfma_f32_16x16x32_bf16 v[100:103], a[8:11], a[160:163], v[100:103]
    ds_read_b128 a[172:175], v15 offset:6144
    v_mfma_f32_16x16x32_bf16 v[104:107], a[16:19], a[160:163], 0
    buffer_load_dwordx4 v11, s[12:15], s54 offen offset:1024 lds
    v_mfma_f32_16x16x32_bf16 v[104:107], a[20:23], a[164:167], v[104:107]
    v_mfma_f32_16x16x32_bf16 v[108:111], a[28:31], a[164:167], 0
    v_mfma_f32_16x16x32_bf16 v[108:111], a[24:27], a[160:163], v[108:111]
    v_mfma_f32_16x16x32_bf16 v[112:115], a[32:35], a[160:163], 0
    v_mfma_f32_16x16x32_bf16 v[112:115], a[36:39], a[164:167], v[112:115]
    v_mfma_f32_16x16x32_bf16 v[116:119], a[44:47], a[164:167], 0
    buffer_load_dwordx4 v12, s[12:15], s54 offen offset:2048 lds
    v_mfma_f32_16x16x32_bf16 v[116:119], a[40:43], a[160:163], v[116:119]
    v_mfma_f32_16x16x32_bf16 v[120:123], a[48:51], a[160:163], 0
    v_mfma_f32_16x16x32_bf16 v[120:123], a[52:55], a[164:167], v[120:123]
    v_mfma_f32_16x16x32_bf16 v[124:127], a[60:63], a[164:167], 0
    v_mfma_f32_16x16x32_bf16 v[124:127], a[56:59], a[160:163], v[124:127]
    s_waitcnt lgkmcnt(0)
    v_mfma_f32_16x16x32_bf16 v[128:131], a[0:3], a[168:171], 0
    buffer_load_dwordx4 v13, s[12:15], s54 offen offset:3072 lds
    s_add_u32 s54, s54, 262144
    v_mfma_f32_16x16x32_bf16 v[128:131], a[4:7], a[172:175], v[128:131]
    ds_read_b128 a[160:163], v14 offset:8192
    v_mfma_f32_16x16x32_bf16 v[132:135], a[12:15], a[172:175], 0
    v_mfma_f32_16x16x32_bf16 v[132:135], a[8:11], a[168:171], v[132:135]
    ds_read_b128 a[164:167], v15 offset:8192
    v_mfma_f32_16x16x32_bf16 v[136:139], a[16:19], a[168:171], 0
    v_mfma_f32_16x16x32_bf16 v[136:139], a[20:23], a[172:175], v[136:139]
    v_mfma_f32_16x16x32_bf16 v[140:143], a[28:31], a[172:175], 0
    v_mfma_f32_16x16x32_bf16 v[140:143], a[24:27], a[168:171], v[140:143]
    s_add_u32 m0, s59, 4096
    s_nop 0
    buffer_load_dwordx4 v6, s[8:11], s53 offen offset:0 lds
    v_mfma_f32_16x16x32_bf16 v[144:147], a[32:35], a[168:171], 0
    v_mfma_f32_16x16x32_bf16 v[144:147], a[36:39], a[172:175], v[144:147]
    v_mfma_f32_16x16x32_bf16 v[148:151], a[44:47], a[172:175], 0
    v_mfma_f32_16x16x32_bf16 v[148:151], a[40:43], a[168:171], v[148:151]
    v_mfma_f32_16x16x32_bf16 v[152:155], a[48:51], a[168:171], 0
    v_mfma_f32_16x16x32_bf16 v[152:155], a[52:55], a[172:175], v[152:155]
    buffer_load_dwordx4 v7, s[8:11], s53 offen offset:1024 lds
    v_mfma_f32_16x16x32_bf16 v[156:159], a[60:63], a[172:175], 0
    v_mfma_f32_16x16x32_bf16 v[156:159], a[56:59], a[168:171], v[156:159]
    s_waitcnt lgkmcnt(0)
    v_mfma_f32_16x16x32_bf16 v[160:163], a[0:3], a[160:163], 0
    v_mfma_f32_16x16x32_bf16 v[160:163], a[4:7], a[164:167], v[160:163]
    ds_read_b128 a[168:171], v14 offset:10240
    v_mfma_f32_16x16x32_bf16 v[164:167], a[12:15], a[164:167], 0
    v_mfma_f32_16x16x32_bf16 v[164:167], a[8:11], a[160:163], v[164:167]
    ds_read_b128 a[172:175], v15 offset:10240
    buffer_load_dwordx4 v8, s[8:11], s53 offen offset:2048 lds
    v_mfma_f32_16x16x32_bf16 v[168:171], a[16:19], a[160:163], 0
    v_mfma_f32_16x16x32_bf16 v[168:171], a[20:23], a[164:167], v[168:171]
    v_mfma_f32_16x16x32_bf16 v[172:175], a[28:31], a[164:167], 0
    v_xor_b32 v16, 0x8000, v16
    v_mfma_f32_16x16x32_bf16 v[172:175], a[24:27], a[160:163], v[172:175]
    v_mfma_f32_16x16x32_bf16 v[176:179], a[32:35], a[160:163], 0
    v_mfma_f32_16x16x32_bf16 v[176:179], a[36:39], a[164:167], v[176:179]
    v_xor_b32 v17, 0x8000, v17
    buffer_load_dwordx4 v9, s[8:11], s53 offen offset:3072 lds
    s_add_u32 s53, s53, 128
    v_mfma_f32_16x16x32_bf16 v[180:183], a[44:47], a[164:167], 0
    v_mfma_f32_16x16x32_bf16 v[180:183], a[40:43], a[160:163], v[180:183]
    v_mfma_f32_16x16x32_bf16 v[184:187], a[48:51], a[160:163], 0
    v_xor_b32 v18, 0x8000, v18
    v_mfma_f32_16x16x32_bf16 v[184:187], a[52:55], a[164:167], v[184:187]
    v_mfma_f32_16x16x32_bf16 v[188:191], a[60:63], a[164:167], 0
    v_mfma_f32_16x16x32_bf16 v[188:191], a[56:59], a[160:163], v[188:191]
    v_xor_b32 v19, 0x8000, v19
    s_waitcnt lgkmcnt(0)
    v_mfma_f32_16x16x32_bf16 v[192:195], a[0:3], a[168:171], 0
    s_add_u32 m0, s56, 16384
    s_nop 0
    buffer_load_dwordx4 v10, s[12:15], s54 offen lds
    v_mfma_f32_16x16x32_bf16 v[192:195], a[4:7], a[172:175], v[192:195]
    ds_read_b128 a[160:163], v14 offset:12288
    v_mfma_f32_16x16x32_bf16 v[196:199], a[12:15], a[172:175], 0
    v_xor_b32 v20, 0x8000, v20
    v_mfma_f32_16x16x32_bf16 v[196:199], a[8:11], a[168:171], v[196:199]
    ds_read_b128 a[164:167], v15 offset:12288
    v_mfma_f32_16x16x32_bf16 v[200:203], a[16:19], a[168:171], 0
    v_mfma_f32_16x16x32_bf16 v[200:203], a[20:23], a[172:175], v[200:203]
    v_xor_b32 v21, 0x8000, v21
    v_mfma_f32_16x16x32_bf16 v[204:207], a[28:31], a[172:175], 0
    buffer_load_dwordx4 v11, s[12:15], s54 offen offset:1024 lds
    v_mfma_f32_16x16x32_bf16 v[204:207], a[24:27], a[168:171], v[204:207]
    v_mfma_f32_16x16x32_bf16 v[208:211], a[32:35], a[168:171], 0
    v_xor_b32 v22, 0x8000, v22
    v_mfma_f32_16x16x32_bf16 v[208:211], a[36:39], a[172:175], v[208:211]
    v_mfma_f32_16x16x32_bf16 v[212:215], a[44:47], a[172:175], 0
    v_mfma_f32_16x16x32_bf16 v[212:215], a[40:43], a[168:171], v[212:215]
    v_xor_b32 v23, 0x8000, v23
    v_mfma_f32_16x16x32_bf16 v[216:219], a[48:51], a[168:171], 0
    buffer_load_dwordx4 v12, s[12:15], s54 offen offset:2048 lds
    v_mfma_f32_16x16x32_bf16 v[216:219], a[52:55], a[172:175], v[216:219]
    v_mfma_f32_16x16x32_bf16 v[220:223], a[60:63], a[172:175], 0
    v_mfma_f32_16x16x32_bf16 v[220:223], a[56:59], a[168:171], v[220:223]
    s_waitcnt lgkmcnt(0)
    v_mfma_f32_16x16x32_bf16 v[224:227], a[0:3], a[160:163], 0
    v_mfma_f32_16x16x32_bf16 v[224:227], a[4:7], a[164:167], v[224:227]
    ds_read_b128 a[168:171], v14 offset:14336
    v_mfma_f32_16x16x32_bf16 v[228:231], a[12:15], a[164:167], 0
    buffer_load_dwordx4 v13, s[12:15], s54 offen offset:3072 lds
    s_add_u32 s54, s54, 262144
    v_mfma_f32_16x16x32_bf16 v[228:231], a[8:11], a[160:163], v[228:231]
    ds_read_b128 a[172:175], v15 offset:14336
    v_mfma_f32_16x16x32_bf16 v[232:235], a[16:19], a[160:163], 0
    v_mfma_f32_16x16x32_bf16 v[232:235], a[20:23], a[164:167], v[232:235]
    v_add_u32 v14, s58, v14
    v_mfma_f32_16x16x32_bf16 v[236:239], a[28:31], a[164:167], 0
    v_mfma_f32_16x16x32_bf16 v[236:239], a[24:27], a[160:163], v[236:239]
    v_add_u32 v15, s58, v15
    v_mfma_f32_16x16x32_bf16 v[240:243], a[32:35], a[160:163], 0
    v_mfma_f32_16x16x32_bf16 v[240:243], a[36:39], a[164:167], v[240:243]
    v_mfma_f32_16x16x32_bf16 v[244:247], a[44:47], a[164:167], 0
    s_add_u32 s59, s55, s57
    s_add_u32 s57, s57, s58
    v_mfma_f32_16x16x32_bf16 v[244:247], a[40:43], a[160:163], v[244:247]
    v_mfma_f32_16x16x32_bf16 v[248:251], a[48:51], a[160:163], 0
    s_cmp_eq_u32 s57, 65536
    s_cselect_b32 s58, s34, s35
    v_mfma_f32_16x16x32_bf16 v[248:251], a[52:55], a[164:167], v[248:251]
    v_mfma_f32_16x16x32_bf16 v[252:255], a[60:63], a[164:167], 0
    s_xor_b32 s56, s56, 0x8000
    s_add_u32 s43, s43, 1
    v_mfma_f32_16x16x32_bf16 v[252:255], a[56:59], a[160:163], v[252:255]
    s_waitcnt lgkmcnt(0)
    s_waitcnt vmcnt(16)
    s_barrier
    v_mfma_f32_16x16x32_bf16 a[64:67], a[0:3], a[168:171], 0
    ds_read_b128 a[160:163], v14 offset:0
    ds_read_b128 a[164:167], v15 offset:0
    v_mfma_f32_16x16x32_bf16 a[64:67], a[4:7], a[172:175], a[64:67]
    ds_read_b64_tr_b16 a[0:1], v16 offset:0
    ds_read_b64_tr_b16 a[2:3], v16 offset:2048
    v_mfma_f32_16x16x32_bf16 a[68:71], a[12:15], a[172:175], 0
    ds_read_b64_tr_b16 a[4:5], v16 offset:16384
    ds_read_b64_tr_b16 a[6:7], v16 offset:18432
    v_mfma_f32_16x16x32_bf16 a[68:71], a[8:11], a[168:171], a[68:71]
    ds_read_b64_tr_b16 a[8:9], v17 offset:0
    ds_read_b64_tr_b16 a[10:11], v17 offset:2048
    v_mfma_f32_16x16x32_bf16 a[72:75], a[16:19], a[168:171], 0
    ds_read_b64_tr_b16 a[12:13], v17 offset:16384
    ds_read_b64_tr_b16 a[14:15], v17 offset:18432
    v_mfma_f32_16x16x32_bf16 a[72:75], a[20:23], a[172:175], a[72:75]
    ds_read_b64_tr_b16 a[16:17], v18 offset:0
    ds_read_b64_tr_b16 a[18:19], v18 offset:2048
    v_mfma_f32_16x16x32_bf16 a[76:79], a[28:31], a[172:175], 0
    ds_read_b64_tr_b16 a[20:21], v18 offset:16384
    ds_read_b64_tr_b16 a[22:23], v18 offset:18432
    v_mfma_f32_16x16x32_bf16 a[76:79], a[24:27], a[168:171], a[76:79]
    ds_read_b64_tr_b16 a[24:25], v19 offset:0
    ds_read_b64_tr_b16 a[26:27], v19 offset:2048
    v_mfma_f32_16x16x32_bf16 a[80:83], a[32:35], a[168:171], 0
    ds_read_b64_tr_b16 a[28:29], v19 offset:16384
    ds_read_b64_tr_b16 a[30:31], v19 offset:18432
    v_mfma_f32_16x16x32_bf16 a[80:83], a[36:39], a[172:175], a[80:83]
    ds_read_b64_tr_b16 a[32:33], v20 offset:0
    ds_read_b64_tr_b16 a[34:35], v20 offset:2048
    v_mfma_f32_16x16x32_bf16 a[84:87], a[44:47], a[172:175], 0
    ds_read_b64_tr_b16 a[36:37], v20 offset:16384
    ds_read_b64_tr_b16 a[38:39], v20 offset:18432
    v_mfma_f32_16x16x32_bf16 a[84:87], a[40:43], a[168:171], a[84:87]
    ds_read_b64_tr_b16 a[40:41], v21 offset:0
    ds_read_b64_tr_b16 a[42:43], v21 offset:2048
    v_mfma_f32_16x16x32_bf16 a[88:91], a[48:51], a[168:171], 0
    ds_read_b64_tr_b16 a[44:45], v21 offset:16384
    ds_read_b64_tr_b16 a[46:47], v21 offset:18432
    v_mfma_f32_16x16x32_bf16 a[88:91], a[52:55], a[172:175], a[88:91]
    ds_read_b64_tr_b16 a[48:49], v22 offset:0
    ds_read_b64_tr_b16 a[50:51], v22 offset:2048
    v_mfma_f32_16x16x32_bf16 a[92:95], a[60:63], a[172:175], 0
    ds_read_b64_tr_b16 a[52:53], v22 offset:16384
    ds_read_b64_tr_b16 a[54:55], v22 offset:18432
    v_mfma_f32_16x16x32_bf16 a[92:95], a[56:59], a[168:171], a[92:95]
    ds_read_b64_tr_b16 a[56:57], v23 offset:0
    ds_read_b64_tr_b16 a[58:59], v23 offset:2048
    ds_read_b64_tr_b16 a[60:61], v23 offset:16384
    ds_read_b64_tr_b16 a[62:63], v23 offset:18432
    s_bitcmp0_b32 s99, s43
.p2align 3
L_loopK:
    s_waitcnt lgkmcnt(15)
    v_mfma_f32_16x16x32_bf16 v[32:35], a[0:3], a[160:163], v[32:35]
    v_mfma_f32_16x16x32_bf16 v[32:35], a[4:7], a[164:167], v[32:35]
    v_mfma_f32_16x16x32_bf16 v[36:39], a[12:15], a[164:167], v[36:39]
    v_mfma_f32_16x16x32_bf16 v[36:39], a[8:11], a[160:163], v[36:39]
    v_mfma_f32_16x16x32_bf16 v[40:43], a[16:19], a[160:163], v[40:43]
    v_mfma_f32_16x16x32_bf16 v[40:43], a[20:23], a[164:167], v[40:43]
    s_mov_b32 m0, s59
    s_nop 0
    buffer_load_dwordx4 v2, s[8:11], s53 offen offset:0 lds
    v_mfma_f32_16x16x32_bf16 v[44:47], a[28:31], a[164:167], v[44:47]
    v_mfma_f32_16x16x32_bf16 v[44:47], a[24:27], a[160:163], v[44:47]
    s_waitcnt lgkmcnt(8)
    v_mfma_f32_16x16x32_bf16 v[48:51], a[32:35], a[160:163], v[48:51]
    ds_read_b128 a[168:171], v14 offset:2048
    v_mfma_f32_16x16x32_bf16 v[48:51], a[36:39], a[164:167], v[48:51]
    v_mfma_f32_16x16x32_bf16 v[52:55], a[44:47], a[164:167], v[52:55]
    ds_read_b128 a[172:175], v15 offset:2048
    v_mfma_f32_16x16x32_bf16 v[52:55], a[40:43], a[160:163], v[52:55]
    buffer_load_dwordx4 v3, s[8:11], s53 offen offset:1024 lds
    s_waitcnt lgkmcnt(2)
    v_mfma_f32_16x16x32_bf16 v[56:59], a[48:51], a[160:163], v[56:59]
    v_mfma_f32_16x16x32_bf16 v[56:59], a[52:55], a[164:167], v[56:59]
    v_mfma_f32_16x16x32_bf16 v[60:63], a[60:63], a[164:167], v[60:63]
    v_mfma_f32_16x16x32_bf16 v[60:63], a[56:59], a[160:163], v[60:63]
    s_waitcnt lgkmcnt(0)
    s_barrier
    v_mfma_f32_16x16x32_bf16 v[64:67], a[0:3], a[168:171], v[64:67]
    v_mfma_f32_16x16x32_bf16 v[64:67], a[4:7], a[172:175], v[64:67]
    ds_read_b128 a[160:163], v14 offset:4096
    buffer_load_dwordx4 v4, s[8:11], s53 offen offset:2048 lds
    v_mfma_f32_16x16x32_bf16 v[68:71], a[12:15], a[172:175], v[68:71]
    v_mfma_f32_16x16x32_bf16 v[68:71], a[8:11], a[168:171], v[68:71]
    ds_read_b128 a[164:167], v15 offset:4096
    v_mfma_f32_16x16x32_bf16 v[72:75], a[16:19], a[168:171], v[72:75]
    v_mfma_f32_16x16x32_bf16 v[72:75], a[20:23], a[172:175], v[72:75]
    v_mfma_f32_16x16x32_bf16 v[76:79], a[28:31], a[172:175], v[76:79]
    v_mfma_f32_16x16x32_bf16 v[76:79], a[24:27], a[168:171], v[76:79]
    buffer_load_dwordx4 v5, s[8:11], s53 offen offset:3072 lds
    v_mfma_f32_16x16x32_bf16 v[80:83], a[32:35], a[168:171], v[80:83]
    v_mfma_f32_16x16x32_bf16 v[80:83], a[36:39], a[172:175], v[80:83]
    v_mfma_f32_16x16x32_bf16 v[84:87], a[44:47], a[172:175], v[84:87]
    v_mfma_f32_16x16x32_bf16 v[84:87], a[40:43], a[168:171], v[84:87]
    v_mfma_f32_16x16x32_bf16 v[88:91], a[48:51], a[168:171], v[88:91]
    v_mfma_f32_16x16x32_bf16 v[88:91], a[52:55], a[172:175], v[88:91]
    v_mfma_f32_16x16x32_bf16 v[92:95], a[60:63], a[172:175], v[92:95]
    s_mov_b32 m0, s56
    s_nop 0
    buffer_load_dwordx4 v10, s[12:15], s54 offen lds
    v_mfma_f32_16x16x32_bf16 v[92:95], a[56:59], a[168:171], v[92:95]
    s_waitcnt lgkmcnt(0)
    v_mfma_f32_16x16x32_bf16 v[96:99], a[0:3], a[160:163], v[96:99]
    v_mfma_f32_16x16x32_bf16 v[96:99], a[4:7], a[164:167], v[96:99]
    ds_read_b128 a[168:171], v14 offset:6144
    v_mfma_f32_16x16x32_bf16 v[100:103], a[12:15], a[164:167], v[100:103]
    v_mfma_f32_16x16x32_bf16 v[100:103], a[8:11], a[160:163], v[100:103]
    ds_read_b128 a[172:175], v15 offset:6144
    v_mfma_f32_16x16x32_bf16 v[104:107], a[16:19], a[160:163], v[104:107]
    buffer_load_dwordx4 v11, s[12:15], s54 offen offset:1024 lds
    v_mfma_f32_16x16x32_bf16 v[104:107], a[20:23], a[164:167], v[104:107]
    v_mfma_f32_16x16x32_bf16 v[108:111], a[28:31], a[164:167], v[108:111]
    v_mfma_f32_16x16x32_bf16 v[108:111], a[24:27], a[160:163], v[108:111]
    v_mfma_f32_16x16x32_bf16 v[112:115], a[32:35], a[160:163], v[112:115]
    v_mfma_f32_16x16x32_bf16 v[112:115], a[36:39], a[164:167], v[112:115]
    v_mfma_f32_16x16x32_bf16 v[116:119], a[44:47], a[164:167], v[116:119]
    buffer_load_dwordx4 v12, s[12:15], s54 offen offset:2048 lds
    v_mfma_f32_16x16x32_bf16 v[116:119], a[40:43], a[160:163], v[116:119]
    v_mfma_f32_16x16x32_bf16 v[120:123], a[48:51], a[160:163], v[120:123]
    v_mfma_f32_16x16x32_bf16 v[120:123], a[52:55], a[164:167], v[120:123]
    v_mfma_f32_16x16x32_bf16 v[124:127], a[60:63], a[164:167], v[124:127]
    v_mfma_f32_16x16x32_bf16 v[124:127], a[56:59], a[160:163], v[124:127]
    s_waitcnt lgkmcnt(0)
    v_mfma_f32_16x16x32_bf16 v[128:131], a[0:3], a[168:171], v[128:131]
    buffer_load_dwordx4 v13, s[12:15], s54 offen offset:3072 lds
    s_add_u32 s54, s54, 262144
    v_mfma_f32_16x16x32_bf16 v[128:131], a[4:7], a[172:175], v[128:131]
    ds_read_b128 a[160:163], v14 offset:8192
    v_mfma_f32_16x16x32_bf16 v[132:135], a[12:15], a[172:175], v[132:135]
    v_mfma_f32_16x16x32_bf16 v[132:135], a[8:11], a[168:171], v[132:135]
    ds_read_b128 a[164:167], v15 offset:8192
    v_mfma_f32_16x16x32_bf16 v[136:139], a[16:19], a[168:171], v[136:139]
    v_mfma_f32_16x16x32_bf16 v[136:139], a[20:23], a[172:175], v[136:139]
    v_mfma_f32_16x16x32_bf16 v[140:143], a[28:31], a[172:175], v[140:143]
    v_mfma_f32_16x16x32_bf16 v[140:143], a[24:27], a[168:171], v[140:143]
    s_add_u32 m0, s59, 4096
    s_nop 0
    buffer_load_dwordx4 v6, s[8:11], s53 offen offset:0 lds
    v_mfma_f32_16x16x32_bf16 v[144:147], a[32:35], a[168:171], v[144:147]
    v_mfma_f32_16x16x32_bf16 v[144:147], a[36:39], a[172:175], v[144:147]
    v_mfma_f32_16x16x32_bf16 v[148:151], a[44:47], a[172:175], v[148:151]
    v_mfma_f32_16x16x32_bf16 v[148:151], a[40:43], a[168:171], v[148:151]
    v_mfma_f32_16x16x32_bf16 v[152:155], a[48:51], a[168:171], v[152:155]
    v_mfma_f32_16x16x32_bf16 v[152:155], a[52:55], a[172:175], v[152:155]
    buffer_load_dwordx4 v7, s[8:11], s53 offen offset:1024 lds
    v_mfma_f32_16x16x32_bf16 v[156:159], a[60:63], a[172:175], v[156:159]
    v_mfma_f32_16x16x32_bf16 v[156:159], a[56:59], a[168:171], v[156:159]
    s_waitcnt lgkmcnt(0)
    v_mfma_f32_16x16x32_bf16 v[160:163], a[0:3], a[160:163], v[160:163]
    v_mfma_f32_16x16x32_bf16 v[160:163], a[4:7], a[164:167], v[160:163]
    ds_read_b128 a[168:171], v14 offset:10240
    v_mfma_f32_16x16x32_bf16 v[164:167], a[12:15], a[164:167], v[164:167]
    v_mfma_f32_16x16x32_bf16 v[164:167], a[8:11], a[160:163], v[164:167]
    ds_read_b128 a[172:175], v15 offset:10240
    buffer_load_dwordx4 v8, s[8:11], s53 offen offset:2048 lds
    v_mfma_f32_16x16x32_bf16 v[168:171], a[16:19], a[160:163], v[168:171]
    v_mfma_f32_16x16x32_bf16 v[168:171], a[20:23], a[164:167], v[168:171]
    v_mfma_f32_16x16x32_bf16 v[172:175], a[28:31], a[164:167], v[172:175]
    v_xor_b32 v16, 0x8000, v16
    v_mfma_f32_16x16x32_bf16 v[172:175], a[24:27], a[160:163], v[172:175]
    v_mfma_f32_16x16x32_bf16 v[176:179], a[32:35], a[160:163], v[176:179]
    v_mfma_f32_16x16x32_bf16 v[176:179], a[36:39], a[164:167], v[176:179]
    v_xor_b32 v17, 0x8000, v17
    buffer_load_dwordx4 v9, s[8:11], s53 offen offset:3072 lds
    s_add_u32 s53, s53, 128
    v_mfma_f32_16x16x32_bf16 v[180:183], a[44:47], a[164:167], v[180:183]
    v_mfma_f32_16x16x32_bf16 v[180:183], a[40:43], a[160:163], v[180:183]
    v_mfma_f32_16x16x32_bf16 v[184:187], a[48:51], a[160:163], v[184:187]
    v_xor_b32 v18, 0x8000, v18
    v_mfma_f32_16x16x32_bf16 v[184:187], a[52:55], a[164:167], v[184:187]
    v_mfma_f32_16x16x32_bf16 v[188:191], a[60:63], a[164:167], v[188:191]
    v_mfma_f32_16x16x32_bf16 v[188:191], a[56:59], a[160:163], v[188:191]
    v_xor_b32 v19, 0x8000, v19
    s_waitcnt lgkmcnt(0)
    v_mfma_f32_16x16x32_bf16 v[192:195], a[0:3], a[168:171], v[192:195]
    s_add_u32 m0, s56, 16384
    s_nop 0
    buffer_load_dwordx4 v10, s[12:15], s54 offen lds
    v_mfma_f32_16x16x32_bf16 v[192:195], a[4:7], a[172:175], v[192:195]
    ds_read_b128 a[160:163], v14 offset:12288
    v_mfma_f32_16x16x32_bf16 v[196:199], a[12:15], a[172:175], v[196:199]
    v_xor_b32 v20, 0x8000, v20
    v_mfma_f32_16x16x32_bf16 v[196:199], a[8:11], a[168:171], v[196:199]
    ds_read_b128 a[164:167], v15 offset:12288
    v_mfma_f32_16x16x32_bf16 v[200:203], a[16:19], a[168:171], v[200:203]
    v_mfma_f32_16x16x32_bf16 v[200:203], a[20:23], a[172:175], v[200:203]
    v_xor_b32 v21, 0x8000, v21
    v_mfma_f32_16x16x32_bf16 v[204:207], a[28:31], a[172:175], v[204:207]
    buffer_load_dwordx4 v11, s[12:15], s54 offen offset:1024 lds
    v_mfma_f32_16x16x32_bf16 v[204:207], a[24:27], a[168:171], v[204:207]
    v_mfma_f32_16x16x32_bf16 v[208:211], a[32:35], a[168:171], v[208:211]
    v_xor_b32 v22, 0x8000, v22
    v_mfma_f32_16x16x32_bf16 v[208:211], a[36:39], a[172:175], v[208:211]
    v_mfma_f32_16x16x32_bf16 v[212:215], a[44:47], a[172:175], v[212:215]
    v_mfma_f32_16x16x32_bf16 v[212:215], a[40:43], a[168:171], v[212:215]
    v_xor_b32 v23, 0x8000, v23
    v_mfma_f32_16x16x32_bf16 v[216:219], a[48:51], a[168:171], v[216:219]
    buffer_load_dwordx4 v12, s[12:15], s54 offen offset:2048 lds
    v_mfma_f32_16x16x32_bf16 v[216:219], a[52:55], a[172:175], v[216:219]
    v_mfma_f32_16x16x32_bf16 v[220:223], a[60:63], a[172:175], v[220:223]
    v_mfma_f32_16x16x32_bf16 v[220:223], a[56:59], a[168:171], v[220:223]
    s_waitcnt lgkmcnt(0)
    v_mfma_f32_16x16x32_bf16 v[224:227], a[0:3], a[160:163], v[224:227]
    v_mfma_f32_16x16x32_bf16 v[224:227], a[4:7], a[164:167], v[224:227]
    ds_read_b128 a[168:171], v14 offset:14336
    v_mfma_f32_16x16x32_bf16 v[228:231], a[12:15], a[164:167], v[228:231]
    buffer_load_dwordx4 v13, s[12:15], s54 offen offset:3072 lds
    s_add_u32 s54, s54, 262144
    v_mfma_f32_16x16x32_bf16 v[228:231], a[8:11], a[160:163], v[228:231]
    ds_read_b128 a[172:175], v15 offset:14336
    v_mfma_f32_16x16x32_bf16 v[232:235], a[16:19], a[160:163], v[232:235]
    v_mfma_f32_16x16x32_bf16 v[232:235], a[20:23], a[164:167], v[232:235]
    v_add_u32 v14, s58, v14
    v_mfma_f32_16x16x32_bf16 v[236:239], a[28:31], a[164:167], v[236:239]
    v_mfma_f32_16x16x32_bf16 v[236:239], a[24:27], a[160:163], v[236:239]
    v_add_u32 v15, s58, v15
    v_mfma_f32_16x16x32_bf16 v[240:243], a[32:35], a[160:163], v[240:243]
    v_mfma_f32_16x16x32_bf16 v[240:243], a[36:39], a[164:167], v[240:243]
    v_mfma_f32_16x16x32_bf16 v[244:247], a[44:47], a[164:167], v[244:247]
    s_add_u32 s59, s55, s57
    s_add_u32 s57, s57, s58
    v_mfma_f32_16x16x32_bf16 v[244:247], a[40:43], a[160:163], v[244:247]
    v_mfma_f32_16x16x32_bf16 v[248:251], a[48:51], a[160:163], v[248:251]
    s_cmp_eq_u32 s57, 65536
    s_cselect_b32 s58, s34, s35
    v_mfma_f32_16x16x32_bf16 v[248:251], a[52:55], a[164:167], v[248:251]
    v_mfma_f32_16x16x32_bf16 v[252:255], a[60:63], a[164:167], v[252:255]
    s_xor_b32 s56, s56, 0x8000
    s_add_u32 s43, s43, 1
    v_mfma_f32_16x16x32_bf16 v[252:255], a[56:59], a[160:163], v[252:255]
    s_waitcnt lgkmcnt(0)
    s_waitcnt vmcnt(16)
    s_barrier
    v_mfma_f32_16x16x32_bf16 a[64:67], a[0:3], a[168:171], a[64:67]
    ds_read_b128 a[160:163], v14 offset:0
    ds_read_b128 a[164:167], v15 offset:0
    v_mfma_f32_16x16x32_bf16 a[64:67], a[4:7], a[172:175], a[64:67]
    ds_read_b64_tr_b16 a[0:1], v16 offset:0
    ds_read_b64_tr_b16 a[2:3], v16 offset:2048
    v_mfma_f32_16x16x32_bf16 a[68:71], a[12:15], a[172:175], a[68:71]
    ds_read_b64_tr_b16 a[4:5], v16 offset:16384
    ds_read_b64_tr_b16 a[6:7], v16 offset:18432
    v_mfma_f32_16x16x32_bf16 a[68:71], a[8:11], a[168:171], a[68:71]
    ds_read_b64_tr_b16 a[8:9], v17 offset:0
    ds_read_b64_tr_b16 a[10:11], v17 offset:2048
    v_mfma_f32_16x16x32_bf16 a[72:75], a[16:19], a[168:171], a[72:75]
    ds_read_b64_tr_b16 a[12:13], v17 offset:16384
    ds_read_b64_tr_b16 a[14:15], v17 offset:18432
    v_mfma_f32_16x16x32_bf16 a[72:75], a[20:23], a[172:175], a[72:75]
    ds_read_b64_tr_b16 a[16:17], v18 offset:0
    ds_read_b64_tr_b16 a[18:19], v18 offset:2048
    v_mfma_f32_16x16x32_bf16 a[76:79], a[28:31], a[172:175], a[76:79]
    ds_read_b64_tr_b16 a[20:21], v18 offset:16384
    ds_read_b64_tr_b16 a[22:23], v18 offset:18432
    v_mfma_f32_16x16x32_bf16 a[76:79], a[24:27], a[168:171], a[76:79]
    ds_read_b64_tr_b16 a[24:25], v19 offset:0
    ds_read_b64_tr_b16 a[26:27], v19 offset:2048
    v_mfma_f32_16x16x32_bf16 a[80:83], a[32:35], a[168:171], a[80:83]
    ds_read_b64_tr_b16 a[28:29], v19 offset:16384
    ds_read_b64_tr_b16 a[30:31], v19 offset:18432
    v_mfma_f32_16x16x32_bf16 a[80:83], a[36:39], a[172:175], a[80:83]
    ds_read_b64_tr_b16 a[32:33], v20 offset:0
    ds_read_b64_tr_b16 a[34:35], v20 offset:2048
    v_mfma_f32_16x16x32_bf16 a[84:87], a[44:47], a[172:175], a[84:87]
    ds_read_b64_tr_b16 a[36:37], v20 offset:16384
    ds_read_b64_tr_b16 a[38:39], v20 offset:18432
    v_mfma_f32_16x16x32_bf16 a[84:87], a[40:43], a[168:171], a[84:87]
    ds_read_b64_tr_b16 a[40:41], v21 offset:0
    ds_read_b64_tr_b16 a[42:43], v21 offset:2048
    v_mfma_f32_16x16x32_bf16 a[88:91], a[48:51], a[168:171], a[88:91]
    ds_read_b64_tr_b16 a[44:45], v21 offset:16384
    ds_read_b64_tr_b16 a[46:47], v21 offset:18432
    v_mfma_f32_16x16x32_bf16 a[88:91], a[52:55], a[172:175], a[88:91]
    ds_read_b64_tr_b16 a[48:49], v22 offset:0
    ds_read_b64_tr_b16 a[50:51], v22 offset:2048
    v_mfma_f32_16x16x32_bf16 a[92:95], a[60:63], a[172:175], a[92:95]
    ds_read_b64_tr_b16 a[52:53], v22 offset:16384
    ds_read_b64_tr_b16 a[54:55], v22 offset:18432
    v_mfma_f32_16x16x32_bf16 a[92:95], a[56:59], a[168:171], a[92:95]
    ds_read_b64_tr_b16 a[56:57], v23 offset:0
    ds_read_b64_tr_b16 a[58:59], v23 offset:2048
    ds_read_b64_tr_b16 a[60:61], v23 offset:16384
    ds_read_b64_tr_b16 a[62:63], v23 offset:18432
    s_bitcmp0_b32 s99, s43
    s_cbranch_scc1 L_loopK
    s_cmp_lg_u32 s43, 14
    s_cbranch_scc1 L_hook
    s_waitcnt lgkmcnt(15)
    v_mfma_f32_16x16x32_bf16 v[32:35], a[0:3], a[160:163], v[32:35]
    v_mfma_f32_16x16x32_bf16 v[32:35], a[4:7], a[164:167], v[32:35]
    v_mfma_f32_16x16x32_bf16 v[36:39], a[12:15], a[164:167], v[36:39]
    v_lshrrev_b32 v28, 5, v1
    s_lshl_b32 s40, s24, 3
    v_mfma_f32_16x16x32_bf16 v[36:39], a[8:11], a[160:163], v[36:39]
    v_add_u32 v29, s40, v28
    v_mfma_f32_16x16x32_bf16 v[40:43], a[16:19], a[160:163], v[40:43]
    v_lshlrev_b32 v29, 13, v29
    v_mfma_f32_16x16x32_bf16 v[40:43], a[20:23], a[164:167], v[40:43]
    s_lshl_b32 s40, s27, 9
    v_mfma_f32_16x16x32_bf16 v[44:47], a[28:31], a[164:167], v[44:47]
    v_add_u32 v29, s40, v29
    v_mfma_f32_16x16x32_bf16 v[44:47], a[24:27], a[160:163], v[44:47]
    v_lshlrev_b32 v28, 1, v28
    s_waitcnt lgkmcnt(8)
    v_mfma_f32_16x16x32_bf16 v[48:51], a[32:35], a[160:163], v[48:51]
    ds_read_b128 a[168:171], v14 offset:2048
    v_and_b32 v30, 31, v1
    v_mfma_f32_16x16x32_bf16 v[48:51], a[36:39], a[164:167], v[48:51]
    v_xor_b32 v28, v28, v30
    v_mfma_f32_16x16x32_bf16 v[52:55], a[44:47], a[164:167], v[52:55]
    ds_read_b128 a[172:175], v15 offset:2048
    s_lshl_b32 s40, s25, 3
    v_mfma_f32_16x16x32_bf16 v[52:55], a[40:43], a[160:163], v[52:55]
    v_xor_b32 v28, s40, v28
    s_waitcnt lgkmcnt(2)
    v_mfma_f32_16x16x32_bf16 v[56:59], a[48:51], a[160:163], v[56:59]
    v_xor_b32 v30, 4, v28
    v_mfma_f32_16x16x32_bf16 v[56:59], a[52:55], a[164:167], v[56:59]
    v_lshl_add_u32 v28, v28, 4, v29
    v_mfma_f32_16x16x32_bf16 v[60:63], a[60:63], a[164:167], v[60:63]
    v_lshl_add_u32 v30, v30, 4, v29
    v_mfma_f32_16x16x32_bf16 v[60:63], a[56:59], a[160:163], v[60:63]
    v_add_u32 v2, 0, v28
    s_waitcnt lgkmcnt(0)
    s_barrier
    v_mfma_f32_16x16x32_bf16 v[64:67], a[0:3], a[168:171], v[64:67]
    v_add_u32 v3, 15360, v30
    v_mfma_f32_16x16x32_bf16 v[64:67], a[4:7], a[172:175], v[64:67]
    ds_read_b128 a[160:163], v14 offset:4096
    v_add_u32 v4, 30720, v28
    v_mfma_f32_16x16x32_bf16 v[68:71], a[12:15], a[172:175], v[68:71]
    v_add_u32 v5, 46080, v30
    v_mfma_f32_16x16x32_bf16 v[68:71], a[8:11], a[168:171], v[68:71]
    ds_read_b128 a[164:167], v15 offset:4096
    v_lshrrev_b32 v28, 4, v1
    v_mfma_f32_16x16x32_bf16 v[72:75], a[16:19], a[168:171], v[72:75]
    s_lshl_b32 s40, s24, 3
    v_mfma_f32_16x16x32_bf16 v[72:75], a[20:23], a[172:175], v[72:75]
    v_add_u32 v29, s40, v28
    v_mfma_f32_16x16x32_bf16 v[76:79], a[28:31], a[172:175], v[76:79]
    v_mul_u32_u24 v29, 3584, v29
    v_mfma_f32_16x16x32_bf16 v[76:79], a[24:27], a[168:171], v[76:79]
    v_lshlrev_b32 v28, 1, v28
    v_mfma_f32_16x16x32_bf16 v[80:83], a[32:35], a[168:171], v[80:83]
    v_and_b32 v30, 15, v1
    v_mfma_f32_16x16x32_bf16 v[80:83], a[36:39], a[172:175], v[80:83]
    v_xor_b32 v28, v28, v30
    v_mfma_f32_16x16x32_bf16 v[84:87], a[44:47], a[172:175], v[84:87]
    s_lshl_b32 s40, s25, 3
    v_mfma_f32_16x16x32_bf16 v[84:87], a[40:43], a[168:171], v[84:87]
    v_xor_b32 v28, s40, v28
    v_mfma_f32_16x16x32_bf16 v[88:91], a[48:51], a[168:171], v[88:91]
    v_lshl_add_u32 v6, v28, 4, v29
    v_mfma_f32_16x16x32_bf16 v[88:91], a[52:55], a[172:175], v[88:91]
    v_add_u32 v7, 13312, v6
    v_mfma_f32_16x16x32_bf16 v[92:95], a[60:63], a[172:175], v[92:95]
    v_accvgpr_read_b32 v31, a224
    v_lshlrev_b32 v24, 16, v31
    v_mfma_f32_16x16x32_bf16 v[92:95], a[56:59], a[168:171], v[92:95]
    v_and_b32 v31, 0xffff0000, v31
    s_waitcnt lgkmcnt(0)
    v_mfma_f32_16x16x32_bf16 v[96:99], a[0:3], a[160:163], v[96:99]
    v_accvgpr_write_b32 a96, v24
    v_mfma_f32_16x16x32_bf16 v[96:99], a[4:7], a[164:167], v[96:99]
    ds_read_b128 a[168:171], v14 offset:6144
    v_accvgpr_write_b32 a97, v31
    v_mfma_f32_16x16x32_bf16 v[100:103], a[12:15], a[164:167], v[100:103]
    s_add_u32 m0, s32, 98304
    s_nop 0
    buffer_load_dwordx4 v2, s[16:19], s49 offen lds
    v_accvgpr_write_b32 a112, v24
    v_mfma_f32_16x16x32_bf16 v[100:103], a[8:11], a[160:163], v[100:103]
    ds_read_b128 a[172:175], v15 offset:6144
    v_accvgpr_write_b32 a113, v31
    v_mfma_f32_16x16x32_bf16 v[104:107], a[16:19], a[160:163], v[104:107]
    v_accvgpr_write_b32 a128, v24
    v_mfma_f32_16x16x32_bf16 v[104:107], a[20:23], a[164:167], v[104:107]
    v_accvgpr_write_b32 a129, v31
    v_mfma_f32_16x16x32_bf16 v[108:111], a[28:31], a[164:167], v[108:111]
    v_accvgpr_write_b32 a144, v24
    v_mfma_f32_16x16x32_bf16 v[108:111], a[24:27], a[160:163], v[108:111]
    v_accvgpr_write_b32 a145, v31
    v_mfma_f32_16x16x32_bf16 v[112:115], a[32:35], a[160:163], v[112:115]
    v_accvgpr_read_b32 v31, a225
    v_mfma_f32_16x16x32_bf16 v[112:115], a[36:39], a[164:167], v[112:115]
    v_lshlrev_b32 v24, 16, v31
    v_and_b32 v31, 0xffff0000, v31
    v_mfma_f32_16x16x32_bf16 v[116:119], a[44:47], a[164:167], v[116:119]
    buffer_load_dwordx4 v3, s[16:19], s49 offen offset:1024 lds
    v_accvgpr_write_b32 a98, v24
    v_mfma_f32_16x16x32_bf16 v[116:119], a[40:43], a[160:163], v[116:119]
    v_accvgpr_write_b32 a99, v31
    v_mfma_f32_16x16x32_bf16 v[120:123], a[48:51], a[160:163], v[120:123]
    v_accvgpr_write_b32 a114, v24
    v_mfma_f32_16x16x32_bf16 v[120:123], a[52:55], a[164:167], v[120:123]
    v_accvgpr_write_b32 a115, v31
    v_mfma_f32_16x16x32_bf16 v[124:127], a[60:63], a[164:167], v[124:127]
    v_accvgpr_write_b32 a130, v24
    v_mfma_f32_16x16x32_bf16 v[124:127], a[56:59], a[160:163], v[124:127]
    v_accvgpr_write_b32 a131, v31
    s_waitcnt lgkmcnt(0)
    v_mfma_f32_16x16x32_bf16 v[128:131], a[0:3], a[168:171], v[128:131]
    v_accvgpr_write_b32 a146, v24
    v_mfma_f32_16x16x32_bf16 v[128:131], a[4:7], a[172:175], v[128:131]
    ds_read_b128 a[160:163], v14 offset:8192
    v_accvgpr_write_b32 a147, v31
    v_mfma_f32_16x16x32_bf16 v[132:135], a[12:15], a[172:175], v[132:135]
    v_accvgpr_read_b32 v31, a226
    v_mfma_f32_16x16x32_bf16 v[132:135], a[8:11], a[168:171], v[132:135]
    ds_read_b128 a[164:167], v15 offset:8192
    buffer_load_dwordx4 v4, s[16:19], s49 offen offset:2048 lds
    v_lshlrev_b32 v24, 16, v31
    v_mfma_f32_16x16x32_bf16 v[136:139], a[16:19], a[168:171], v[136:139]
    v_and_b32 v31, 0xffff0000, v31
    v_mfma_f32_16x16x32_bf16 v[136:139], a[20:23], a[172:175], v[136:139]
    v_accvgpr_write_b32 a100, v24
    v_accvgpr_write_b32 a101, v31
    v_mfma_f32_16x16x32_bf16 v[140:143], a[28:31], a[172:175], v[140:143]
    v_accvgpr_write_b32 a116, v24
    v_mfma_f32_16x16x32_bf16 v[140:143], a[24:27], a[168:171], v[140:143]
    v_accvgpr_write_b32 a117, v31
    v_mfma_f32_16x16x32_bf16 v[144:147], a[32:35], a[168:171], v[144:147]
    v_accvgpr_write_b32 a132, v24
    v_mfma_f32_16x16x32_bf16 v[144:147], a[36:39], a[172:175], v[144:147]
    v_accvgpr_write_b32 a133, v31
    v_mfma_f32_16x16x32_bf16 v[148:151], a[44:47], a[172:175], v[148:151]
    v_accvgpr_write_b32 a148, v24
    v_mfma_f32_16x16x32_bf16 v[148:151], a[40:43], a[168:171], v[148:151]
    v_accvgpr_write_b32 a149, v31
    v_mfma_f32_16x16x32_bf16 v[152:155], a[48:51], a[168:171], v[152:155]
    buffer_load_dwordx4 v5, s[16:19], s49 offen offset:3072 lds
    v_accvgpr_read_b32 v31, a227
    v_mfma_f32_16x16x32_bf16 v[152:155], a[52:55], a[172:175], v[152:155]
    v_lshlrev_b32 v24, 16, v31
    v_mfma_f32_16x16x32_bf16 v[156:159], a[60:63], a[172:175], v[156:159]
    v_and_b32 v31, 0xffff0000, v31
    v_mfma_f32_16x16x32_bf16 v[156:159], a[56:59], a[168:171], v[156:159]
    v_accvgpr_write_b32 a102, v24
    s_waitcnt lgkmcnt(0)
    v_mfma_f32_16x16x32_bf16 v[160:163], a[0:3], a[160:163], v[160:163]
    v_accvgpr_write_b32 a103, v31
    v_accvgpr_write_b32 a118, v24
    v_mfma_f32_16x16x32_bf16 v[160:163], a[4:7], a[164:167], v[160:163]
    ds_read_b128 a[168:171], v14 offset:10240
    v_accvgpr_write_b32 a119, v31
    v_mfma_f32_16x16x32_bf16 v[164:167], a[12:15], a[164:167], v[164:167]
    v_accvgpr_write_b32 a134, v24
    v_mfma_f32_16x16x32_bf16 v[164:167], a[8:11], a[160:163], v[164:167]
    ds_read_b128 a[172:175], v15 offset:10240
    v_accvgpr_write_b32 a135, v31
    v_mfma_f32_16x16x32_bf16 v[168:171], a[16:19], a[160:163], v[168:171]
    v_accvgpr_write_b32 a150, v24
    v_mfma_f32_16x16x32_bf16 v[168:171], a[20:23], a[164:167], v[168:171]
    s_add_u32 m0, s33, 98304
    s_add_u32 s49, s49, 262144
    buffer_load_dwordx4 v6, s[20:23], s50 offen lds
    v_accvgpr_write_b32 a151, v31
    v_mfma_f32_16x16x32_bf16 v[172:175], a[28:31], a[164:167], v[172:175]
    v_xor_b32 v16, 0x8000, v16
    v_accvgpr_read_b32 v31, a228
    v_mfma_f32_16x16x32_bf16 v[172:175], a[24:27], a[160:163], v[172:175]
    v_lshlrev_b32 v24, 16, v31
    v_mfma_f32_16x16x32_bf16 v[176:179], a[32:35], a[160:163], v[176:179]
    v_and_b32 v31, 0xffff0000, v31
    v_mfma_f32_16x16x32_bf16 v[176:179], a[36:39], a[164:167], v[176:179]
    v_xor_b32 v17, 0x8000, v17
    v_accvgpr_write_b32 a104, v24
    v_mfma_f32_16x16x32_bf16 v[180:183], a[44:47], a[164:167], v[180:183]
    v_accvgpr_write_b32 a105, v31
    v_mfma_f32_16x16x32_bf16 v[180:183], a[40:43], a[160:163], v[180:183]
    v_accvgpr_write_b32 a120, v24
    v_mfma_f32_16x16x32_bf16 v[184:187], a[48:51], a[160:163], v[184:187]
    v_xor_b32 v18, 0x8000, v18
    v_accvgpr_write_b32 a121, v31
    v_accvgpr_write_b32 a136, v24
    v_mfma_f32_16x16x32_bf16 v[184:187], a[52:55], a[164:167], v[184:187]
    buffer_load_dwordx4 v7, s[20:23], s50 offen offset:1024 lds
    v_accvgpr_write_b32 a137, v31
    v_mfma_f32_16x16x32_bf16 v[188:191], a[60:63], a[164:167], v[188:191]
    v_accvgpr_write_b32 a152, v24
    v_mfma_f32_16x16x32_bf16 v[188:191], a[56:59], a[160:163], v[188:191]
    v_xor_b32 v19, 0x8000, v19
    v_accvgpr_write_b32 a153, v31
    s_waitcnt lgkmcnt(0)
    v_mfma_f32_16x16x32_bf16 v[192:195], a[0:3], a[168:171], v[192:195]
    v_accvgpr_read_b32 v31, a229
    v_mfma_f32_16x16x32_bf16 v[192:195], a[4:7], a[172:175], v[192:195]
    ds_read_b128 a[160:163], v14 offset:12288
    v_lshlrev_b32 v24, 16, v31
    v_mfma_f32_16x16x32_bf16 v[196:199], a[12:15], a[172:175], v[196:199]
    v_xor_b32 v20, 0x8000, v20
    v_and_b32 v31, 0xffff0000, v31
    v_mfma_f32_16x16x32_bf16 v[196:199], a[8:11], a[168:171], v[196:199]
    ds_read_b128 a[164:167], v15 offset:12288
    v_accvgpr_write_b32 a106, v24
    v_mfma_f32_16x16x32_bf16 v[200:203], a[16:19], a[168:171], v[200:203]
    v_accvgpr_write_b32 a107, v31
    v_mfma_f32_16x16x32_bf16 v[200:203], a[20:23], a[172:175], v[200:203]
    v_xor_b32 v21, 0x8000, v21
    v_accvgpr_write_b32 a122, v24
    v_mfma_f32_16x16x32_bf16 v[204:207], a[28:31], a[172:175], v[204:207]
    s_add_u32 m0, m0, 8192
    s_add_u32 s50, s50, 114688
    buffer_load_dwordx4 v27, s[4:7], s51 offen sc1 lds
    v_accvgpr_write_b32 a123, v31
    v_mfma_f32_16x16x32_bf16 v[204:207], a[24:27], a[168:171], v[204:207]
    v_accvgpr_write_b32 a138, v24
    v_accvgpr_write_b32 a139, v31
    v_mfma_f32_16x16x32_bf16 v[208:211], a[32:35], a[168:171], v[208:211]
    v_xor_b32 v22, 0x8000, v22
    v_accvgpr_write_b32 a154, v24
    v_mfma_f32_16x16x32_bf16 v[208:211], a[36:39], a[172:175], v[208:211]
    v_accvgpr_write_b32 a155, v31
    v_mfma_f32_16x16x32_bf16 v[212:215], a[44:47], a[172:175], v[212:215]
    v_accvgpr_read_b32 v31, a230
    v_mfma_f32_16x16x32_bf16 v[212:215], a[40:43], a[168:171], v[212:215]
    v_xor_b32 v23, 0x8000, v23
    v_lshlrev_b32 v24, 16, v31
    v_mfma_f32_16x16x32_bf16 v[216:219], a[48:51], a[168:171], v[216:219]
    v_and_b32 v31, 0xffff0000, v31
    v_mfma_f32_16x16x32_bf16 v[216:219], a[52:55], a[172:175], v[216:219]
    v_accvgpr_write_b32 a108, v24
    v_mfma_f32_16x16x32_bf16 v[220:223], a[60:63], a[172:175], v[220:223]
    v_accvgpr_write_b32 a109, v31
    v_mfma_f32_16x16x32_bf16 v[220:223], a[56:59], a[168:171], v[220:223]
    buffer_load_dwordx4 v27, s[4:7], s51 offen offset:1024 sc1 lds
    s_add_u32 s51, s51, 2048
    s_cmp_eq_u32 s49, 3670016
    s_cselect_b32 s49, 0, s49
    s_cselect_b32 s50, s61, s50
    s_cselect_b32 s51, s62, s51
    v_accvgpr_write_b32 a124, v24
    s_waitcnt lgkmcnt(0)
    v_mfma_f32_16x16x32_bf16 v[224:227], a[0:3], a[160:163], v[224:227]
    v_accvgpr_write_b32 a125, v31
    v_mfma_f32_16x16x32_bf16 v[224:227], a[4:7], a[164:167], v[224:227]
    ds_read_b128 a[168:171], v14 offset:14336
    v_accvgpr_write_b32 a140, v24
    v_mfma_f32_16x16x32_bf16 v[228:231], a[12:15], a[164:167], v[228:231]
    v_accvgpr_write_b32 a141, v31
    v_mfma_f32_16x16x32_bf16 v[228:231], a[8:11], a[160:163], v[228:231]
    ds_read_b128 a[172:175], v15 offset:14336
    v_accvgpr_write_b32 a156, v24
    v_accvgpr_write_b32 a157, v31
    v_mfma_f32_16x16x32_bf16 v[232:235], a[16:19], a[160:163], v[232:235]
    v_accvgpr_read_b32 v31, a231
    v_mfma_f32_16x16x32_bf16 v[232:235], a[20:23], a[164:167], v[232:235]
    v_add_u32 v14, s58, v14
    v_lshlrev_b32 v24, 16, v31
    v_mfma_f32_16x16x32_bf16 v[236:239], a[28:31], a[164:167], v[236:239]
    v_and_b32 v31, 0xffff0000, v31
    v_mfma_f32_16x16x32_bf16 v[236:239], a[24:27], a[160:163], v[236:239]
    v_add_u32 v15, s58, v15
    v_accvgpr_write_b32 a110, v24
    v_mfma_f32_16x16x32_bf16 v[240:243], a[32:35], a[160:163], v[240:243]
    v_accvgpr_write_b32 a111, v31
    v_mfma_f32_16x16x32_bf16 v[240:243], a[36:39], a[164:167], v[240:243]
    v_accvgpr_write_b32 a126, v24
    v_mfma_f32_16x16x32_bf16 v[244:247], a[44:47], a[164:167], v[244:247]
    s_add_u32 s59, s55, s57
    s_add_u32 s57, s57, s58
    v_accvgpr_write_b32 a127, v31
    v_mfma_f32_16x16x32_bf16 v[244:247], a[40:43], a[160:163], v[244:247]
    v_accvgpr_write_b32 a142, v24
    v_mfma_f32_16x16x32_bf16 v[248:251], a[48:51], a[160:163], v[248:251]
    s_cmp_eq_u32 s57, 65536
    s_cselect_b32 s58, s34, s35
    v_accvgpr_write_b32 a143, v31
    v_mfma_f32_16x16x32_bf16 v[248:251], a[52:55], a[164:167], v[248:251]
    v_accvgpr_write_b32 a158, v24
    v_mfma_f32_16x16x32_bf16 v[252:255], a[60:63], a[164:167], v[252:255]
    v_accvgpr_write_b32 a159, v31
    v_mfma_f32_16x16x32_bf16 v[252:255], a[56:59], a[160:163], v[252:255]
    v_readfirstlane_b32 s48, v25
    s_waitcnt lgkmcnt(0)
    s_waitcnt vmcnt(8)
    s_barrier
    v_mfma_f32_16x16x32_bf16 a[64:67], a[0:3], a[168:171], a[64:67]
    ds_read_b128 a[160:163], v14 offset:0
    ds_read_b128 a[164:167], v15 offset:0
    v_mfma_f32_16x16x32_bf16 a[64:67], a[4:7], a[172:175], a[64:67]
    ds_read_b64_tr_b16 a[0:1], v16 offset:0
    ds_read_b64_tr_b16 a[2:3], v16 offset:2048
    v_mfma_f32_16x16x32_bf16 a[68:71], a[12:15], a[172:175], a[68:71]
    ds_read_b64_tr_b16 a[4:5], v16 offset:16384
    ds_read_b64_tr_b16 a[6:7], v16 offset:18432
    v_mfma_f32_16x16x32_bf16 a[68:71], a[8:11], a[168:171], a[68:71]
    ds_read_b64_tr_b16 a[8:9], v17 offset:0
    ds_read_b64_tr_b16 a[10:11], v17 offset:2048
    v_mfma_f32_16x16x32_bf16 a[72:75], a[16:19], a[168:171], a[72:75]
    ds_read_b64_tr_b16 a[12:13], v17 offset:16384
    ds_read_b64_tr_b16 a[14:15], v17 offset:18432
    v_mfma_f32_16x16x32_bf16 a[72:75], a[20:23], a[172:175], a[72:75]
    ds_read_b64_tr_b16 a[16:17], v18 offset:0
    ds_read_b64_tr_b16 a[18:19], v18 offset:2048
    v_mfma_f32_16x16x32_bf16 a[76:79], a[28:31], a[172:175], a[76:79]
    ds_read_b64_tr_b16 a[20:21], v18 offset:16384
    ds_read_b64_tr_b16 a[22:23], v18 offset:18432
    v_mfma_f32_16x16x32_bf16 a[76:79], a[24:27], a[168:171], a[76:79]
    ds_read_b64_tr_b16 a[24:25], v19 offset:0
    ds_read_b64_tr_b16 a[26:27], v19 offset:2048
    v_mfma_f32_16x16x32_bf16 a[80:83], a[32:35], a[168:171], a[80:83]
    ds_read_b64_tr_b16 a[28:29], v19 offset:16384
    ds_read_b64_tr_b16 a[30:31], v19 offset:18432
    v_mfma_f32_16x16x32_bf16 a[80:83], a[36:39], a[172:175], a[80:83]
    ds_read_b64_tr_b16 a[32:33], v20 offset:0
    ds_read_b64_tr_b16 a[34:35], v20 offset:2048
    v_mfma_f32_16x16x32_bf16 a[84:87], a[44:47], a[172:175], a[84:87]
    ds_read_b64_tr_b16 a[36:37], v20 offset:16384
    ds_read_b64_tr_b16 a[38:39], v20 offset:18432
    v_mfma_f32_16x16x32_bf16 a[84:87], a[40:43], a[168:171], a[84:87]
    ds_read_b64_tr_b16 a[40:41], v21 offset:0
    ds_read_b64_tr_b16 a[42:43], v21 offset:2048
    v_mfma_f32_16x16x32_bf16 a[88:91], a[48:51], a[168:171], a[88:91]
    ds_read_b64_tr_b16 a[44:45], v21 offset:16384
    ds_read_b64_tr_b16 a[46:47], v21 offset:18432
    v_mfma_f32_16x16x32_bf16 a[88:91], a[52:55], a[172:175], a[88:91]
    ds_read_b64_tr_b16 a[48:49], v22 offset:0
    ds_read_b64_tr_b16 a[50:51], v22 offset:2048
    v_mfma_f32_16x16x32_bf16 a[92:95], a[60:63], a[172:175], a[92:95]
    ds_read_b64_tr_b16 a[52:53], v22 offset:16384
    ds_read_b64_tr_b16 a[54:55], v22 offset:18432
    v_mfma_f32_16x16x32_bf16 a[92:95], a[56:59], a[168:171], a[92:95]
    ds_read_b64_tr_b16 a[56:57], v23 offset:0
    ds_read_b64_tr_b16 a[58:59], v23 offset:2048
    ds_read_b64_tr_b16 a[60:61], v23 offset:16384
    ds_read_b64_tr_b16 a[62:63], v23 offset:18432
    s_waitcnt lgkmcnt(15)
    v_mfma_f32_16x16x32_bf16 v[32:35], a[0:3], a[160:163], v[32:35]
    v_mfma_f32_16x16x32_bf16 v[32:35], a[4:7], a[164:167], v[32:35]
    s_bfe_u32 s41, s48, 0xa0006
    s_mul_i32 s41, s41, s41
    v_mfma_f32_16x16x32_bf16 v[36:39], a[12:15], a[164:167], v[36:39]
    s_lshr_b32 s48, s48, 16
    s_lshl_b32 s48, s48, 5
    v_mfma_f32_16x16x32_bf16 v[36:39], a[8:11], a[160:163], v[36:39]
    s_cmp_lg_u32 s48, s41
    s_cselect_b64 vcc, -1, 0
    v_mfma_f32_16x16x32_bf16 v[40:43], a[16:19], a[160:163], v[40:43]
    s_add_u32 m0, s32, 131072
    s_nop 0
    buffer_load_dwordx4 v2, s[16:19], s49 offen lds
    s_lshl_b32 s40, s25, 8
    s_add_u32 s40, s40, 98304
    v_mfma_f32_16x16x32_bf16 v[40:43], a[20:23], a[164:167], v[40:43]
    v_bfe_u32 v28, v1, 2, 2
    v_mfma_f32_16x16x32_bf16 v[44:47], a[28:31], a[164:167], v[44:47]
    v_lshrrev_b32 v29, 4, v1
    v_lshl_add_u32 v29, v29, 3, v28
    v_mfma_f32_16x16x32_bf16 v[44:47], a[24:27], a[160:163], v[44:47]
    v_lshlrev_b32 v9, 8, v29
    s_waitcnt lgkmcnt(8)
    v_mfma_f32_16x16x32_bf16 v[48:51], a[32:35], a[160:163], v[48:51]
    ds_read_b128 a[168:171], v14 offset:2048
    v_lshlrev_b32 v29, 9, v29
    v_and_b32 v30, 3, v1
    v_mfma_f32_16x16x32_bf16 v[48:51], a[36:39], a[164:167], v[48:51]
    v_lshl_add_u32 v29, v30, 3, v29
    v_mfma_f32_16x16x32_bf16 v[52:55], a[44:47], a[164:167], v[52:55]
    ds_read_b128 a[172:175], v15 offset:2048
    v_add_u32 v29, s40, v29
    v_bfe_u32 v28, v1, 2, 3
    v_mfma_f32_16x16x32_bf16 v[52:55], a[40:43], a[160:163], v[52:55]
    buffer_load_dwordx4 v3, s[16:19], s49 offen offset:1024 lds
    v_xor_b32 v30, 0, v28
    s_waitcnt lgkmcnt(2)
    v_mfma_f32_16x16x32_bf16 v[56:59], a[48:51], a[160:163], v[56:59]
    v_lshl_add_u32 v16, v30, 5, v29
    v_xor_b32 v30, 1, v28
    v_mfma_f32_16x16x32_bf16 v[56:59], a[52:55], a[164:167], v[56:59]
    v_lshl_add_u32 v17, v30, 5, v29
    v_mfma_f32_16x16x32_bf16 v[60:63], a[60:63], a[164:167], v[60:63]
    v_xor_b32 v30, 2, v28
    v_lshl_add_u32 v18, v30, 5, v29
    v_mfma_f32_16x16x32_bf16 v[60:63], a[56:59], a[160:163], v[60:63]
    v_xor_b32 v30, 3, v28
    s_waitcnt lgkmcnt(0)
    v_mfma_f32_16x16x32_bf16 v[64:67], a[0:3], a[168:171], v[64:67]
    v_lshl_add_u32 v19, v30, 5, v29
    v_xor_b32 v30, 4, v28
    v_mfma_f32_16x16x32_bf16 v[64:67], a[4:7], a[172:175], v[64:67]
    ds_read_b128 a[160:163], v14 offset:4096
    v_lshl_add_u32 v20, v30, 5, v29
    v_mfma_f32_16x16x32_bf16 v[68:71], a[12:15], a[172:175], v[68:71]
    buffer_load_dwordx4 v4, s[16:19], s49 offen offset:2048 lds
    v_xor_b32 v30, 5, v28
    v_mfma_f32_16x16x32_bf16 v[68:71], a[8:11], a[168:171], v[68:71]
    ds_read_b128 a[164:167], v15 offset:4096
    v_lshl_add_u32 v21, v30, 5, v29
    v_xor_b32 v30, 6, v28
    v_mfma_f32_16x16x32_bf16 v[72:75], a[16:19], a[168:171], v[72:75]
    v_lshl_add_u32 v22, v30, 5, v29
    v_mfma_f32_16x16x32_bf16 v[72:75], a[20:23], a[172:175], v[72:75]
    v_xor_b32 v30, 7, v28
    v_lshl_add_u32 v23, v30, 5, v29
    v_mfma_f32_16x16x32_bf16 v[76:79], a[28:31], a[172:175], v[76:79]
    v_sub_u32 v29, v29, v9
    v_mfma_f32_16x16x32_bf16 v[76:79], a[24:27], a[168:171], v[76:79]
    s_lshl_b32 s40, s25, 8
    v_subrev_u32 v29, s40, v29
    v_mfma_f32_16x16x32_bf16 v[80:83], a[32:35], a[168:171], v[80:83]
    v_add_u32 v29, 16384, v29
    v_mfma_f32_16x16x32_bf16 v[80:83], a[36:39], a[172:175], v[80:83]
    buffer_load_dwordx4 v5, s[16:19], s49 offen offset:3072 lds
    s_lshl_b32 s40, s25, 2
    v_xor_b32 v28, s40, v28
    v_mfma_f32_16x16x32_bf16 v[84:87], a[44:47], a[172:175], v[84:87]
    v_xor_b32 v30, 0, v28
    v_mfma_f32_16x16x32_bf16 v[84:87], a[40:43], a[168:171], v[84:87]
    v_lshl_add_u32 v10, v30, 5, v29
    v_xor_b32 v30, 1, v28
    v_mfma_f32_16x16x32_bf16 v[88:91], a[48:51], a[168:171], v[88:91]
    v_lshl_add_u32 v11, v30, 5, v29
    v_mfma_f32_16x16x32_bf16 v[88:91], a[52:55], a[172:175], v[88:91]
    v_xor_b32 v30, 2, v28
    v_lshl_add_u32 v12, v30, 5, v29
    v_mfma_f32_16x16x32_bf16 v[92:95], a[60:63], a[172:175], v[92:95]
    v_xor_b32 v30, 3, v28
    v_mfma_f32_16x16x32_bf16 v[92:95], a[56:59], a[168:171], v[92:95]
    v_lshl_add_u32 v13, v30, 5, v29
    s_lshl_b32 s40, s26, 12
    s_waitcnt lgkmcnt(0)
    v_mfma_f32_16x16x32_bf16 v[96:99], a[0:3], a[160:163], v[96:99]
    s_add_u32 m0, s33, 131072
    s_add_u32 s49, s49, 262144
    buffer_load_dwordx4 v6, s[20:23], s50 offen lds
    s_add_u32 s40, s40, 122880
    v_mfma_f32_16x16x32_bf16 v[96:99], a[4:7], a[164:167], v[96:99]
    ds_read_b128 a[168:171], v14 offset:6144
    v_add_u32 v8, s40, v27
    v_mfma_f32_16x16x32_bf16 v[100:103], a[12:15], a[164:167], v[100:103]
    v_mfma_f32_16x16x32_bf16 v[100:103], a[8:11], a[160:163], v[100:103]
    ds_read_b128 a[172:175], v15 offset:6144
    v_mfma_f32_16x16x32_bf16 v[104:107], a[16:19], a[160:163], v[104:107]
    v_mfma_f32_16x16x32_bf16 v[104:107], a[20:23], a[164:167], v[104:107]
    v_mfma_f32_16x16x32_bf16 v[108:111], a[28:31], a[164:167], v[108:111]
    v_cvt_pk_bf16_f32 v32, v32, v33
    v_cvt_pk_bf16_f32 v33, v34, v35
    v_mfma_f32_16x16x32_bf16 v[108:111], a[24:27], a[160:163], v[108:111]
    buffer_load_dwordx4 v7, s[20:23], s50 offen offset:1024 lds
    v_cvt_pk_bf16_f32 v34, v36, v37
    v_mfma_f32_16x16x32_bf16 v[112:115], a[32:35], a[160:163], v[112:115]
    v_cvt_pk_bf16_f32 v35, v38, v39
    v_mfma_f32_16x16x32_bf16 v[112:115], a[36:39], a[164:167], v[112:115]
    v_cvt_pk_bf16_f32 v40, v40, v41
    v_mfma_f32_16x16x32_bf16 v[116:119], a[44:47], a[164:167], v[116:119]
    v_cvt_pk_bf16_f32 v41, v42, v43
    v_mfma_f32_16x16x32_bf16 v[116:119], a[40:43], a[160:163], v[116:119]
    v_cvt_pk_bf16_f32 v42, v44, v45
    v_mfma_f32_16x16x32_bf16 v[120:123], a[48:51], a[160:163], v[120:123]
    v_cvt_pk_bf16_f32 v43, v46, v47
    s_cbranch_vccnz L_wt0
    buffer_store_dwordx4 v[32:35], v27, s[4:7], s60 offen offset:0
L_wr0:
    v_mfma_f32_16x16x32_bf16 v[120:123], a[52:55], a[164:167], v[120:123]
    v_cvt_pk_bf16_f32 v48, v48, v49
    v_cvt_pk_bf16_f32 v49, v50, v51
    v_mfma_f32_16x16x32_bf16 v[124:127], a[60:63], a[164:167], v[124:127]
    s_add_u32 m0, m0, 8192
    s_add_u32 s50, s50, 114688
    buffer_load_dwordx4 v27, s[4:7], s51 offen sc1 lds
    v_cvt_pk_bf16_f32 v50, v52, v53
    v_mfma_f32_16x16x32_bf16 v[124:127], a[56:59], a[160:163], v[124:127]
    v_cvt_pk_bf16_f32 v51, v54, v55
    s_waitcnt lgkmcnt(0)
    v_mfma_f32_16x16x32_bf16 v[128:131], a[0:3], a[168:171], v[128:131]
    v_cvt_pk_bf16_f32 v56, v56, v57
    s_cbranch_vccnz L_wt1
    buffer_store_dwordx4 v[40:43], v27, s[4:7], s60 offen offset:1024
L_wr1:
    v_mfma_f32_16x16x32_bf16 v[128:131], a[4:7], a[172:175], v[128:131]
    ds_read_b128 a[160:163], v14 offset:8192
    v_cvt_pk_bf16_f32 v57, v58, v59
    v_mfma_f32_16x16x32_bf16 v[132:135], a[12:15], a[172:175], v[132:135]
    v_cvt_pk_bf16_f32 v58, v60, v61
    v_mfma_f32_16x16x32_bf16 v[132:135], a[8:11], a[168:171], v[132:135]
    ds_read_b128 a[164:167], v15 offset:8192
    v_cvt_pk_bf16_f32 v59, v62, v63
    v_mfma_f32_16x16x32_bf16 v[136:139], a[16:19], a[168:171], v[136:139]
    v_cvt_pk_bf16_f32 v64, v64, v65
    v_cvt_pk_bf16_f32 v65, v66, v67
    s_cbranch_vccnz L_wt2
    buffer_store_dwordx4 v[48:51], v27, s[4:7], s60 offen offset:2048
L_wr2:
    v_mfma_f32_16x16x32_bf16 v[136:139], a[20:23], a[172:175], v[136:139]
    buffer_load_dwordx4 v27, s[4:7], s51 offen offset:1024 sc1 lds
    s_add_u32 s51, s51, 2048
    s_cmp_eq_u32 s49, 3670016
    s_cselect_b32 s49, 0, s49
    s_cselect_b32 s50, s61, s50
    s_cselect_b32 s51, s62, s51
    v_cvt_pk_bf16_f32 v66, v68, v69
    v_mfma_f32_16x16x32_bf16 v[140:143], a[28:31], a[172:175], v[140:143]
    v_cvt_pk_bf16_f32 v67, v70, v71
    v_mfma_f32_16x16x32_bf16 v[140:143], a[24:27], a[168:171], v[140:143]
    v_cvt_pk_bf16_f32 v72, v72, v73
    v_mfma_f32_16x16x32_bf16 v[144:147], a[32:35], a[168:171], v[144:147]
    v_cvt_pk_bf16_f32 v73, v74, v75
    s_cbranch_vccnz L_wt3
    buffer_store_dwordx4 v[56:59], v27, s[4:7], s60 offen offset:3072
L_wr3:
    s_add_u32 s60, s60, s96
    v_mfma_f32_16x16x32_bf16 v[144:147], a[36:39], a[172:175], v[144:147]
    v_cvt_pk_bf16_f32 v74, v76, v77
    v_mfma_f32_16x16x32_bf16 v[148:151], a[44:47], a[172:175], v[148:151]
    v_cvt_pk_bf16_f32 v75, v78, v79
    v_mfma_f32_16x16x32_bf16 v[148:151], a[40:43], a[168:171], v[148:151]
    v_cvt_pk_bf16_f32 v80, v80, v81
    v_cvt_pk_bf16_f32 v81, v82, v83
    v_mfma_f32_16x16x32_bf16 v[152:155], a[48:51], a[168:171], v[152:155]
    s_add_u32 m0, s32, 0
    s_nop 0
    buffer_load_dwordx4 v2, s[16:19], s49 offen lds
    v_cvt_pk_bf16_f32 v82, v84, v85
    s_cbranch_vccnz L_wt4
    buffer_store_dwordx4 v[64:67], v27, s[4:7], s60 offen offset:0
L_wr4:
    v_mfma_f32_16x16x32_bf16 v[152:155], a[52:55], a[172:175], v[152:155]
    v_cvt_pk_bf16_f32 v83, v86, v87
    v_mfma_f32_16x16x32_bf16 v[156:159], a[60:63], a[172:175], v[156:159]
    v_cvt_pk_bf16_f32 v88, v88, v89
    v_mfma_f32_16x16x32_bf16 v[156:159], a[56:59], a[168:171], v[156:159]
    v_cvt_pk_bf16_f32 v89, v90, v91
    s_waitcnt lgkmcnt(0)
    v_mfma_f32_16x16x32_bf16 v[160:163], a[0:3], a[160:163], v[160:163]
    v_cvt_pk_bf16_f32 v90, v92, v93
    s_cbranch_vccnz L_wt5
    buffer_store_dwordx4 v[72:75], v27, s[4:7], s60 offen offset:1024
L_wr5:
    v_mfma_f32_16x16x32_bf16 v[160:163], a[4:7], a[164:167], v[160:163]
    ds_read_b128 a[168:171], v14 offset:10240
    v_cvt_pk_bf16_f32 v91, v94, v95
    v_mfma_f32_16x16x32_bf16 v[164:167], a[12:15], a[164:167], v[164:167]
    v_mfma_f32_16x16x32_bf16 v[164:167], a[8:11], a[160:163], v[164:167]
    ds_read_b128 a[172:175], v15 offset:10240
    buffer_load_dwordx4 v3, s[16:19], s49 offen offset:1024 lds
    v_mfma_f32_16x16x32_bf16 v[168:171], a[16:19], a[160:163], v[168:171]
    v_mfma_f32_16x16x32_bf16 v[168:171], a[20:23], a[164:167], v[168:171]
    s_cbranch_vccnz L_wt6
    buffer_store_dwordx4 v[80:83], v27, s[4:7], s60 offen offset:2048
L_wr6:
    v_mfma_f32_16x16x32_bf16 v[172:175], a[28:31], a[164:167], v[172:175]
    v_cvt_pk_bf16_f32 v96, v96, v97
    v_cvt_pk_bf16_f32 v97, v98, v99
    v_mfma_f32_16x16x32_bf16 v[172:175], a[24:27], a[160:163], v[172:175]
    v_cvt_pk_bf16_f32 v98, v100, v101
    v_mfma_f32_16x16x32_bf16 v[176:179], a[32:35], a[160:163], v[176:179]
    v_cvt_pk_bf16_f32 v99, v102, v103
    v_mfma_f32_16x16x32_bf16 v[176:179], a[36:39], a[164:167], v[176:179]
    v_cvt_pk_bf16_f32 v104, v104, v105
    s_cbranch_vccnz L_wt7
    buffer_store_dwordx4 v[88:91], v27, s[4:7], s60 offen offset:3072
L_wr7:
    s_add_u32 s60, s60, s36
    v_mfma_f32_16x16x32_bf16 v[180:183], a[44:47], a[164:167], v[180:183]
    buffer_load_dwordx4 v4, s[16:19], s49 offen offset:2048 lds
    v_cvt_pk_bf16_f32 v105, v106, v107
    v_mfma_f32_16x16x32_bf16 v[180:183], a[40:43], a[160:163], v[180:183]
    v_cvt_pk_bf16_f32 v106, v108, v109
    v_mfma_f32_16x16x32_bf16 v[184:187], a[48:51], a[160:163], v[184:187]
    v_cvt_pk_bf16_f32 v107, v110, v111
    v_mfma_f32_16x16x32_bf16 v[184:187], a[52:55], a[164:167], v[184:187]
    v_cvt_pk_bf16_f32 v112, v112, v113
    v_cvt_pk_bf16_f32 v113, v114, v115
    s_cbranch_vccnz L_wt8
    buffer_store_dwordx4 v[96:99], v27, s[4:7], s60 offen offset:0
L_wr8:
    v_mfma_f32_16x16x32_bf16 v[188:191], a[60:63], a[164:167], v[188:191]
    v_cvt_pk_bf16_f32 v114, v116, v117
    v_mfma_f32_16x16x32_bf16 v[188:191], a[56:59], a[160:163], v[188:191]
    v_cvt_pk_bf16_f32 v115, v118, v119
    s_waitcnt lgkmcnt(0)
    v_mfma_f32_16x16x32_bf16 v[192:195], a[0:3], a[168:171], v[192:195]
    v_cvt_pk_bf16_f32 v120, v120, v121
    v_mfma_f32_16x16x32_bf16 v[192:195], a[4:7], a[172:175], v[192:195]
    ds_read_b128 a[160:163], v14 offset:12288
    buffer_load_dwordx4 v5, s[16:19], s49 offen offset:3072 lds
    v_cvt_pk_bf16_f32 v121, v122, v123
    v_mfma_f32_16x16x32_bf16 v[196:199], a[12:15], a[172:175], v[196:199]
    v_cvt_pk_bf16_f32 v122, v124, v125
    v_mfma_f32_16x16x32_bf16 v[196:199], a[8:11], a[168:171], v[196:199]
    ds_read_b128 a[164:167], v15 offset:12288
    v_cvt_pk_bf16_f32 v123, v126, v127
    s_cbranch_vccnz L_wt9
    buffer_store_dwordx4 v[104:107], v27, s[4:7], s60 offen offset:1024
L_wr9:
    v_mfma_f32_16x16x32_bf16 v[200:203], a[16:19], a[168:171], v[200:203]
    v_cvt_pk_bf16_f32 v128, v128, v129
    v_cvt_pk_bf16_f32 v129, v130, v131
    v_mfma_f32_16x16x32_bf16 v[200:203], a[20:23], a[172:175], v[200:203]
    v_cvt_pk_bf16_f32 v130, v132, v133
    v_mfma_f32_16x16x32_bf16 v[204:207], a[28:31], a[172:175], v[204:207]
    v_cvt_pk_bf16_f32 v131, v134, v135
    v_mfma_f32_16x16x32_bf16 v[204:207], a[24:27], a[168:171], v[204:207]
    v_cvt_pk_bf16_f32 v136, v136, v137
    v_mfma_f32_16x16x32_bf16 v[208:211], a[32:35], a[168:171], v[208:211]
    s_add_u32 m0, s33, 0
    s_add_u32 s49, s49, 262144
    buffer_load_dwordx4 v6, s[20:23], s50 offen lds
    v_cvt_pk_bf16_f32 v137, v138, v139
    v_mfma_f32_16x16x32_bf16 v[208:211], a[36:39], a[172:175], v[208:211]
    v_cvt_pk_bf16_f32 v138, v140, v141
    s_cbranch_vccnz L_wt10
    buffer_store_dwordx4 v[112:115], v27, s[4:7], s60 offen offset:2048
L_wr10:
    v_mfma_f32_16x16x32_bf16 v[212:215], a[44:47], a[172:175], v[212:215]
    v_cvt_pk_bf16_f32 v139, v142, v143
    v_mfma_f32_16x16x32_bf16 v[212:215], a[40:43], a[168:171], v[212:215]
    v_cvt_pk_bf16_f32 v144, v144, v145
    v_cvt_pk_bf16_f32 v145, v146, v147
    v_mfma_f32_16x16x32_bf16 v[216:219], a[48:51], a[168:171], v[216:219]
    v_cvt_pk_bf16_f32 v146, v148, v149
    v_mfma_f32_16x16x32_bf16 v[216:219], a[52:55], a[172:175], v[216:219]
    v_cvt_pk_bf16_f32 v147, v150, v151
    v_mfma_f32_16x16x32_bf16 v[220:223], a[60:63], a[172:175], v[220:223]
    v_cvt_pk_bf16_f32 v152, v152, v153
    v_mfma_f32_16x16x32_bf16 v[220:223], a[56:59], a[168:171], v[220:223]
    buffer_load_dwordx4 v7, s[20:23], s50 offen offset:1024 lds
    v_cvt_pk_bf16_f32 v153, v154, v155
    s_cbranch_vccnz L_wt11
    buffer_store_dwordx4 v[120:123], v27, s[4:7], s60 offen offset:3072
L_wr11:
    s_add_u32 s60, s60, s96
    s_waitcnt lgkmcnt(0)
    v_mfma_f32_16x16x32_bf16 v[224:227], a[0:3], a[160:163], v[224:227]
    v_cvt_pk_bf16_f32 v154, v156, v157
    v_mfma_f32_16x16x32_bf16 v[224:227], a[4:7], a[164:167], v[224:227]
    ds_read_b128 a[168:171], v14 offset:14336
    v_cvt_pk_bf16_f32 v155, v158, v159
    v_mfma_f32_16x16x32_bf16 v[228:231], a[12:15], a[164:167], v[228:231]
    v_mfma_f32_16x16x32_bf16 v[228:231], a[8:11], a[160:163], v[228:231]
    ds_read_b128 a[172:175], v15 offset:14336
    v_mfma_f32_16x16x32_bf16 v[232:235], a[16:19], a[160:163], v[232:235]
    v_mfma_f32_16x16x32_bf16 v[232:235], a[20:23], a[164:167], v[232:235]
    s_cbranch_vccnz L_wt12
    buffer_store_dwordx4 v[128:131], v27, s[4:7], s60 offen offset:0
L_wr12:
    v_mfma_f32_16x16x32_bf16 v[236:239], a[28:31], a[164:167], v[236:239]
    s_add_u32 m0, m0, 8192
    s_add_u32 s50, s50, 114688
    buffer_load_dwordx4 v27, s[4:7], s51 offen sc1 lds
    v_cvt_pk_bf16_f32 v160, v160, v161
    v_cvt_pk_bf16_f32 v161, v162, v163
    v_mfma_f32_16x16x32_bf16 v[236:239], a[24:27], a[160:163], v[236:239]
    v_cvt_pk_bf16_f32 v162, v164, v165
    v_mfma_f32_16x16x32_bf16 v[240:243], a[32:35], a[160:163], v[240:243]
    v_cvt_pk_bf16_f32 v163, v166, v167
    v_mfma_f32_16x16x32_bf16 v[240:243], a[36:39], a[164:167], v[240:243]
    v_cvt_pk_bf16_f32 v168, v168, v169
    v_mfma_f32_16x16x32_bf16 v[244:247], a[44:47], a[164:167], v[244:247]
    v_cvt_pk_bf16_f32 v169, v170, v171
    v_cvt_pk_bf16_f32 v170, v172, v173
    v_mfma_f32_16x16x32_bf16 v[244:247], a[40:43], a[160:163], v[244:247]
    v_cvt_pk_bf16_f32 v171, v174, v175
    s_cbranch_vccnz L_wt13
    buffer_store_dwordx4 v[136:139], v27, s[4:7], s60 offen offset:1024
L_wr13:
    v_mfma_f32_16x16x32_bf16 v[248:251], a[48:51], a[160:163], v[248:251]
    v_cvt_pk_bf16_f32 v176, v176, v177
    v_mfma_f32_16x16x32_bf16 v[248:251], a[52:55], a[164:167], v[248:251]
    buffer_load_dwordx4 v27, s[4:7], s51 offen offset:1024 sc1 lds
    s_add_u32 s51, s51, 2048
    s_cmp_eq_u32 s49, 3670016
    s_cselect_b32 s49, 0, s49
    s_cselect_b32 s50, s61, s50
    s_cselect_b32 s51, s62, s51
    v_cvt_pk_bf16_f32 v177, v178, v179
    v_mfma_f32_16x16x32_bf16 v[252:255], a[60:63], a[164:167], v[252:255]
    v_cvt_pk_bf16_f32 v178, v180, v181
    v_cvt_pk_bf16_f32 v179, v182, v183
    v_mfma_f32_16x16x32_bf16 v[252:255], a[56:59], a[160:163], v[252:255]
    v_cvt_pk_bf16_f32 v184, v184, v185
    s_waitcnt lgkmcnt(0)
    v_mfma_f32_16x16x32_bf16 a[64:67], a[0:3], a[168:171], a[64:67]
    v_cvt_pk_bf16_f32 v185, v186, v187
    v_mfma_f32_16x16x32_bf16 a[64:67], a[4:7], a[172:175], a[64:67]
    v_cvt_pk_bf16_f32 v186, v188, v189
    s_cbranch_vccnz L_wt14
    buffer_store_dwordx4 v[144:147], v27, s[4:7], s60 offen offset:2048
L_wr14:
    v_mfma_f32_16x16x32_bf16 a[68:71], a[12:15], a[172:175], a[68:71]
    v_cvt_pk_bf16_f32 v187, v190, v191
    v_mfma_f32_16x16x32_bf16 a[68:71], a[8:11], a[168:171], a[68:71]
    v_cvt_pk_bf16_f32 v192, v192, v193
    v_cvt_pk_bf16_f32 v193, v194, v195
    v_mfma_f32_16x16x32_bf16 a[72:75], a[16:19], a[168:171], a[72:75]
    v_cvt_pk_bf16_f32 v194, v196, v197
    v_mfma_f32_16x16x32_bf16 a[72:75], a[20:23], a[172:175], a[72:75]
    v_cvt_pk_bf16_f32 v195, v198, v199
    v_mfma_f32_16x16x32_bf16 a[76:79], a[28:31], a[172:175], a[76:79]
    v_cvt_pk_bf16_f32 v200, v200, v201
    v_mfma_f32_16x16x32_bf16 a[76:79], a[24:27], a[168:171], a[76:79]
    v_cvt_pk_bf16_f32 v201, v202, v203
    v_cvt_pk_bf16_f32 v202, v204, v205
    s_cbranch_vccnz L_wt15
    buffer_store_dwordx4 v[152:155], v27, s[4:7], s60 offen offset:3072
L_wr15:
    s_add_u32 s60, s60, s36
    v_mfma_f32_16x16x32_bf16 a[80:83], a[32:35], a[168:171], a[80:83]
    v_cvt_pk_bf16_f32 v203, v206, v207
    v_mfma_f32_16x16x32_bf16 a[80:83], a[36:39], a[172:175], a[80:83]
    v_cvt_pk_bf16_f32 v208, v208, v209
    v_mfma_f32_16x16x32_bf16 a[84:87], a[44:47], a[172:175], a[84:87]
    v_cvt_pk_bf16_f32 v209, v210, v211
    v_mfma_f32_16x16x32_bf16 a[84:87], a[40:43], a[168:171], a[84:87]
    v_cvt_pk_bf16_f32 v210, v212, v213
    v_cvt_pk_bf16_f32 v211, v214, v215
    v_mfma_f32_16x16x32_bf16 a[88:91], a[48:51], a[168:171], a[88:91]
    v_cvt_pk_bf16_f32 v216, v216, v217
    v_mfma_f32_16x16x32_bf16 a[88:91], a[52:55], a[172:175], a[88:91]
    v_cvt_pk_bf16_f32 v217, v218, v219
    v_mfma_f32_16x16x32_bf16 a[92:95], a[60:63], a[172:175], a[92:95]
    v_cvt_pk_bf16_f32 v218, v220, v221
    v_mfma_f32_16x16x32_bf16 a[92:95], a[56:59], a[168:171], a[92:95]
    v_cvt_pk_bf16_f32 v219, v222, v223
    s_branch L_gdone
L_gV:
    s_waitcnt lgkmcnt(15)
    v_mfma_f32_16x16x32_bf16 v[32:35], a[160:163], a[0:3], 0
    v_mfma_f32_16x16x32_bf16 v[32:35], a[164:167], a[4:7], v[32:35]
    v_mfma_f32_16x16x32_bf16 v[40:43], a[164:167], a[12:15], 0
    v_mfma_f32_16x16x32_bf16 v[40:43], a[160:163], a[8:11], v[40:43]
    v_mfma_f32_16x16x32_bf16 v[48:51], a[160:163], a[16:19], 0
    v_mfma_f32_16x16x32_bf16 v[48:51], a[164:167], a[20:23], v[48:51]
    s_mov_b32 m0, s59
    s_nop 0
    buffer_load_dwordx4 v2, s[8:11], s53 offen offset:0 lds
    v_mfma_f32_16x16x32_bf16 v[56:59], a[164:167], a[28:31], 0
    v_mfma_f32_16x16x32_bf16 v[56:59], a[160:163], a[24:27], v[56:59]
    s_waitcnt lgkmcnt(8)
    v_mfma_f32_16x16x32_bf16 v[64:67], a[160:163], a[32:35], 0
    ds_read_b128 a[168:171], v14 offset:2048
    v_mfma_f32_16x16x32_bf16 v[64:67], a[164:167], a[36:39], v[64:67]
    v_mfma_f32_16x16x32_bf16 v[72:75], a[164:167], a[44:47], 0
    ds_read_b128 a[172:175], v15 offset:2048
    v_mfma_f32_16x16x32_bf16 v[72:75], a[160:163], a[40:43], v[72:75]
    buffer_load_dwordx4 v3, s[8:11], s53 offen offset:1024 lds
    s_waitcnt lgkmcnt(2)
    v_mfma_f32_16x16x32_bf16 v[80:83], a[160:163], a[48:51], 0
    v_mfma_f32_16x16x32_bf16 v[80:83], a[164:167], a[52:55], v[80:83]
    v_mfma_f32_16x16x32_bf16 v[88:91], a[164:167], a[60:63], 0
    v_mfma_f32_16x16x32_bf16 v[88:91], a[160:163], a[56:59], v[88:91]
    s_waitcnt lgkmcnt(0)
    s_barrier
    v_mfma_f32_16x16x32_bf16 v[36:39], a[168:171], a[0:3], 0
    v_mfma_f32_16x16x32_bf16 v[36:39], a[172:175], a[4:7], v[36:39]
    ds_read_b128 a[160:163], v14 offset:4096
    buffer_load_dwordx4 v4, s[8:11], s53 offen offset:2048 lds
    v_mfma_f32_16x16x32_bf16 v[44:47], a[172:175], a[12:15], 0
    v_mfma_f32_16x16x32_bf16 v[44:47], a[168:171], a[8:11], v[44:47]
    ds_read_b128 a[164:167], v15 offset:4096
    v_mfma_f32_16x16x32_bf16 v[52:55], a[168:171], a[16:19], 0
    v_mfma_f32_16x16x32_bf16 v[52:55], a[172:175], a[20:23], v[52:55]
    v_mfma_f32_16x16x32_bf16 v[60:63], a[172:175], a[28:31], 0
    v_mfma_f32_16x16x32_bf16 v[60:63], a[168:171], a[24:27], v[60:63]
    buffer_load_dwordx4 v5, s[8:11], s53 offen offset:3072 lds
    v_mfma_f32_16x16x32_bf16 v[68:71], a[168:171], a[32:35], 0
    v_mfma_f32_16x16x32_bf16 v[68:71], a[172:175], a[36:39], v[68:71]
    v_mfma_f32_16x16x32_bf16 v[76:79], a[172:175], a[44:47], 0
    v_mfma_f32_16x16x32_bf16 v[76:79], a[168:171], a[40:43], v[76:79]
    v_mfma_f32_16x16x32_bf16 v[84:87], a[168:171], a[48:51], 0
    v_mfma_f32_16x16x32_bf16 v[84:87], a[172:175], a[52:55], v[84:87]
    v_mfma_f32_16x16x32_bf16 v[92:95], a[172:175], a[60:63], 0
    s_mov_b32 m0, s56
    s_nop 0
    buffer_load_dwordx4 v10, s[12:15], s54 offen lds
    v_mfma_f32_16x16x32_bf16 v[92:95], a[168:171], a[56:59], v[92:95]
    s_waitcnt lgkmcnt(0)
    v_mfma_f32_16x16x32_bf16 v[96:99], a[160:163], a[0:3], 0
    v_mfma_f32_16x16x32_bf16 v[96:99], a[164:167], a[4:7], v[96:99]
    ds_read_b128 a[168:171], v14 offset:6144
    v_mfma_f32_16x16x32_bf16 v[104:107], a[164:167], a[12:15], 0
    v_mfma_f32_16x16x32_bf16 v[104:107], a[160:163], a[8:11], v[104:107]
    ds_read_b128 a[172:175], v15 offset:6144
    v_mfma_f32_16x16x32_bf16 v[112:115], a[160:163], a[16:19], 0
    buffer_load_dwordx4 v11, s[12:15], s54 offen offset:1024 lds
    v_mfma_f32_16x16x32_bf16 v[112:115], a[164:167], a[20:23], v[112:115]
    v_mfma_f32_16x16x32_bf16 v[120:123], a[164:167], a[28:31], 0
    v_mfma_f32_16x16x32_bf16 v[120:123], a[160:163], a[24:27], v[120:123]
    v_mfma_f32_16x16x32_bf16 v[128:131], a[160:163], a[32:35], 0
    v_mfma_f32_16x16x32_bf16 v[128:131], a[164:167], a[36:39], v[128:131]
    v_mfma_f32_16x16x32_bf16 v[136:139], a[164:167], a[44:47], 0
    buffer_load_dwordx4 v12, s[12:15], s54 offen offset:2048 lds
    v_mfma_f32_16x16x32_bf16 v[136:139], a[160:163], a[40:43], v[136:139]
    v_mfma_f32_16x16x32_bf16 v[144:147], a[160:163], a[48:51], 0
    v_mfma_f32_16x16x32_bf16 v[144:147], a[164:167], a[52:55], v[144:147]
    v_mfma_f32_16x16x32_bf16 v[152:155], a[164:167], a[60:63], 0
    v_mfma_f32_16x16x32_bf16 v[152:155], a[160:163], a[56:59], v[152:155]
    s_waitcnt lgkmcnt(0)
    v_mfma_f32_16x16x32_bf16 v[100:103], a[168:171], a[0:3], 0
    buffer_load_dwordx4 v13, s[12:15], s54 offen offset:3072 lds
    s_add_u32 s54, s54, 262144
    v_mfma_f32_16x16x32_bf16 v[100:103], a[172:175], a[4:7], v[100:103]
    ds_read_b128 a[160:163], v14 offset:8192
    v_mfma_f32_16x16x32_bf16 v[108:111], a[172:175], a[12:15], 0
    v_mfma_f32_16x16x32_bf16 v[108:111], a[168:171], a[8:11], v[108:111]
    ds_read_b128 a[164:167], v15 offset:8192
    v_mfma_f32_16x16x32_bf16 v[116:119], a[168:171], a[16:19], 0
    v_mfma_f32_16x16x32_bf16 v[116:119], a[172:175], a[20:23], v[116:119]
    v_mfma_f32_16x16x32_bf16 v[124:127], a[172:175], a[28:31], 0
    v_mfma_f32_16x16x32_bf16 v[124:127], a[168:171], a[24:27], v[124:127]
    s_add_u32 m0, s59, 4096
    s_nop 0
    buffer_load_dwordx4 v6, s[8:11], s53 offen offset:0 lds
    v_mfma_f32_16x16x32_bf16 v[132:135], a[168:171], a[32:35], 0
    v_mfma_f32_16x16x32_bf16 v[132:135], a[172:175], a[36:39], v[132:135]
    v_mfma_f32_16x16x32_bf16 v[140:143], a[172:175], a[44:47], 0
    v_mfma_f32_16x16x32_bf16 v[140:143], a[168:171], a[40:43], v[140:143]
    v_mfma_f32_16x16x32_bf16 v[148:151], a[168:171], a[48:51], 0
    v_mfma_f32_16x16x32_bf16 v[148:151], a[172:175], a[52:55], v[148:151]
    buffer_load_dwordx4 v7, s[8:11], s53 offen offset:1024 lds
    v_mfma_f32_16x16x32_bf16 v[156:159], a[172:175], a[60:63], 0
    v_mfma_f32_16x16x32_bf16 v[156:159], a[168:171], a[56:59], v[156:159]
    s_waitcnt lgkmcnt(0)
    v_mfma_f32_16x16x32_bf16 v[160:163], a[160:163], a[0:3], 0
    v_mfma_f32_16x16x32_bf16 v[160:163], a[164:167], a[4:7], v[160:163]
    ds_read_b128 a[168:171], v14 offset:10240
    v_mfma_f32_16x16x32_bf16 v[168:171], a[164:167], a[12:15], 0
    v_mfma_f32_16x16x32_bf16 v[168:171], a[160:163], a[8:11], v[168:171]
    ds_read_b128 a[172:175], v15 offset:10240
    buffer_load_dwordx4 v8, s[8:11], s53 offen offset:2048 lds
    v_mfma_f32_16x16x32_bf16 v[176:179], a[160:163], a[16:19], 0
    v_mfma_f32_16x16x32_bf16 v[176:179], a[164:167], a[20:23], v[176:179]
    v_mfma_f32_16x16x32_bf16 v[184:187], a[164:167], a[28:31], 0
    v_xor_b32 v16, 0x8000, v16
    v_mfma_f32_16x16x32_bf16 v[184:187], a[160:163], a[24:27], v[184:187]
    v_mfma_f32_16x16x32_bf16 v[192:195], a[160:163], a[32:35], 0
    v_mfma_f32_16x16x32_bf16 v[192:195], a[164:167], a[36:39], v[192:195]
    v_xor_b32 v17, 0x8000, v17
    buffer_load_dwordx4 v9, s[8:11], s53 offen offset:3072 lds
    s_add_u32 s53, s53, 128
    v_mfma_f32_16x16x32_bf16 v[200:203], a[164:167], a[44:47], 0
    v_mfma_f32_16x16x32_bf16 v[200:203], a[160:163], a[40:43], v[200:203]
    v_mfma_f32_16x16x32_bf16 v[208:211], a[160:163], a[48:51], 0
    v_xor_b32 v18, 0x8000, v18
    v_mfma_f32_16x16x32_bf16 v[208:211], a[164:167], a[52:55], v[208:211]
    v_mfma_f32_16x16x32_bf16 v[216:219], a[164:167], a[60:63], 0
    v_mfma_f32_16x16x32_bf16 v[216:219], a[160:163], a[56:59], v[216:219]
    v_xor_b32 v19, 0x8000, v19
    s_waitcnt lgkmcnt(0)
    v_mfma_f32_16x16x32_bf16 v[164:167], a[168:171], a[0:3], 0
    s_add_u32 m0, s56, 16384
    s_nop 0
    buffer_load_dwordx4 v10, s[12:15], s54 offen lds
    v_mfma_f32_16x16x32_bf16 v[164:167], a[172:175], a[4:7], v[164:167]
    ds_read_b128 a[160:163], v14 offset:12288
    v_mfma_f32_16x16x32_bf16 v[172:175], a[172:175], a[12:15], 0
    v_xor_b32 v20, 0x8000, v20
    v_mfma_f32_16x16x32_bf16 v[172:175], a[168:171], a[8:11], v[172:175]
    ds_read_b128 a[164:167], v15 offset:12288
    v_mfma_f32_16x16x32_bf16 v[180:183], a[168:171], a[16:19], 0
    v_mfma_f32_16x16x32_bf16 v[180:183], a[172:175], a[20:23], v[180:183]
    v_xor_b32 v21, 0x8000, v21
    v_mfma_f32_16x16x32_bf16 v[188:191], a[172:175], a[28:31], 0
    buffer_load_dwordx4 v11, s[12:15], s54 offen offset:1024 lds
    v_mfma_f32_16x16x32_bf16 v[188:191], a[168:171], a[24:27], v[188:191]
    v_mfma_f32_16x16x32_bf16 v[196:199], a[168:171], a[32:35], 0
    v_xor_b32 v22, 0x8000, v22
    v_mfma_f32_16x16x32_bf16 v[196:199], a[172:175], a[36:39], v[196:199]
    v_mfma_f32_16x16x32_bf16 v[204:207], a[172:175], a[44:47], 0
    v_mfma_f32_16x16x32_bf16 v[204:207], a[168:171], a[40:43], v[204:207]
    v_xor_b32 v23, 0x8000, v23
    v_mfma_f32_16x16x32_bf16 v[212:215], a[168:171], a[48:51], 0
    buffer_load_dwordx4 v12, s[12:15], s54 offen offset:2048 lds
    v_mfma_f32_16x16x32_bf16 v[212:215], a[172:175], a[52:55], v[212:215]
    v_mfma_f32_16x16x32_bf16 v[220:223], a[172:175], a[60:63], 0
    v_mfma_f32_16x16x32_bf16 v[220:223], a[168:171], a[56:59], v[220:223]
    s_waitcnt lgkmcnt(0)
    v_mfma_f32_16x16x32_bf16 v[224:227], a[160:163], a[0:3], 0
    v_mfma_f32_16x16x32_bf16 v[224:227], a[164:167], a[4:7], v[224:227]
    ds_read_b128 a[168:171], v14 offset:14336
    v_mfma_f32_16x16x32_bf16 v[232:235], a[164:167], a[12:15], 0
    buffer_load_dwordx4 v13, s[12:15], s54 offen offset:3072 lds
    s_add_u32 s54, s54, 262144
    v_mfma_f32_16x16x32_bf16 v[232:235], a[160:163], a[8:11], v[232:235]
    ds_read_b128 a[172:175], v15 offset:14336
    v_mfma_f32_16x16x32_bf16 v[240:243], a[160:163], a[16:19], 0
    v_mfma_f32_16x16x32_bf16 v[240:243], a[164:167], a[20:23], v[240:243]
    v_add_u32 v14, s58, v14
    v_mfma_f32_16x16x32_bf16 v[248:251], a[164:167], a[28:31], 0
    v_mfma_f32_16x16x32_bf16 v[248:251], a[160:163], a[24:27], v[248:251]
    v_add_u32 v15, s58, v15
    v_mfma_f32_16x16x32_bf16 a[64:67], a[160:163], a[32:35], 0
    v_mfma_f32_16x16x32_bf16 a[64:67], a[164:167], a[36:39], a[64:67]
    v_mfma_f32_16x16x32_bf16 a[72:75], a[164:167], a[44:47], 0
    s_add_u32 s59, s55, s57
    s_add_u32 s57, s57, s58
    v_mfma_f32_16x16x32_bf16 a[72:75], a[160:163], a[40:43], a[72:75]
    v_mfma_f32_16x16x32_bf16 a[80:83], a[160:163], a[48:51], 0
    s_cmp_eq_u32 s57, 65536
    s_cselect_b32 s58, s34, s35
    v_mfma_f32_16x16x32_bf16 a[80:83], a[164:167], a[52:55], a[80:83]
    v_mfma_f32_16x16x32_bf16 a[88:91], a[164:167], a[60:63], 0
    s_xor_b32 s56, s56, 0x8000
    s_add_u32 s43, s43, 1
    v_mfma_f32_16x16x32_bf16 a[88:91], a[160:163], a[56:59], a[88:91]
    s_waitcnt lgkmcnt(0)
    s_waitcnt vmcnt(16)
    s_barrier
    v_mfma_f32_16x16x32_bf16 v[228:231], a[168:171], a[0:3], 0
    ds_read_b128 a[160:163], v14 offset:0
    ds_read_b128 a[164:167], v15 offset:0
    v_mfma_f32_16x16x32_bf16 v[228:231], a[172:175], a[4:7], v[228:231]
    ds_read_b64_tr_b16 a[0:1], v16 offset:0
    ds_read_b64_tr_b16 a[2:3], v16 offset:2048
    v_mfma_f32_16x16x32_bf16 v[236:239], a[172:175], a[12:15], 0
    ds_read_b64_tr_b16 a[4:5], v16 offset:16384
    ds_read_b64_tr_b16 a[6:7], v16 offset:18432
    v_mfma_f32_16x16x32_bf16 v[236:239], a[168:171], a[8:11], v[236:239]
    ds_read_b64_tr_b16 a[8:9], v17 offset:0
    ds_read_b64_tr_b16 a[10:11], v17 offset:2048
    v_mfma_f32_16x16x32_bf16 v[244:247], a[168:171], a[16:19], 0
    ds_read_b64_tr_b16 a[12:13], v17 offset:16384
    ds_read_b64_tr_b16 a[14:15], v17 offset:18432
    v_mfma_f32_16x16x32_bf16 v[244:247], a[172:175], a[20:23], v[244:247]
    ds_read_b64_tr_b16 a[16:17], v18 offset:0
    ds_read_b64_tr_b16 a[18:19], v18 offset:2048
    v_mfma_f32_16x16x32_bf16 v[252:255], a[172:175], a[28:31], 0
    ds_read_b64_tr_b16 a[20:21], v18 offset:16384
    ds_read_b64_tr_b16 a[22:23], v18 offset:18432
    v_mfma_f32_16x16x32_bf16 v[252:255], a[168:171], a[24:27], v[252:255]
    ds_read_b64_tr_b16 a[24:25], v19 offset:0
    ds_read_b64_tr_b16 a[26:27], v19 offset:2048
    v_mfma_f32_16x16x32_bf16 a[68:71], a[168:171], a[32:35], 0
    ds_read_b64_tr_b16 a[28:29], v19 offset:16384
    ds_read_b64_tr_b16 a[30:31], v19 offset:18432
    v_mfma_f32_16x16x32_bf16 a[68:71], a[172:175], a[36:39], a[68:71]
    ds_read_b64_tr_b16 a[32:33], v20 offset:0
    ds_read_b64_tr_b16 a[34:35], v20 offset:2048
    v_mfma_f32_16x16x32_bf16 a[76:79], a[172:175], a[44:47], 0
    ds_read_b64_tr_b16 a[36:37], v20 offset:16384
    ds_read_b64_tr_b16 a[38:39], v20 offset:18432
    v_mfma_f32_16x16x32_bf16 a[76:79], a[168:171], a[40:43], a[76:79]
    ds_read_b64_tr_b16 a[40:41], v21 offset:0
    ds_read_b64_tr_b16 a[42:43], v21 offset:2048
    v_mfma_f32_16x16x32_bf16 a[84:87], a[168:171], a[48:51], 0
    ds_read_b64_tr_b16 a[44:45], v21 offset:16384
    ds_read_b64_tr_b16 a[46:47], v21 offset:18432
    v_mfma_f32_16x16x32_bf16 a[84:87], a[172:175], a[52:55], a[84:87]
    ds_read_b64_tr_b16 a[48:49], v22 offset:0
    ds_read_b64_tr_b16 a[50:51], v22 offset:2048
    v_mfma_f32_16x16x32_bf16 a[92:95], a[172:175], a[60:63], 0
    ds_read_b64_tr_b16 a[52:53], v22 offset:16384
    ds_read_b64_tr_b16 a[54:55], v22 offset:18432
    v_mfma_f32_16x16x32_bf16 a[92:95], a[168:171], a[56:59], a[92:95]
    ds_read_b64_tr_b16 a[56:57], v23 offset:0
    ds_read_b64_tr_b16 a[58:59], v23 offset:2048
    ds_read_b64_tr_b16 a[60:61], v23 offset:16384
    ds_read_b64_tr_b16 a[62:63], v23 offset:18432
    s_bitcmp0_b32 s99, s43
.p2align 3
L_loopV:
    s_waitcnt lgkmcnt(15)
    v_mfma_f32_16x16x32_bf16 v[32:35], a[160:163], a[0:3], v[32:35]
    v_mfma_f32_16x16x32_bf16 v[32:35], a[164:167], a[4:7], v[32:35]
    v_mfma_f32_16x16x32_bf16 v[40:43], a[164:167], a[12:15], v[40:43]
    v_mfma_f32_16x16x32_bf16 v[40:43], a[160:163], a[8:11], v[40:43]
    v_mfma_f32_16x16x32_bf16 v[48:51], a[160:163], a[16:19], v[48:51]
    v_mfma_f32_16x16x32_bf16 v[48:51], a[164:167], a[20:23], v[48:51]
    s_mov_b32 m0, s59
    s_nop 0
    buffer_load_dwordx4 v2, s[8:11], s53 offen offset:0 lds
    v_mfma_f32_16x16x32_bf16 v[56:59], a[164:167], a[28:31], v[56:59]
    v_mfma_f32_16x16x32_bf16 v[56:59], a[160:163], a[24:27], v[56:59]
    s_waitcnt lgkmcnt(8)
    v_mfma_f32_16x16x32_bf16 v[64:67], a[160:163], a[32:35], v[64:67]
    ds_read_b128 a[168:171], v14 offset:2048
    v_mfma_f32_16x16x32_bf16 v[64:67], a[164:167], a[36:39], v[64:67]
    v_mfma_f32_16x16x32_bf16 v[72:75], a[164:167], a[44:47], v[72:75]
    ds_read_b128 a[172:175], v15 offset:2048
    v_mfma_f32_16x16x32_bf16 v[72:75], a[160:163], a[40:43], v[72:75]
    buffer_load_dwordx4 v3, s[8:11], s53 offen offset:1024 lds
    s_waitcnt lgkmcnt(2)
    v_mfma_f32_16x16x32_bf16 v[80:83], a[160:163], a[48:51], v[80:83]
    v_mfma_f32_16x16x32_bf16 v[80:83], a[164:167], a[52:55], v[80:83]
    v_mfma_f32_16x16x32_bf16 v[88:91], a[164:167], a[60:63], v[88:91]
    v_mfma_f32_16x16x32_bf16 v[88:91], a[160:163], a[56:59], v[88:91]
    s_waitcnt lgkmcnt(0)
    s_barrier
    v_mfma_f32_16x16x32_bf16 v[36:39], a[168:171], a[0:3], v[36:39]
    v_mfma_f32_16x16x32_bf16 v[36:39], a[172:175], a[4:7], v[36:39]
    ds_read_b128 a[160:163], v14 offset:4096
    buffer_load_dwordx4 v4, s[8:11], s53 offen offset:2048 lds
    v_mfma_f32_16x16x32_bf16 v[44:47], a[172:175], a[12:15], v[44:47]
    v_mfma_f32_16x16x32_bf16 v[44:47], a[168:171], a[8:11], v[44:47]
    ds_read_b128 a[164:167], v15 offset:4096
    v_mfma_f32_16x16x32_bf16 v[52:55], a[168:171], a[16:19], v[52:55]
    v_mfma_f32_16x16x32_bf16 v[52:55], a[172:175], a[20:23], v[52:55]
    v_mfma_f32_16x16x32_bf16 v[60:63], a[172:175], a[28:31], v[60:63]
    v_mfma_f32_16x16x32_bf16 v[60:63], a[168:171], a[24:27], v[60:63]
    buffer_load_dwordx4 v5, s[8:11], s53 offen offset:3072 lds
    v_mfma_f32_16x16x32_bf16 v[68:71], a[168:171], a[32:35], v[68:71]
    v_mfma_f32_16x16x32_bf16 v[68:71], a[172:175], a[36:39], v[68:71]
    v_mfma_f32_16x16x32_bf16 v[76:79], a[172:175], a[44:47], v[76:79]
    v_mfma_f32_16x16x32_bf16 v[76:79], a[168:171], a[40:43], v[76:79]
    v_mfma_f32_16x16x32_bf16 v[84:87], a[168:171], a[48:51], v[84:87]
    v_mfma_f32_16x16x32_bf16 v[84:87], a[172:175], a[52:55], v[84:87]
    v_mfma_f32_16x16x32_bf16 v[92:95], a[172:175], a[60:63], v[92:95]
    s_mov_b32 m0, s56
    s_nop 0
    buffer_load_dwordx4 v10, s[12:15], s54 offen lds
    v_mfma_f32_16x16x32_bf16 v[92:95], a[168:171], a[56:59], v[92:95]
    s_waitcnt lgkmcnt(0)
    v_mfma_f32_16x16x32_bf16 v[96:99], a[160:163], a[0:3], v[96:99]
    v_mfma_f32_16x16x32_bf16 v[96:99], a[164:167], a[4:7], v[96:99]
    ds_read_b128 a[168:171], v14 offset:6144
    v_mfma_f32_16x16x32_bf16 v[104:107], a[164:167], a[12:15], v[104:107]
    v_mfma_f32_16x16x32_bf16 v[104:107], a[160:163], a[8:11], v[104:107]
    ds_read_b128 a[172:175], v15 offset:6144
    v_mfma_f32_16x16x32_bf16 v[112:115], a[160:163], a[16:19], v[112:115]
    buffer_load_dwordx4 v11, s[12:15], s54 offen offset:1024 lds
    v_mfma_f32_16x16x32_bf16 v[112:115], a[164:167], a[20:23], v[112:115]
    v_mfma_f32_16x16x32_bf16 v[120:123], a[164:167], a[28:31], v[120:123]
    v_mfma_f32_16x16x32_bf16 v[120:123], a[160:163], a[24:27], v[120:123]
    v_mfma_f32_16x16x32_bf16 v[128:131], a[160:163], a[32:35], v[128:131]
    v_mfma_f32_16x16x32_bf16 v[128:131], a[164:167], a[36:39], v[128:131]
    v_mfma_f32_16x16x32_bf16 v[136:139], a[164:167], a[44:47], v[136:139]
    buffer_load_dwordx4 v12, s[12:15], s54 offen offset:2048 lds
    v_mfma_f32_16x16x32_bf16 v[136:139], a[160:163], a[40:43], v[136:139]
    v_mfma_f32_16x16x32_bf16 v[144:147], a[160:163], a[48:51], v[144:147]
    v_mfma_f32_16x16x32_bf16 v[144:147], a[164:167], a[52:55], v[144:147]
    v_mfma_f32_16x16x32_bf16 v[152:155], a[164:167], a[60:63], v[152:155]
    v_mfma_f32_16x16x32_bf16 v[152:155], a[160:163], a[56:59], v[152:155]
    s_waitcnt lgkmcnt(0)
    v_mfma_f32_16x16x32_bf16 v[100:103], a[168:171], a[0:3], v[100:103]
    buffer_load_dwordx4 v13, s[12:15], s54 offen offset:3072 lds
    s_add_u32 s54, s54, 262144
    v_mfma_f32_16x16x32_bf16 v[100:103], a[172:175], a[4:7], v[100:103]
    ds_read_b128 a[160:163], v14 offset:8192
    v_mfma_f32_16x16x32_bf16 v[108:111], a[172:175], a[12:15], v[108:111]
    v_mfma_f32_16x16x32_bf16 v[108:111], a[168:171], a[8:11], v[108:111]
    ds_read_b128 a[164:167], v15 offset:8192
    v_mfma_f32_16x16x32_bf16 v[116:119], a[168:171], a[16:19], v[116:119]
    v_mfma_f32_16x16x32_bf16 v[116:119], a[172:175], a[20:23], v[116:119]
    v_mfma_f32_16x16x32_bf16 v[124:127], a[172:175], a[28:31], v[124:127]
    v_mfma_f32_16x16x32_bf16 v[124:127], a[168:171], a[24:27], v[124:127]
    s_add_u32 m0, s59, 4096
    s_nop 0
    buffer_load_dwordx4 v6, s[8:11], s53 offen offset:0 lds
    v_mfma_f32_16x16x32_bf16 v[132:135], a[168:171], a[32:35], v[132:135]
    v_mfma_f32_16x16x32_bf16 v[132:135], a[172:175], a[36:39], v[132:135]
    v_mfma_f32_16x16x32_bf16 v[140:143], a[172:175], a[44:47], v[140:143]
    v_mfma_f32_16x16x32_bf16 v[140:143], a[168:171], a[40:43], v[140:143]
    v_mfma_f32_16x16x32_bf16 v[148:151], a[168:171], a[48:51], v[148:151]
    v_mfma_f32_16x16x32_bf16 v[148:151], a[172:175], a[52:55], v[148:151]
    buffer_load_dwordx4 v7, s[8:11], s53 offen offset:1024 lds
    v_mfma_f32_16x16x32_bf16 v[156:159], a[172:175], a[60:63], v[156:159]
    v_mfma_f32_16x16x32_bf16 v[156:159], a[168:171], a[56:59], v[156:159]
    s_waitcnt lgkmcnt(0)
    v_mfma_f32_16x16x32_bf16 v[160:163], a[160:163], a[0:3], v[160:163]
    v_mfma_f32_16x16x32_bf16 v[160:163], a[164:167], a[4:7], v[160:163]
    ds_read_b128 a[168:171], v14 offset:10240
    v_mfma_f32_16x16x32_bf16 v[168:171], a[164:167], a[12:15], v[168:171]
    v_mfma_f32_16x16x32_bf16 v[168:171], a[160:163], a[8:11], v[168:171]
    ds_read_b128 a[172:175], v15 offset:10240
    buffer_load_dwordx4 v8, s[8:11], s53 offen offset:2048 lds
    v_mfma_f32_16x16x32_bf16 v[176:179], a[160:163], a[16:19], v[176:179]
    v_mfma_f32_16x16x32_bf16 v[176:179], a[164:167], a[20:23], v[176:179]
    v_mfma_f32_16x16x32_bf16 v[184:187], a[164:167], a[28:31], v[184:187]
    v_xor_b32 v16, 0x8000, v16
    v_mfma_f32_16x16x32_bf16 v[184:187], a[160:163], a[24:27], v[184:187]
    v_mfma_f32_16x16x32_bf16 v[192:195], a[160:163], a[32:35], v[192:195]
    v_mfma_f32_16x16x32_bf16 v[192:195], a[164:167], a[36:39], v[192:195]
    v_xor_b32 v17, 0x8000, v17
    buffer_load_dwordx4 v9, s[8:11], s53 offen offset:3072 lds
    s_add_u32 s53, s53, 128
    v_mfma_f32_16x16x32_bf16 v[200:203], a[164:167], a[44:47], v[200:203]
    v_mfma_f32_16x16x32_bf16 v[200:203], a[160:163], a[40:43], v[200:203]
    v_mfma_f32_16x16x32_bf16 v[208:211], a[160:163], a[48:51], v[208:211]
    v_xor_b32 v18, 0x8000, v18
    v_mfma_f32_16x16x32_bf16 v[208:211], a[164:167], a[52:55], v[208:211]
    v_mfma_f32_16x16x32_bf16 v[216:219], a[164:167], a[60:63], v[216:219]
    v_mfma_f32_16x16x32_bf16 v[216:219], a[160:163], a[56:59], v[216:219]
    v_xor_b32 v19, 0x8000, v19
    s_waitcnt lgkmcnt(0)
    v_mfma_f32_16x16x32_bf16 v[164:167], a[168:171], a[0:3], v[164:167]
    s_add_u32 m0, s56, 16384
    s_nop 0
    buffer_load_dwordx4 v10, s[12:15], s54 offen lds
    v_mfma_f32_16x16x32_bf16 v[164:167], a[172:175], a[4:7], v[164:167]
    ds_read_b128 a[160:163], v14 offset:12288
    v_mfma_f32_16x16x32_bf16 v[172:175], a[172:175], a[12:15], v[172:175]
    v_xor_b32 v20, 0x8000, v20
    v_mfma_f32_16x16x32_bf16 v[172:175], a[168:171], a[8:11], v[172:175]
    ds_read_b128 a[164:167], v15 offset:12288
    v_mfma_f32_16x16x32_bf16 v[180:183], a[168:171], a[16:19], v[180:183]
    v_mfma_f32_16x16x32_bf16 v[180:183], a[172:175], a[20:23], v[180:183]
    v_xor_b32 v21, 0x8000, v21
    v_mfma_f32_16x16x32_bf16 v[188:191], a[172:175], a[28:31], v[188:191]
    buffer_load_dwordx4 v11, s[12:15], s54 offen offset:1024 lds
    v_mfma_f32_16x16x32_bf16 v[188:191], a[168:171], a[24:27], v[188:191]
    v_mfma_f32_16x16x32_bf16 v[196:199], a[168:171], a[32:35], v[196:199]
    v_xor_b32 v22, 0x8000, v22
    v_mfma_f32_16x16x32_bf16 v[196:199], a[172:175], a[36:39], v[196:199]
    v_mfma_f32_16x16x32_bf16 v[204:207], a[172:175], a[44:47], v[204:207]
    v_mfma_f32_16x16x32_bf16 v[204:207], a[168:171], a[40:43], v[204:207]
    v_xor_b32 v23, 0x8000, v23
    v_mfma_f32_16x16x32_bf16 v[212:215], a[168:171], a[48:51], v[212:215]
    buffer_load_dwordx4 v12, s[12:15], s54 offen offset:2048 lds
    v_mfma_f32_16x16x32_bf16 v[212:215], a[172:175], a[52:55], v[212:215]
    v_mfma_f32_16x16x32_bf16 v[220:223], a[172:175], a[60:63], v[220:223]
    v_mfma_f32_16x16x32_bf16 v[220:223], a[168:171], a[56:59], v[220:223]
    s_waitcnt lgkmcnt(0)
    v_mfma_f32_16x16x32_bf16 v[224:227], a[160:163], a[0:3], v[224:227]
    v_mfma_f32_16x16x32_bf16 v[224:227], a[164:167], a[4:7], v[224:227]
    ds_read_b128 a[168:171], v14 offset:14336
    v_mfma_f32_16x16x32_bf16 v[232:235], a[164:167], a[12:15], v[232:235]
    buffer_load_dwordx4 v13, s[12:15], s54 offen offset:3072 lds
    s_add_u32 s54, s54, 262144
    v_mfma_f32_16x16x32_bf16 v[232:235], a[160:163], a[8:11], v[232:235]
    ds_read_b128 a[172:175], v15 offset:14336
    v_mfma_f32_16x16x32_bf16 v[240:243], a[160:163], a[16:19], v[240:243]
    v_mfma_f32_16x16x32_bf16 v[240:243], a[164:167], a[20:23], v[240:243]
    v_add_u32 v14, s58, v14
    v_mfma_f32_16x16x32_bf16 v[248:251], a[164:167], a[28:31], v[248:251]
    v_mfma_f32_16x16x32_bf16 v[248:251], a[160:163], a[24:27], v[248:251]
    v_add_u32 v15, s58, v15
    v_mfma_f32_16x16x32_bf16 a[64:67], a[160:163], a[32:35], a[64:67]
    v_mfma_f32_16x16x32_bf16 a[64:67], a[164:167], a[36:39], a[64:67]
    v_mfma_f32_16x16x32_bf16 a[72:75], a[164:167], a[44:47], a[72:75]
    s_add_u32 s59, s55, s57
    s_add_u32 s57, s57, s58
    v_mfma_f32_16x16x32_bf16 a[72:75], a[160:163], a[40:43], a[72:75]
    v_mfma_f32_16x16x32_bf16 a[80:83], a[160:163], a[48:51], a[80:83]
    s_cmp_eq_u32 s57, 65536
    s_cselect_b32 s58, s34, s35
    v_mfma_f32_16x16x32_bf16 a[80:83], a[164:167], a[52:55], a[80:83]
    v_mfma_f32_16x16x32_bf16 a[88:91], a[164:167], a[60:63], a[88:91]
    s_xor_b32 s56, s56, 0x8000
    s_add_u32 s43, s43, 1
    v_mfma_f32_16x16x32_bf16 a[88:91], a[160:163], a[56:59], a[88:91]
    s_waitcnt lgkmcnt(0)
    s_waitcnt vmcnt(16)
    s_barrier
    v_mfma_f32_16x16x32_bf16 v[228:231], a[168:171], a[0:3], v[228:231]
    ds_read_b128 a[160:163], v14 offset:0
    ds_read_b128 a[164:167], v15 offset:0
    v_mfma_f32_16x16x32_bf16 v[228:231], a[172:175], a[4:7], v[228:231]
    ds_read_b64_tr_b16 a[0:1], v16 offset:0
    ds_read_b64_tr_b16 a[2:3], v16 offset:2048
    v_mfma_f32_16x16x32_bf16 v[236:239], a[172:175], a[12:15], v[236:239]
    ds_read_b64_tr_b16 a[4:5], v16 offset:16384
    ds_read_b64_tr_b16 a[6:7], v16 offset:18432
    v_mfma_f32_16x16x32_bf16 v[236:239], a[168:171], a[8:11], v[236:239]
    ds_read_b64_tr_b16 a[8:9], v17 offset:0
    ds_read_b64_tr_b16 a[10:11], v17 offset:2048
    v_mfma_f32_16x16x32_bf16 v[244:247], a[168:171], a[16:19], v[244:247]
    ds_read_b64_tr_b16 a[12:13], v17 offset:16384
    ds_read_b64_tr_b16 a[14:15], v17 offset:18432
    v_mfma_f32_16x16x32_bf16 v[244:247], a[172:175], a[20:23], v[244:247]
    ds_read_b64_tr_b16 a[16:17], v18 offset:0
    ds_read_b64_tr_b16 a[18:19], v18 offset:2048
    v_mfma_f32_16x16x32_bf16 v[252:255], a[172:175], a[28:31], v[252:255]
    ds_read_b64_tr_b16 a[20:21], v18 offset:16384
    ds_read_b64_tr_b16 a[22:23], v18 offset:18432
    v_mfma_f32_16x16x32_bf16 v[252:255], a[168:171], a[24:27], v[252:255]
    ds_read_b64_tr_b16 a[24:25], v19 offset:0
    ds_read_b64_tr_b16 a[26:27], v19 offset:2048
    v_mfma_f32_16x16x32_bf16 a[68:71], a[168:171], a[32:35], a[68:71]
    ds_read_b64_tr_b16 a[28:29], v19 offset:16384
    ds_read_b64_tr_b16 a[30:31], v19 offset:18432
    v_mfma_f32_16x16x32_bf16 a[68:71], a[172:175], a[36:39], a[68:71]
    ds_read_b64_tr_b16 a[32:33], v20 offset:0
    ds_read_b64_tr_b16 a[34:35], v20 offset:2048
    v_mfma_f32_16x16x32_bf16 a[76:79], a[172:175], a[44:47], a[76:79]
    ds_read_b64_tr_b16 a[36:37], v20 offset:16384
    ds_read_b64_tr_b16 a[38:39], v20 offset:18432
    v_mfma_f32_16x16x32_bf16 a[76:79], a[168:171], a[40:43], a[76:79]
    ds_read_b64_tr_b16 a[40:41], v21 offset:0
    ds_read_b64_tr_b16 a[42:43], v21 offset:2048
    v_mfma_f32_16x16x32_bf16 a[84:87], a[168:171], a[48:51], a[84:87]
    ds_read_b64_tr_b16 a[44:45], v21 offset:16384
    ds_read_b64_tr_b16 a[46:47], v21 offset:18432
    v_mfma_f32_16x16x32_bf16 a[84:87], a[172:175], a[52:55], a[84:87]
    ds_read_b64_tr_b16 a[48:49], v22 offset:0
    ds_read_b64_tr_b16 a[50:51], v22 offset:2048
    v_mfma_f32_16x16x32_bf16 a[92:95], a[172:175], a[60:63], a[92:95]
    ds_read_b64_tr_b16 a[52:53], v22 offset:16384
    ds_read_b64_tr_b16 a[54:55], v22 offset:18432
    v_mfma_f32_16x16x32_bf16 a[92:95], a[168:171], a[56:59], a[92:95]
    ds_read_b64_tr_b16 a[56:57], v23 offset:0
    ds_read_b64_tr_b16 a[58:59], v23 offset:2048
    ds_read_b64_tr_b16 a[60:61], v23 offset:16384
    ds_read_b64_tr_b16 a[62:63], v23 offset:18432
    s_bitcmp0_b32 s99, s43
    s_cbranch_scc1 L_loopV
    s_cmp_lg_u32 s43, 14
    s_cbranch_scc1 L_hook
    s_waitcnt lgkmcnt(15)
    v_mfma_f32_16x16x32_bf16 v[32:35], a[160:163], a[0:3], v[32:35]
    v_mfma_f32_16x16x32_bf16 v[32:35], a[164:167], a[4:7], v[32:35]
    v_mfma_f32_16x16x32_bf16 v[40:43], a[164:167], a[12:15], v[40:43]
    v_lshrrev_b32 v28, 5, v1
    s_lshl_b32 s40, s24, 3
    v_mfma_f32_16x16x32_bf16 v[40:43], a[160:163], a[8:11], v[40:43]
    v_add_u32 v29, s40, v28
    v_mfma_f32_16x16x32_bf16 v[48:51], a[160:163], a[16:19], v[48:51]
    v_lshlrev_b32 v29, 13, v29
    v_mfma_f32_16x16x32_bf16 v[48:51], a[164:167], a[20:23], v[48:51]
    s_lshl_b32 s40, s27, 9
    v_mfma_f32_16x16x32_bf16 v[56:59], a[164:167], a[28:31], v[56:59]
    v_add_u32 v29, s40, v29
    v_mfma_f32_16x16x32_bf16 v[56:59], a[160:163], a[24:27], v[56:59]
    v_lshlrev_b32 v28, 1, v28
    s_waitcnt lgkmcnt(8)
    v_mfma_f32_16x16x32_bf16 v[64:67], a[160:163], a[32:35], v[64:67]
    ds_read_b128 a[168:171], v14 offset:2048
    v_and_b32 v30, 31, v1
    v_mfma_f32_16x16x32_bf16 v[64:67], a[164:167], a[36:39], v[64:67]
    v_xor_b32 v28, v28, v30
    v_mfma_f32_16x16x32_bf16 v[72:75], a[164:167], a[44:47], v[72:75]
    ds_read_b128 a[172:175], v15 offset:2048
    s_lshl_b32 s40, s25, 3
    v_mfma_f32_16x16x32_bf16 v[72:75], a[160:163], a[40:43], v[72:75]
    v_xor_b32 v28, s40, v28
    s_waitcnt lgkmcnt(2)
    v_mfma_f32_16x16x32_bf16 v[80:83], a[160:163], a[48:51], v[80:83]
    v_xor_b32 v30, 4, v28
    v_mfma_f32_16x16x32_bf16 v[80:83], a[164:167], a[52:55], v[80:83]
    v_lshl_add_u32 v28, v28, 4, v29
    v_mfma_f32_16x16x32_bf16 v[88:91], a[164:167], a[60:63], v[88:91]
    v_lshl_add_u32 v30, v30, 4, v29
    v_mfma_f32_16x16x32_bf16 v[88:91], a[160:163], a[56:59], v[88:91]
    v_add_u32 v2, 0, v28
    s_waitcnt lgkmcnt(0)
    s_barrier
    v_mfma_f32_16x16x32_bf16 v[36:39], a[168:171], a[0:3], v[36:39]
    v_add_u32 v3, 15360, v30
    v_mfma_f32_16x16x32_bf16 v[36:39], a[172:175], a[4:7], v[36:39]
    ds_read_b128 a[160:163], v14 offset:4096
    v_add_u32 v4, 30720, v28
    v_mfma_f32_16x16x32_bf16 v[44:47], a[172:175], a[12:15], v[44:47]
    v_add_u32 v5, 46080, v30
    v_mfma_f32_16x16x32_bf16 v[44:47], a[168:171], a[8:11], v[44:47]
    ds_read_b128 a[164:167], v15 offset:4096
    v_lshrrev_b32 v28, 4, v1
    v_mfma_f32_16x16x32_bf16 v[52:55], a[168:171], a[16:19], v[52:55]
    s_lshl_b32 s40, s24, 3
    v_mfma_f32_16x16x32_bf16 v[52:55], a[172:175], a[20:23], v[52:55]
    v_add_u32 v29, s40, v28
    v_mfma_f32_16x16x32_bf16 v[60:63], a[172:175], a[28:31], v[60:63]
    v_mul_u32_u24 v29, 3584, v29
    v_mfma_f32_16x16x32_bf16 v[60:63], a[168:171], a[24:27], v[60:63]
    v_lshlrev_b32 v28, 1, v28
    v_mfma_f32_16x16x32_bf16 v[68:71], a[168:171], a[32:35], v[68:71]
    v_and_b32 v30, 15, v1
    v_mfma_f32_16x16x32_bf16 v[68:71], a[172:175], a[36:39], v[68:71]
    v_xor_b32 v28, v28, v30
    v_mfma_f32_16x16x32_bf16 v[76:79], a[172:175], a[44:47], v[76:79]
    s_lshl_b32 s40, s25, 3
    v_mfma_f32_16x16x32_bf16 v[76:79], a[168:171], a[40:43], v[76:79]
    v_xor_b32 v28, s40, v28
    v_mfma_f32_16x16x32_bf16 v[84:87], a[168:171], a[48:51], v[84:87]
    v_lshl_add_u32 v6, v28, 4, v29
    v_mfma_f32_16x16x32_bf16 v[84:87], a[172:175], a[52:55], v[84:87]
    v_add_u32 v7, 13312, v6
    v_mfma_f32_16x16x32_bf16 v[92:95], a[172:175], a[60:63], v[92:95]
    v_accvgpr_read_b32 v31, a224
    v_lshlrev_b32 v24, 16, v31
    v_mfma_f32_16x16x32_bf16 v[92:95], a[168:171], a[56:59], v[92:95]
    v_and_b32 v31, 0xffff0000, v31
    s_waitcnt lgkmcnt(0)
    v_mfma_f32_16x16x32_bf16 v[96:99], a[160:163], a[0:3], v[96:99]
    v_accvgpr_write_b32 a96, v24
    v_mfma_f32_16x16x32_bf16 v[96:99], a[164:167], a[4:7], v[96:99]
    ds_read_b128 a[168:171], v14 offset:6144
    v_accvgpr_write_b32 a97, v31
    v_mfma_f32_16x16x32_bf16 v[104:107], a[164:167], a[12:15], v[104:107]
    s_add_u32 m0, s32, 98304
    s_nop 0
    buffer_load_dwordx4 v2, s[16:19], s49 offen lds
    v_accvgpr_write_b32 a112, v24
    v_mfma_f32_16x16x32_bf16 v[104:107], a[160:163], a[8:11], v[104:107]
    ds_read_b128 a[172:175], v15 offset:6144
    v_accvgpr_write_b32 a113, v31
    v_mfma_f32_16x16x32_bf16 v[112:115], a[160:163], a[16:19], v[112:115]
    v_accvgpr_write_b32 a128, v24
    v_mfma_f32_16x16x32_bf16 v[112:115], a[164:167], a[20:23], v[112:115]
    v_accvgpr_write_b32 a129, v31
    v_mfma_f32_16x16x32_bf16 v[120:123], a[164:167], a[28:31], v[120:123]
    v_accvgpr_write_b32 a144, v24
    v_mfma_f32_16x16x32_bf16 v[120:123], a[160:163], a[24:27], v[120:123]
    v_accvgpr_write_b32 a145, v31
    v_mfma_f32_16x16x32_bf16 v[128:131], a[160:163], a[32:35], v[128:131]
    v_accvgpr_read_b32 v31, a225
    v_mfma_f32_16x16x32_bf16 v[128:131], a[164:167], a[36:39], v[128:131]
    v_lshlrev_b32 v24, 16, v31
    v_and_b32 v31, 0xffff0000, v31
    v_mfma_f32_16x16x32_bf16 v[136:139], a[164:167], a[44:47], v[136:139]
    buffer_load_dwordx4 v3, s[16:19], s49 offen offset:1024 lds
    v_accvgpr_write_b32 a98, v24
    v_mfma_f32_16x16x32_bf16 v[136:139], a[160:163], a[40:43], v[136:139]
    v_accvgpr_write_b32 a99, v31
    v_mfma_f32_16x16x32_bf16 v[144:147], a[160:163], a[48:51], v[144:147]
    v_accvgpr_write_b32 a114, v24
    v_mfma_f32_16x16x32_bf16 v[144:147], a[164:167], a[52:55], v[144:147]
    v_accvgpr_write_b32 a115, v31
    v_mfma_f32_16x16x32_bf16 v[152:155], a[164:167], a[60:63], v[152:155]
    v_accvgpr_write_b32 a130, v24
    v_mfma_f32_16x16x32_bf16 v[152:155], a[160:163], a[56:59], v[152:155]
    v_accvgpr_write_b32 a131, v31
    s_waitcnt lgkmcnt(0)
    v_mfma_f32_16x16x32_bf16 v[100:103], a[168:171], a[0:3], v[100:103]
    v_accvgpr_write_b32 a146, v24
    v_mfma_f32_16x16x32_bf16 v[100:103], a[172:175], a[4:7], v[100:103]
    ds_read_b128 a[160:163], v14 offset:8192
    v_accvgpr_write_b32 a147, v31
    v_mfma_f32_16x16x32_bf16 v[108:111], a[172:175], a[12:15], v[108:111]
    v_accvgpr_read_b32 v31, a226
    v_mfma_f32_16x16x32_bf16 v[108:111], a[168:171], a[8:11], v[108:111]
    ds_read_b128 a[164:167], v15 offset:8192
    buffer_load_dwordx4 v4, s[16:19], s49 offen offset:2048 lds
    v_lshlrev_b32 v24, 16, v31
    v_mfma_f32_16x16x32_bf16 v[116:119], a[168:171], a[16:19], v[116:119]
    v_and_b32 v31, 0xffff0000, v31
    v_mfma_f32_16x16x32_bf16 v[116:119], a[172:175], a[20:23], v[116:119]
    v_accvgpr_write_b32 a100, v24
    v_accvgpr_write_b32 a101, v31
    v_mfma_f32_16x16x32_bf16 v[124:127], a[172:175], a[28:31], v[124:127]
    v_accvgpr_write_b32 a116, v24
    v_mfma_f32_16x16x32_bf16 v[124:127], a[168:171], a[24:27], v[124:127]
    v_accvgpr_write_b32 a117, v31
    v_mfma_f32_16x16x32_bf16 v[132:135], a[168:171], a[32:35], v[132:135]
    v_accvgpr_write_b32 a132, v24
    v_mfma_f32_16x16x32_bf16 v[132:135], a[172:175], a[36:39], v[132:135]
    v_accvgpr_write_b32 a133, v31
    v_mfma_f32_16x16x32_bf16 v[140:143], a[172:175], a[44:47], v[140:143]
    v_accvgpr_write_b32 a148, v24
    v_mfma_f32_16x16x32_bf16 v[140:143], a[168:171], a[40:43], v[140:143]
    v_accvgpr_write_b32 a149, v31
    v_mfma_f32_16x16x32_bf16 v[148:151], a[168:171], a[48:51], v[148:151]
    buffer_load_dwordx4 v5, s[16:19], s49 offen offset:3072 lds
    v_accvgpr_read_b32 v31, a227
    v_mfma_f32_16x16x32_bf16 v[148:151], a[172:175], a[52:55], v[148:151]
    v_lshlrev_b32 v24, 16, v31
    v_mfma_f32_16x16x32_bf16 v[156:159], a[172:175], a[60:63], v[156:159]
    v_and_b32 v31, 0xffff0000, v31
    v_mfma_f32_16x16x32_bf16 v[156:159], a[168:171], a[56:59], v[156:159]
    v_accvgpr_write_b32 a102, v24
    s_waitcnt lgkmcnt(0)
    v_mfma_f32_16x16x32_bf16 v[160:163], a[160:163], a[0:3], v[160:163]
    v_accvgpr_write_b32 a103, v31
    v_accvgpr_write_b32 a118, v24
    v_mfma_f32_16x16x32_bf16 v[160:163], a[164:167], a[4:7], v[160:163]
    ds_read_b128 a[168:171], v14 offset:10240
    v_accvgpr_write_b32 a119, v31
    v_mfma_f32_16x16x32_bf16 v[168:171], a[164:167], a[12:15], v[168:171]
    v_accvgpr_write_b32 a134, v24
    v_mfma_f32_16x16x32_bf16 v[168:171], a[160:163], a[8:11], v[168:171]
    ds_read_b128 a[172:175], v15 offset:10240
    v_accvgpr_write_b32 a135, v31
    v_mfma_f32_16x16x32_bf16 v[176:179], a[160:163], a[16:19], v[176:179]
    v_accvgpr_write_b32 a150, v24
    v_mfma_f32_16x16x32_bf16 v[176:179], a[164:167], a[20:23], v[176:179]
    s_add_u32 m0, s33, 98304
    s_add_u32 s49, s49, 262144
    buffer_load_dwordx4 v6, s[20:23], s50 offen lds
    v_accvgpr_write_b32 a151, v31
    v_mfma_f32_16x16x32_bf16 v[184:187], a[164:167], a[28:31], v[184:187]
    v_xor_b32 v16, 0x8000, v16
    v_accvgpr_read_b32 v31, a228
    v_mfma_f32_16x16x32_bf16 v[184:187], a[160:163], a[24:27], v[184:187]
    v_lshlrev_b32 v24, 16, v31
    v_mfma_f32_16x16x32_bf16 v[192:195], a[160:163], a[32:35], v[192:195]
    v_and_b32 v31, 0xffff0000, v31
    v_mfma_f32_16x16x32_bf16 v[192:195], a[164:167], a[36:39], v[192:195]
    v_xor_b32 v17, 0x8000, v17
    v_accvgpr_write_b32 a104, v24
    v_mfma_f32_16x16x32_bf16 v[200:203], a[164:167], a[44:47], v[200:203]
    v_accvgpr_write_b32 a105, v31
    v_mfma_f32_16x16x32_bf16 v[200:203], a[160:163], a[40:43], v[200:203]
    v_accvgpr_write_b32 a120, v24
    v_mfma_f32_16x16x32_bf16 v[208:211], a[160:163], a[48:51], v[208:211]
    v_xor_b32 v18, 0x8000, v18
    v_accvgpr_write_b32 a121, v31
    v_accvgpr_write_b32 a136, v24
    v_mfma_f32_16x16x32_bf16 v[208:211], a[164:167], a[52:55], v[208:211]
    buffer_load_dwordx4 v7, s[20:23], s50 offen offset:1024 lds
    v_accvgpr_write_b32 a137, v31
    v_mfma_f32_16x16x32_bf16 v[216:219], a[164:167], a[60:63], v[216:219]
    v_accvgpr_write_b32 a152, v24
    v_mfma_f32_16x16x32_bf16 v[216:219], a[160:163], a[56:59], v[216:219]
    v_xor_b32 v19, 0x8000, v19
    v_accvgpr_write_b32 a153, v31
    s_waitcnt lgkmcnt(0)
    v_mfma_f32_16x16x32_bf16 v[164:167], a[168:171], a[0:3], v[164:167]
    v_accvgpr_read_b32 v31, a229
    v_mfma_f32_16x16x32_bf16 v[164:167], a[172:175], a[4:7], v[164:167]
    ds_read_b128 a[160:163], v14 offset:12288
    v_lshlrev_b32 v24, 16, v31
    v_mfma_f32_16x16x32_bf16 v[172:175], a[172:175], a[12:15], v[172:175]
    v_xor_b32 v20, 0x8000, v20
    v_and_b32 v31, 0xffff0000, v31
    v_mfma_f32_16x16x32_bf16 v[172:175], a[168:171], a[8:11], v[172:175]
    ds_read_b128 a[164:167], v15 offset:12288
    v_accvgpr_write_b32 a106, v24
    v_mfma_f32_16x16x32_bf16 v[180:183], a[168:171], a[16:19], v[180:183]
    v_accvgpr_write_b32 a107, v31
    v_mfma_f32_16x16x32_bf16 v[180:183], a[172:175], a[20:23], v[180:183]
    v_xor_b32 v21, 0x8000, v21
    v_accvgpr_write_b32 a122, v24
    v_mfma_f32_16x16x32_bf16 v[188:191], a[172:175], a[28:31], v[188:191]
    s_add_u32 m0, m0, 8192
    s_add_u32 s50, s50, 114688
    buffer_load_dwordx4 v27, s[4:7], s51 offen sc1 lds
    v_accvgpr_write_b32 a123, v31
    v_mfma_f32_16x16x32_bf16 v[188:191], a[168:171], a[24:27], v[188:191]
    v_accvgpr_write_b32 a138, v24
    v_accvgpr_write_b32 a139, v31
    v_mfma_f32_16x16x32_bf16 v[196:199], a[168:171], a[32:35], v[196:199]
    v_xor_b32 v22, 0x8000, v22
    v_accvgpr_write_b32 a154, v24
    v_mfma_f32_16x16x32_bf16 v[196:199], a[172:175], a[36:39], v[196:199]
    v_accvgpr_write_b32 a155, v31
    v_mfma_f32_16x16x32_bf16 v[204:207], a[172:175], a[44:47], v[204:207]
    v_accvgpr_read_b32 v31, a230
    v_mfma_f32_16x16x32_bf16 v[204:207], a[168:171], a[40:43], v[204:207]
    v_xor_b32 v23, 0x8000, v23
    v_lshlrev_b32 v24, 16, v31
    v_mfma_f32_16x16x32_bf16 v[212:215], a[168:171], a[48:51], v[212:215]
    v_and_b32 v31, 0xffff0000, v31
    v_mfma_f32_16x16x32_bf16 v[212:215], a[172:175], a[52:55], v[212:215]
    v_accvgpr_write_b32 a108, v24
    v_mfma_f32_16x16x32_bf16 v[220:223], a[172:175], a[60:63], v[220:223]
    v_accvgpr_write_b32 a109, v31
    v_mfma_f32_16x16x32_bf16 v[220:223], a[168:171], a[56:59], v[220:223]
    buffer_load_dwordx4 v27, s[4:7], s51 offen offset:1024 sc1 lds
    s_add_u32 s51, s51, 2048
    s_cmp_eq_u32 s49, 3670016
    s_cselect_b32 s49, 0, s49
    s_cselect_b32 s50, s61, s50
    s_cselect_b32 s51, s62, s51
    v_accvgpr_write_b32 a124, v24
    s_waitcnt lgkmcnt(0)
    v_mfma_f32_16x16x32_bf16 v[224:227], a[160:163], a[0:3], v[224:227]
    v_accvgpr_write_b32 a125, v31
    v_mfma_f32_16x16x32_bf16 v[224:227], a[164:167], a[4:7], v[224:227]
    ds_read_b128 a[168:171], v14 offset:14336
    v_accvgpr_write_b32 a140, v24
    v_mfma_f32_16x16x32_bf16 v[232:235], a[164:167], a[12:15], v[232:235]
    v_accvgpr_write_b32 a141, v31
    v_mfma_f32_16x16x32_bf16 v[232:235], a[160:163], a[8:11], v[232:235]
    ds_read_b128 a[172:175], v15 offset:14336
    v_accvgpr_write_b32 a156, v24
    v_accvgpr_write_b32 a157, v31
    v_mfma_f32_16x16x32_bf16 v[240:243], a[160:163], a[16:19], v[240:243]
    v_accvgpr_read_b32 v31, a231
    v_mfma_f32_16x16x32_bf16 v[240:243], a[164:167], a[20:23], v[240:243]
    v_add_u32 v14, s58, v14
    v_lshlrev_b32 v24, 16, v31
    v_mfma_f32_16x16x32_bf16 v[248:251], a[164:167], a[28:31], v[248:251]
    v_and_b32 v31, 0xffff0000, v31
    v_mfma_f32_16x16x32_bf16 v[248:251], a[160:163], a[24:27], v[248:251]
    v_add_u32 v15, s58, v15
    v_accvgpr_write_b32 a110, v24
    v_mfma_f32_16x16x32_bf16 a[64:67], a[160:163], a[32:35], a[64:67]
    v_accvgpr_write_b32 a111, v31
    v_mfma_f32_16x16x32_bf16 a[64:67], a[164:167], a[36:39], a[64:67]
    v_accvgpr_write_b32 a126, v24
    v_mfma_f32_16x16x32_bf16 a[72:75], a[164:167], a[44:47], a[72:75]
    s_add_u32 s59, s55, s57
    s_add_u32 s57, s57, s58
    v_accvgpr_write_b32 a127, v31
    v_mfma_f32_16x16x32_bf16 a[72:75], a[160:163], a[40:43], a[72:75]
    v_accvgpr_write_b32 a142, v24
    v_mfma_f32_16x16x32_bf16 a[80:83], a[160:163], a[48:51], a[80:83]
    s_cmp_eq_u32 s57, 65536
    s_cselect_b32 s58, s34, s35
    v_accvgpr_write_b32 a143, v31
    v_mfma_f32_16x16x32_bf16 a[80:83], a[164:167], a[52:55], a[80:83]
    v_accvgpr_write_b32 a158, v24
    v_mfma_f32_16x16x32_bf16 a[88:91], a[164:167], a[60:63], a[88:91]
    v_accvgpr_write_b32 a159, v31
    v_mfma_f32_16x16x32_bf16 a[88:91], a[160:163], a[56:59], a[88:91]
    v_readfirstlane_b32 s48, v25
    s_waitcnt lgkmcnt(0)
    s_waitcnt vmcnt(8)
    s_barrier
    v_mfma_f32_16x16x32_bf16 v[228:231], a[168:171], a[0:3], v[228:231]
    ds_read_b128 a[160:163], v14 offset:0
    ds_read_b128 a[164:167], v15 offset:0
    v_mfma_f32_16x16x32_bf16 v[228:231], a[172:175], a[4:7], v[228:231]
    ds_read_b64_tr_b16 a[0:1], v16 offset:0
    ds_read_b64_tr_b16 a[2:3], v16 offset:2048
    v_mfma_f32_16x16x32_bf16 v[236:239], a[172:175], a[12:15], v[236:239]
    ds_read_b64_tr_b16 a[4:5], v16 offset:16384
    ds_read_b64_tr_b16 a[6:7], v16 offset:18432
    v_mfma_f32_16x16x32_bf16 v[236:239], a[168:171], a[8:11], v[236:239]
    ds_read_b64_tr_b16 a[8:9], v17 offset:0
    ds_read_b64_tr_b16 a[10:11], v17 offset:2048
    v_mfma_f32_16x16x32_bf16 v[244:247], a[168:171], a[16:19], v[244:247]
    ds_read_b64_tr_b16 a[12:13], v17 offset:16384
    ds_read_b64_tr_b16 a[14:15], v17 offset:18432
    v_mfma_f32_16x16x32_bf16 v[244:247], a[172:175], a[20:23], v[244:247]
    ds_read_b64_tr_b16 a[16:17], v18 offset:0
    ds_read_b64_tr_b16 a[18:19], v18 offset:2048
    v_mfma_f32_16x16x32_bf16 v[252:255], a[172:175], a[28:31], v[252:255]
    ds_read_b64_tr_b16 a[20:21], v18 offset:16384
    ds_read_b64_tr_b16 a[22:23], v18 offset:18432
    v_mfma_f32_16x16x32_bf16 v[252:255], a[168:171], a[24:27], v[252:255]
    ds_read_b64_tr_b16 a[24:25], v19 offset:0
    ds_read_b64_tr_b16 a[26:27], v19 offset:2048
    v_mfma_f32_16x16x32_bf16 a[68:71], a[168:171], a[32:35], a[68:71]
    ds_read_b64_tr_b16 a[28:29], v19 offset:16384
    ds_read_b64_tr_b16 a[30:31], v19 offset:18432
    v_mfma_f32_16x16x32_bf16 a[68:71], a[172:175], a[36:39], a[68:71]
    ds_read_b64_tr_b16 a[32:33], v20 offset:0
    ds_read_b64_tr_b16 a[34:35], v20 offset:2048
    v_mfma_f32_16x16x32_bf16 a[76:79], a[172:175], a[44:47], a[76:79]
    ds_read_b64_tr_b16 a[36:37], v20 offset:16384
    ds_read_b64_tr_b16 a[38:39], v20 offset:18432
    v_mfma_f32_16x16x32_bf16 a[76:79], a[168:171], a[40:43], a[76:79]
    ds_read_b64_tr_b16 a[40:41], v21 offset:0
    ds_read_b64_tr_b16 a[42:43], v21 offset:2048
    v_mfma_f32_16x16x32_bf16 a[84:87], a[168:171], a[48:51], a[84:87]
    ds_read_b64_tr_b16 a[44:45], v21 offset:16384
    ds_read_b64_tr_b16 a[46:47], v21 offset:18432
    v_mfma_f32_16x16x32_bf16 a[84:87], a[172:175], a[52:55], a[84:87]
    ds_read_b64_tr_b16 a[48:49], v22 offset:0
    ds_read_b64_tr_b16 a[50:51], v22 offset:2048
    v_mfma_f32_16x16x32_bf16 a[92:95], a[172:175], a[60:63], a[92:95]
    ds_read_b64_tr_b16 a[52:53], v22 offset:16384
    ds_read_b64_tr_b16 a[54:55], v22 offset:18432
    v_mfma_f32_16x16x32_bf16 a[92:95], a[168:171], a[56:59], a[92:95]
    ds_read_b64_tr_b16 a[56:57], v23 offset:0
    ds_read_b64_tr_b16 a[58:59], v23 offset:2048
    ds_read_b64_tr_b16 a[60:61], v23 offset:16384
    ds_read_b64_tr_b16 a[62:63], v23 offset:18432
    s_waitcnt lgkmcnt(15)
    v_mfma_f32_16x16x32_bf16 v[32:35], a[160:163], a[0:3], v[32:35]
    v_mfma_f32_16x16x32_bf16 v[32:35], a[164:167], a[4:7], v[32:35]
    s_bfe_u32 s41, s48, 0xa0006
    s_mul_i32 s41, s41, s41
    v_mfma_f32_16x16x32_bf16 v[40:43], a[164:167], a[12:15], v[40:43]
    s_lshr_b32 s48, s48, 16
    s_lshl_b32 s48, s48, 5
    v_mfma_f32_16x16x32_bf16 v[40:43], a[160:163], a[8:11], v[40:43]
    s_cmp_lg_u32 s48, s41
    s_cselect_b64 vcc, -1, 0
    v_mfma_f32_16x16x32_bf16 v[48:51], a[160:163], a[16:19], v[48:51]
    s_add_u32 m0, s32, 131072
    s_nop 0
    buffer_load_dwordx4 v2, s[16:19], s49 offen lds
    s_lshl_b32 s40, s25, 8
    s_add_u32 s40, s40, 98304
    v_mfma_f32_16x16x32_bf16 v[48:51], a[164:167], a[20:23], v[48:51]
    v_bfe_u32 v28, v1, 2, 2
    v_mfma_f32_16x16x32_bf16 v[56:59], a[164:167], a[28:31], v[56:59]
    v_lshrrev_b32 v29, 4, v1
    v_lshl_add_u32 v29, v29, 3, v28
    v_mfma_f32_16x16x32_bf16 v[56:59], a[160:163], a[24:27], v[56:59]
    v_lshlrev_b32 v9, 8, v29
    s_waitcnt lgkmcnt(8)
    v_mfma_f32_16x16x32_bf16 v[64:67], a[160:163], a[32:35], v[64:67]
    ds_read_b128 a[168:171], v14 offset:2048
    v_lshlrev_b32 v29, 9, v29
    v_and_b32 v30, 3, v1
    v_mfma_f32_16x16x32_bf16 v[64:67], a[164:167], a[36:39], v[64:67]
    v_lshl_add_u32 v29, v30, 3, v29
    v_mfma_f32_16x16x32_bf16 v[72:75], a[164:167], a[44:47], v[72:75]
    ds_read_b128 a[172:175], v15 offset:2048
    v_add_u32 v29, s40, v29
    v_bfe_u32 v28, v1, 2, 3
    v_mfma_f32_16x16x32_bf16 v[72:75], a[160:163], a[40:43], v[72:75]
    buffer_load_dwordx4 v3, s[16:19], s49 offen offset:1024 lds
    v_xor_b32 v30, 0, v28
    s_waitcnt lgkmcnt(2)
    v_mfma_f32_16x16x32_bf16 v[80:83], a[160:163], a[48:51], v[80:83]
    v_lshl_add_u32 v16, v30, 5, v29
    v_xor_b32 v30, 1, v28
    v_mfma_f32_16x16x32_bf16 v[80:83], a[164:167], a[52:55], v[80:83]
    v_lshl_add_u32 v17, v30, 5, v29
    v_mfma_f32_16x16x32_bf16 v[88:91], a[164:167], a[60:63], v[88:91]
    v_xor_b32 v30, 2, v28
    v_lshl_add_u32 v18, v30, 5, v29
    v_mfma_f32_16x16x32_bf16 v[88:91], a[160:163], a[56:59], v[88:91]
    v_xor_b32 v30, 3, v28
    s_waitcnt lgkmcnt(0)
    v_mfma_f32_16x16x32_bf16 v[36:39], a[168:171], a[0:3], v[36:39]
    v_lshl_add_u32 v19, v30, 5, v29
    v_xor_b32 v30, 4, v28
    v_mfma_f32_16x16x32_bf16 v[36:39], a[172:175], a[4:7], v[36:39]
    ds_read_b128 a[160:163], v14 offset:4096
    v_lshl_add_u32 v20, v30, 5, v29
    v_mfma_f32_16x16x32_bf16 v[44:47], a[172:175], a[12:15], v[44:47]
    buffer_load_dwordx4 v4, s[16:19], s49 offen offset:2048 lds
    v_xor_b32 v30, 5, v28
    v_mfma_f32_16x16x32_bf16 v[44:47], a[168:171], a[8:11], v[44:47]
    ds_read_b128 a[164:167], v15 offset:4096
    v_lshl_add_u32 v21, v30, 5, v29
    v_xor_b32 v30, 6, v28
    v_mfma_f32_16x16x32_bf16 v[52:55], a[168:171], a[16:19], v[52:55]
    v_lshl_add_u32 v22, v30, 5, v29
    v_mfma_f32_16x16x32_bf16 v[52:55], a[172:175], a[20:23], v[52:55]
    v_xor_b32 v30, 7, v28
    v_lshl_add_u32 v23, v30, 5, v29
    v_mfma_f32_16x16x32_bf16 v[60:63], a[172:175], a[28:31], v[60:63]
    v_sub_u32 v29, v29, v9
    v_mfma_f32_16x16x32_bf16 v[60:63], a[168:171], a[24:27], v[60:63]
    s_lshl_b32 s40, s25, 8
    v_subrev_u32 v29, s40, v29
    v_mfma_f32_16x16x32_bf16 v[68:71], a[168:171], a[32:35], v[68:71]
    v_add_u32 v29, 16384, v29
    v_mfma_f32_16x16x32_bf16 v[68:71], a[172:175], a[36:39], v[68:71]
    buffer_load_dwordx4 v5, s[16:19], s49 offen offset:3072 lds
    s_lshl_b32 s40, s25, 2
    v_xor_b32 v28, s40, v28
    v_mfma_f32_16x16x32_bf16 v[76:79], a[172:175], a[44:47], v[76:79]
    v_xor_b32 v30, 0, v28
    v_mfma_f32_16x16x32_bf16 v[76:79], a[168:171], a[40:43], v[76:79]
    v_lshl_add_u32 v10, v30, 5, v29
    v_xor_b32 v30, 1, v28
    v_mfma_f32_16x16x32_bf16 v[84:87], a[168:171], a[48:51], v[84:87]
    v_lshl_add_u32 v11, v30, 5, v29
    v_mfma_f32_16x16x32_bf16 v[84:87], a[172:175], a[52:55], v[84:87]
    v_xor_b32 v30, 2, v28
    v_lshl_add_u32 v12, v30, 5, v29
    v_mfma_f32_16x16x32_bf16 v[92:95], a[172:175], a[60:63], v[92:95]
    v_xor_b32 v30, 3, v28
    v_mfma_f32_16x16x32_bf16 v[92:95], a[168:171], a[56:59], v[92:95]
    v_lshl_add_u32 v13, v30, 5, v29
    s_lshl_b32 s40, s26, 12
    s_waitcnt lgkmcnt(0)
    v_mfma_f32_16x16x32_bf16 v[96:99], a[160:163], a[0:3], v[96:99]
    s_add_u32 m0, s33, 131072
    s_add_u32 s49, s49, 262144
    buffer_load_dwordx4 v6, s[20:23], s50 offen lds
    s_add_u32 s40, s40, 122880
    v_mfma_f32_16x16x32_bf16 v[96:99], a[164:167], a[4:7], v[96:99]
    ds_read_b128 a[168:171], v14 offset:6144
    v_add_u32 v8, s40, v27
    v_mfma_f32_16x16x32_bf16 v[104:107], a[164:167], a[12:15], v[104:107]
    v_mfma_f32_16x16x32_bf16 v[104:107], a[160:163], a[8:11], v[104:107]
    ds_read_b128 a[172:175], v15 offset:6144
    v_mfma_f32_16x16x32_bf16 v[112:115], a[160:163], a[16:19], v[112:115]
    v_mfma_f32_16x16x32_bf16 v[112:115], a[164:167], a[20:23], v[112:115]
    v_mfma_f32_16x16x32_bf16 v[120:123], a[164:167], a[28:31], v[120:123]
    v_cvt_pk_bf16_f32 v32, v32, v33
    v_cvt_pk_bf16_f32 v33, v34, v35
    v_mfma_f32_16x16x32_bf16 v[120:123], a[160:163], a[24:27], v[120:123]
    buffer_load_dwordx4 v7, s[20:23], s50 offen offset:1024 lds
    v_cvt_pk_bf16_f32 v34, v36, v37
    v_mfma_f32_16x16x32_bf16 v[128:131], a[160:163], a[32:35], v[128:131]
    v_cvt_pk_bf16_f32 v35, v38, v39
    v_mfma_f32_16x16x32_bf16 v[128:131], a[164:167], a[36:39], v[128:131]
    v_cvt_pk_bf16_f32 v40, v40, v41
    v_mfma_f32_16x16x32_bf16 v[136:139], a[164:167], a[44:47], v[136:139]
    v_cvt_pk_bf16_f32 v41, v42, v43
    v_mfma_f32_16x16x32_bf16 v[136:139], a[160:163], a[40:43], v[136:139]
    v_cvt_pk_bf16_f32 v42, v44, v45
    v_mfma_f32_16x16x32_bf16 v[144:147], a[160:163], a[48:51], v[144:147]
    v_cvt_pk_bf16_f32 v43, v46, v47
    s_cbranch_vccnz L_wt16
    buffer_store_dwordx4 v[32:35], v27, s[4:7], s60 offen offset:0
L_wr16:
    v_mfma_f32_16x16x32_bf16 v[144:147], a[164:167], a[52:55], v[144:147]
    v_cvt_pk_bf16_f32 v48, v48, v49
    v_cvt_pk_bf16_f32 v49, v50, v51
    v_mfma_f32_16x16x32_bf16 v[152:155], a[164:167], a[60:63], v[152:155]
    s_add_u32 m0, m0, 8192
    s_add_u32 s50, s50, 114688
    buffer_load_dwordx4 v27, s[4:7], s51 offen sc1 lds
    v_cvt_pk_bf16_f32 v50, v52, v53
    v_mfma_f32_16x16x32_bf16 v[152:155], a[160:163], a[56:59], v[152:155]
    v_cvt_pk_bf16_f32 v51, v54, v55
    s_waitcnt lgkmcnt(0)
    v_mfma_f32_16x16x32_bf16 v[100:103], a[168:171], a[0:3], v[100:103]
    v_cvt_pk_bf16_f32 v56, v56, v57
    s_cbranch_vccnz L_wt17
    buffer_store_dwordx4 v[40:43], v27, s[4:7], s60 offen offset:1024
L_wr17:
    v_mfma_f32_16x16x32_bf16 v[100:103], a[172:175], a[4:7], v[100:103]
    ds_read_b128 a[160:163], v14 offset:8192
    v_cvt_pk_bf16_f32 v57, v58, v59
    v_mfma_f32_16x16x32_bf16 v[108:111], a[172:175], a[12:15], v[108:111]
    v_cvt_pk_bf16_f32 v58, v60, v61
    v_mfma_f32_16x16x32_bf16 v[108:111], a[168:171], a[8:11], v[108:111]
    ds_read_b128 a[164:167], v15 offset:8192
    v_cvt_pk_bf16_f32 v59, v62, v63
    v_mfma_f32_16x16x32_bf16 v[116:119], a[168:171], a[16:19], v[116:119]
    v_cvt_pk_bf16_f32 v64, v64, v65
    v_cvt_pk_bf16_f32 v65, v66, v67
    s_cbranch_vccnz L_wt18
    buffer_store_dwordx4 v[48:51], v27, s[4:7], s60 offen offset:2048
L_wr18:
    v_mfma_f32_16x16x32_bf16 v[116:119], a[172:175], a[20:23], v[116:119]
    buffer_load_dwordx4 v27, s[4:7], s51 offen offset:1024 sc1 lds
    s_add_u32 s51, s51, 2048
    s_cmp_eq_u32 s49, 3670016
    s_cselect_b32 s49, 0, s49
    s_cselect_b32 s50, s61, s50
    s_cselect_b32 s51, s62, s51
    v_cvt_pk_bf16_f32 v66, v68, v69
    v_mfma_f32_16x16x32_bf16 v[124:127], a[172:175], a[28:31], v[124:127]
    v_cvt_pk_bf16_f32 v67, v70, v71
    v_mfma_f32_16x16x32_bf16 v[124:127], a[168:171], a[24:27], v[124:127]
    v_cvt_pk_bf16_f32 v72, v72, v73
    v_mfma_f32_16x16x32_bf16 v[132:135], a[168:171], a[32:35], v[132:135]
    v_cvt_pk_bf16_f32 v73, v74, v75
    s_cbranch_vccnz L_wt19
    buffer_store_dwordx4 v[56:59], v27, s[4:7], s60 offen offset:3072
L_wr19:
    s_add_u32 s60, s60, s96
    v_mfma_f32_16x16x32_bf16 v[132:135], a[172:175], a[36:39], v[132:135]
    v_cvt_pk_bf16_f32 v74, v76, v77
    v_mfma_f32_16x16x32_bf16 v[140:143], a[172:175], a[44:47], v[140:143]
    v_cvt_pk_bf16_f32 v75, v78, v79
    v_mfma_f32_16x16x32_bf16 v[140:143], a[168:171], a[40:43], v[140:143]
    v_cvt_pk_bf16_f32 v80, v80, v81
    v_cvt_pk_bf16_f32 v81, v82, v83
    v_mfma_f32_16x16x32_bf16 v[148:151], a[168:171], a[48:51], v[148:151]
    s_add_u32 m0, s32, 0
    s_nop 0
    buffer_load_dwordx4 v2, s[16:19], s49 offen lds
    v_cvt_pk_bf16_f32 v82, v84, v85
    s_cbranch_vccnz L_wt20
    buffer_store_dwordx4 v[64:67], v27, s[4:7], s60 offen offset:0
L_wr20:
    v_mfma_f32_16x16x32_bf16 v[148:151], a[172:175], a[52:55], v[148:151]
    v_cvt_pk_bf16_f32 v83, v86, v87
    v_mfma_f32_16x16x32_bf16 v[156:159], a[172:175], a[60:63], v[156:159]
    v_cvt_pk_bf16_f32 v88, v88, v89
    v_mfma_f32_16x16x32_bf16 v[156:159], a[168:171], a[56:59], v[156:159]
    v_cvt_pk_bf16_f32 v89, v90, v91
    s_waitcnt lgkmcnt(0)
    v_mfma_f32_16x16x32_bf16 v[160:163], a[160:163], a[0:3], v[160:163]
    v_cvt_pk_bf16_f32 v90, v92, v93
    s_cbranch_vccnz L_wt21
    buffer_store_dwordx4 v[72:75], v27, s[4:7], s60 offen offset:1024
L_wr21:
    v_mfma_f32_16x16x32_bf16 v[160:163], a[164:167], a[4:7], v[160:163]
    ds_read_b128 a[168:171], v14 offset:10240
    v_cvt_pk_bf16_f32 v91, v94, v95
    v_mfma_f32_16x16x32_bf16 v[168:171], a[164:167], a[12:15], v[168:171]
    v_mfma_f32_16x16x32_bf16 v[168:171], a[160:163], a[8:11], v[168:171]
    ds_read_b128 a[172:175], v15 offset:10240
    buffer_load_dwordx4 v3, s[16:19], s49 offen offset:1024 lds
    v_mfma_f32_16x16x32_bf16 v[176:179], a[160:163], a[16:19], v[176:179]
    v_mfma_f32_16x16x32_bf16 v[176:179], a[164:167], a[20:23], v[176:179]
    s_cbranch_vccnz L_wt22
    buffer_store_dwordx4 v[80:83], v27, s[4:7], s60 offen offset:2048
L_wr22:
    v_mfma_f32_16x16x32_bf16 v[184:187], a[164:167], a[28:31], v[184:187]
    v_cvt_pk_bf16_f32 v96, v96, v97
    v_cvt_pk_bf16_f32 v97, v98, v99
    v_mfma_f32_16x16x32_bf16 v[184:187], a[160:163], a[24:27], v[184:187]
    v_cvt_pk_bf16_f32 v98, v100, v101
    v_mfma_f32_16x16x32_bf16 v[192:195], a[160:163], a[32:35], v[192:195]
    v_cvt_pk_bf16_f32 v99, v102, v103
    v_mfma_f32_16x16x32_bf16 v[192:195], a[164:167], a[36:39], v[192:195]
    v_cvt_pk_bf16_f32 v104, v104, v105
    s_cbranch_vccnz L_wt23
    buffer_store_dwordx4 v[88:91], v27, s[4:7], s60 offen offset:3072
L_wr23:
    s_add_u32 s60, s60, s36
    v_mfma_f32_16x16x32_bf16 v[200:203], a[164:167], a[44:47], v[200:203]
    buffer_load_dwordx4 v4, s[16:19], s49 offen offset:2048 lds
    v_cvt_pk_bf16_f32 v105, v106, v107
    v_mfma_f32_16x16x32_bf16 v[200:203], a[160:163], a[40:43], v[200:203]
    v_cvt_pk_bf16_f32 v106, v108, v109
    v_mfma_f32_16x16x32_bf16 v[208:211], a[160:163], a[48:51], v[208:211]
    v_cvt_pk_bf16_f32 v107, v110, v111
    v_mfma_f32_16x16x32_bf16 v[208:211], a[164:167], a[52:55], v[208:211]
    v_cvt_pk_bf16_f32 v112, v112, v113
    v_cvt_pk_bf16_f32 v113, v114, v115
    s_cbranch_vccnz L_wt24
    buffer_store_dwordx4 v[96:99], v27, s[4:7], s60 offen offset:0
L_wr24:
    v_mfma_f32_16x16x32_bf16 v[216:219], a[164:167], a[60:63], v[216:219]
    v_cvt_pk_bf16_f32 v114, v116, v117
    v_mfma_f32_16x16x32_bf16 v[216:219], a[160:163], a[56:59], v[216:219]
    v_cvt_pk_bf16_f32 v115, v118, v119
    s_waitcnt lgkmcnt(0)
    v_mfma_f32_16x16x32_bf16 v[164:167], a[168:171], a[0:3], v[164:167]
    v_cvt_pk_bf16_f32 v120, v120, v121
    v_mfma_f32_16x16x32_bf16 v[164:167], a[172:175], a[4:7], v[164:167]
    ds_read_b128 a[160:163], v14 offset:12288
    buffer_load_dwordx4 v5, s[16:19], s49 offen offset:3072 lds
    v_cvt_pk_bf16_f32 v121, v122, v123
    v_mfma_f32_16x16x32_bf16 v[172:175], a[172:175], a[12:15], v[172:175]
    v_cvt_pk_bf16_f32 v122, v124, v125
    v_mfma_f32_16x16x32_bf16 v[172:175], a[168:171], a[8:11], v[172:175]
    ds_read_b128 a[164:167], v15 offset:12288
    v_cvt_pk_bf16_f32 v123, v126, v127
    s_cbranch_vccnz L_wt25
    buffer_store_dwordx4 v[104:107], v27, s[4:7], s60 offen offset:1024
L_wr25:
    v_mfma_f32_16x16x32_bf16 v[180:183], a[168:171], a[16:19], v[180:183]
    v_cvt_pk_bf16_f32 v128, v128, v129
    v_cvt_pk_bf16_f32 v129, v130, v131
    v_mfma_f32_16x16x32_bf16 v[180:183], a[172:175], a[20:23], v[180:183]
    v_cvt_pk_bf16_f32 v130, v132, v133
    v_mfma_f32_16x16x32_bf16 v[188:191], a[172:175], a[28:31], v[188:191]
    v_cvt_pk_bf16_f32 v131, v134, v135
    v_mfma_f32_16x16x32_bf16 v[188:191], a[168:171], a[24:27], v[188:191]
    v_cvt_pk_bf16_f32 v136, v136, v137
    v_mfma_f32_16x16x32_bf16 v[196:199], a[168:171], a[32:35], v[196:199]
    s_add_u32 m0, s33, 0
    s_add_u32 s49, s49, 262144
    buffer_load_dwordx4 v6, s[20:23], s50 offen lds
    v_cvt_pk_bf16_f32 v137, v138, v139
    v_mfma_f32_16x16x32_bf16 v[196:199], a[172:175], a[36:39], v[196:199]
    v_cvt_pk_bf16_f32 v138, v140, v141
    s_cbranch_vccnz L_wt26
    buffer_store_dwordx4 v[112:115], v27, s[4:7], s60 offen offset:2048
L_wr26:
    v_mfma_f32_16x16x32_bf16 v[204:207], a[172:175], a[44:47], v[204:207]
    v_cvt_pk_bf16_f32 v139, v142, v143
    v_mfma_f32_16x16x32_bf16 v[204:207], a[168:171], a[40:43], v[204:207]
    v_cvt_pk_bf16_f32 v144, v144, v145
    v_cvt_pk_bf16_f32 v145, v146, v147
    v_mfma_f32_16x16x32_bf16 v[212:215], a[168:171], a[48:51], v[212:215]
    v_cvt_pk_bf16_f32 v146, v148, v149
    v_mfma_f32_16x16x32_bf16 v[212:215], a[172:175], a[52:55], v[212:215]
    v_cvt_pk_bf16_f32 v147, v150, v151
    v_mfma_f32_16x16x32_bf16 v[220:223], a[172:175], a[60:63], v[220:223]
    v_cvt_pk_bf16_f32 v152, v152, v153
    v_mfma_f32_16x16x32_bf16 v[220:223], a[168:171], a[56:59], v[220:223]
    buffer_load_dwordx4 v7, s[20:23], s50 offen offset:1024 lds
    v_cvt_pk_bf16_f32 v153, v154, v155
    s_cbranch_vccnz L_wt27
    buffer_store_dwordx4 v[120:123], v27, s[4:7], s60 offen offset:3072
L_wr27:
    s_add_u32 s60, s60, s96
    s_waitcnt lgkmcnt(0)
    v_mfma_f32_16x16x32_bf16 v[224:227], a[160:163], a[0:3], v[224:227]
    v_cvt_pk_bf16_f32 v154, v156, v157
    v_mfma_f32_16x16x32_bf16 v[224:227], a[164:167], a[4:7], v[224:227]
    ds_read_b128 a[168:171], v14 offset:14336
    v_cvt_pk_bf16_f32 v155, v158, v159
    v_mfma_f32_16x16x32_bf16 v[232:235], a[164:167], a[12:15], v[232:235]
    v_mfma_f32_16x16x32_bf16 v[232:235], a[160:163], a[8:11], v[232:235]
    ds_read_b128 a[172:175], v15 offset:14336
    v_mfma_f32_16x16x32_bf16 v[240:243], a[160:163], a[16:19], v[240:243]
    v_mfma_f32_16x16x32_bf16 v[240:243], a[164:167], a[20:23], v[240:243]
    s_cbranch_vccnz L_wt28
    buffer_store_dwordx4 v[128:131], v27, s[4:7], s60 offen offset:0
L_wr28:
    v_mfma_f32_16x16x32_bf16 v[248:251], a[164:167], a[28:31], v[248:251]
    s_add_u32 m0, m0, 8192
    s_add_u32 s50, s50, 114688
    buffer_load_dwordx4 v27, s[4:7], s51 offen sc1 lds
    v_cvt_pk_bf16_f32 v160, v160, v161
    v_cvt_pk_bf16_f32 v161, v162, v163
    v_mfma_f32_16x16x32_bf16 v[248:251], a[160:163], a[24:27], v[248:251]
    v_cvt_pk_bf16_f32 v162, v164, v165
    v_mfma_f32_16x16x32_bf16 a[64:67], a[160:163], a[32:35], a[64:67]
    v_cvt_pk_bf16_f32 v163, v166, v167
    v_mfma_f32_16x16x32_bf16 a[64:67], a[164:167], a[36:39], a[64:67]
    v_cvt_pk_bf16_f32 v168, v168, v169
    v_mfma_f32_16x16x32_bf16 a[72:75], a[164:167], a[44:47], a[72:75]
    v_cvt_pk_bf16_f32 v169, v170, v171
    v_cvt_pk_bf16_f32 v170, v172, v173
    v_mfma_f32_16x16x32_bf16 a[72:75], a[160:163], a[40:43], a[72:75]
    v_cvt_pk_bf16_f32 v171, v174, v175
    s_cbranch_vccnz L_wt29
    buffer_store_dwordx4 v[136:139], v27, s[4:7], s60 offen offset:1024
L_wr29:
    v_mfma_f32_16x16x32_bf16 a[80:83], a[160:163], a[48:51], a[80:83]
    v_cvt_pk_bf16_f32 v176, v176, v177
    v_mfma_f32_16x16x32_bf16 a[80:83], a[164:167], a[52:55], a[80:83]
    buffer_load_dwordx4 v27, s[4:7], s51 offen offset:1024 sc1 lds
    s_add_u32 s51, s51, 2048
    s_cmp_eq_u32 s49, 3670016
    s_cselect_b32 s49, 0, s49
    s_cselect_b32 s50, s61, s50
    s_cselect_b32 s51, s62, s51
    v_cvt_pk_bf16_f32 v177, v178, v179
    v_mfma_f32_16x16x32_bf16 a[88:91], a[164:167], a[60:63], a[88:91]
    v_cvt_pk_bf16_f32 v178, v180, v181
    v_cvt_pk_bf16_f32 v179, v182, v183
    v_mfma_f32_16x16x32_bf16 a[88:91], a[160:163], a[56:59], a[88:91]
    v_cvt_pk_bf16_f32 v184, v184, v185
    s_waitcnt lgkmcnt(0)
    v_mfma_f32_16x16x32_bf16 v[228:231], a[168:171], a[0:3], v[228:231]
    v_cvt_pk_bf16_f32 v185, v186, v187
    v_mfma_f32_16x16x32_bf16 v[228:231], a[172:175], a[4:7], v[228:231]
    v_cvt_pk_bf16_f32 v186, v188, v189
    s_cbranch_vccnz L_wt30
    buffer_store_dwordx4 v[144:147], v27, s[4:7], s60 offen offset:2048
L_wr30:
    v_mfma_f32_16x16x32_bf16 v[236:239], a[172:175], a[12:15], v[236:239]
    v_cvt_pk_bf16_f32 v187, v190, v191
    v_mfma_f32_16x16x32_bf16 v[236:239], a[168:171], a[8:11], v[236:239]
    v_cvt_pk_bf16_f32 v192, v192, v193
    v_cvt_pk_bf16_f32 v193, v194, v195
    v_mfma_f32_16x16x32_bf16 v[244:247], a[168:171], a[16:19], v[244:247]
    v_cvt_pk_bf16_f32 v194, v196, v197
    v_mfma_f32_16x16x32_bf16 v[244:247], a[172:175], a[20:23], v[244:247]
    v_cvt_pk_bf16_f32 v195, v198, v199
    v_mfma_f32_16x16x32_bf16 v[252:255], a[172:175], a[28:31], v[252:255]
    v_cvt_pk_bf16_f32 v200, v200, v201
    v_mfma_f32_16x16x32_bf16 v[252:255], a[168:171], a[24:27], v[252:255]
    v_cvt_pk_bf16_f32 v201, v202, v203
    v_cvt_pk_bf16_f32 v202, v204, v205
    s_cbranch_vccnz L_wt31
    buffer_store_dwordx4 v[152:155], v27, s[4:7], s60 offen offset:3072
L_wr31:
    s_add_u32 s60, s60, s36
    v_mfma_f32_16x16x32_bf16 a[68:71], a[168:171], a[32:35], a[68:71]
    v_cvt_pk_bf16_f32 v203, v206, v207
    v_mfma_f32_16x16x32_bf16 a[68:71], a[172:175], a[36:39], a[68:71]
    v_cvt_pk_bf16_f32 v208, v208, v209
    v_mfma_f32_16x16x32_bf16 a[76:79], a[172:175], a[44:47], a[76:79]
    v_cvt_pk_bf16_f32 v209, v210, v211
    v_mfma_f32_16x16x32_bf16 a[76:79], a[168:171], a[40:43], a[76:79]
    v_cvt_pk_bf16_f32 v210, v212, v213
    v_cvt_pk_bf16_f32 v211, v214, v215
    v_mfma_f32_16x16x32_bf16 a[84:87], a[168:171], a[48:51], a[84:87]
    v_cvt_pk_bf16_f32 v216, v216, v217
    v_mfma_f32_16x16x32_bf16 a[84:87], a[172:175], a[52:55], a[84:87]
    v_cvt_pk_bf16_f32 v217, v218, v219
    v_mfma_f32_16x16x32_bf16 a[92:95], a[172:175], a[60:63], a[92:95]
    v_cvt_pk_bf16_f32 v218, v220, v221
    v_mfma_f32_16x16x32_bf16 a[92:95], a[168:171], a[56:59], a[92:95]
    v_cvt_pk_bf16_f32 v219, v222, v223
    s_branch L_gdone
L_hook:
    s_cmp_eq_u32 s43, 13
    s_cbranch_scc1 L_hpf
    s_cmp_lg_u32 s43, 2
    s_cbranch_scc1 L_h1
    v_lshrrev_b32 v28, 4, v1
    v_lshlrev_b32 v28, 3, v28
    s_lshl_b32 s40, s27, 1
    s_add_u32 s40, s40, s25
    s_lshl_b32 s40, s40, 7
    buffer_load_dwordx2 a[224:225], v28, s[20:23], s40 offen offset:0
    buffer_load_dwordx2 a[226:227], v28, s[20:23], s40 offen offset:32
    buffer_load_dwordx2 a[228:229], v28, s[20:23], s40 offen offset:64
    buffer_load_dwordx2 a[230:231], v28, s[20:23], s40 offen offset:96
    s_branch L_hret
L_h1:
    s_cmp_lg_u32 s24, 0
    s_cbranch_scc1 L_hret
    s_cmp_ge_u32 s43, 9
    s_cbranch_scc1 L_h2
    s_getreg_b32 s40, hwreg(HW_REG_XCC_ID, 0, 4)
    s_mul_i32 s41, s40, s40
    s_lshl_b32 s41, s41, 16
    s_lshl_b32 s40, s40, 6
    s_add_u32 s40, s40, s41
    s_add_u32 s40, s40, 1
    s_and_b32 s41, s2, 7
    s_lshl_b32 s41, s41, 5
    v_mov_b32 v28, s41
    v_mov_b32 v29, s40
    s_mov_b64 exec, 1
    global_atomic_add v28, v29, s[100:101]
    s_mov_b64 exec, -1
    s_branch L_hret
L_h2:
    v_and_b32 v28, 7, v1
    v_lshlrev_b32 v28, 5, v28
    s_cmp_eq_u32 s43, 9
    s_cbranch_scc0 L_h3
    global_load_dword v24, v28, s[100:101] sc1
    s_branch L_hret
L_h3:
    s_mov_b32 s3, 0
    s_waitcnt vmcnt(32)
L_pl1:
    v_and_b32 v24, 63, v24
    v_cmp_ne_u32 vcc, 32, v24
    s_add_u32 s3, s3, 1
    s_cbranch_vccz L_hret
    s_cmp_ge_u32 s3, 0x400000
    s_cbranch_scc1 L_hret
    s_sleep 1
    global_load_dword v24, v28, s[100:101] sc1
    s_waitcnt vmcnt(0)
    s_branch L_pl1
L_hpf:
    s_mov_b32 s20, s86
    s_and_b32 s21, s87, 0xffff
    s_mov_b32 s22, 1605632
    s_mov_b32 s23, 0x00020000
    s_and_b32 s41, s2, 7
    s_lshl_b32 s41, s41, 5
    v_mov_b32 v28, s41
    global_load_dword v25, v28, s[100:101] sc1
L_hret:
    s_cmp_eq_u32 s52, 0
    s_cbranch_scc1 L_loopK
    s_branch L_loopV
L_gdone:
    s_waitcnt vmcnt(32)
    s_barrier
    ds_read_b128 a[240:243], v8 offset:0
    ds_read_b128 a[244:247], v8 offset:1024
    ds_read_b128 a[248:251], v8 offset:2048
    ds_read_b128 a[252:255], v8 offset:3072
    v_add_u32 v26, 4096, v27
    ds_read_b64_tr_b16 a[224:225], v16
    ds_read_b64_tr_b16 a[226:227], v16 offset:2048
    ds_read_b64_tr_b16 a[228:229], v17
    ds_read_b64_tr_b16 a[230:231], v17 offset:2048
    ds_read_b64_tr_b16 a[232:233], v18
    ds_read_b64_tr_b16 a[234:235], v18 offset:2048
    s_add_u32 m0, s32, 32768
    s_nop 0
    buffer_load_dwordx4 v2, s[16:19], s49 offen lds
    buffer_load_dwordx4 v3, s[16:19], s49 offen offset:1024 lds
    s_waitcnt lgkmcnt(4)
    v_mfma_f32_16x16x32_bf16 a[0:3], a[224:227], a[240:243], 0
    ds_read_b64_tr_b16 a[236:237], v19
    ds_read_b64_tr_b16 a[238:239], v19 offset:2048
    v_mfma_f32_16x16x32_bf16 a[32:35], a[224:227], a[244:247], 0
    v_mfma_f32_16x16x32_bf16 a[160:163], a[224:227], a[248:251], 0
    buffer_load_dwordx4 v4, s[16:19], s49 offen offset:2048 lds
    v_mfma_f32_16x16x32_bf16 a[192:195], a[224:227], a[252:255], 0
    v_add_u32 v8, 0x8000, v8
    s_waitcnt lgkmcnt(4)
    v_mfma_f32_16x16x32_bf16 a[196:199], a[228:231], a[252:255], 0
    ds_read_b64_tr_b16 a[224:225], v20
    ds_read_b64_tr_b16 a[226:227], v20 offset:2048
    v_mfma_f32_16x16x32_bf16 a[164:167], a[228:231], a[248:251], 0
    v_cvt_pk_bf16_f32 v224, v224, v225
    v_cvt_pk_bf16_f32 v225, v226, v227
    v_mfma_f32_16x16x32_bf16 a[36:39], a[228:231], a[244:247], 0
    buffer_load_dwordx4 v5, s[16:19], s49 offen offset:3072 lds
    v_mfma_f32_16x16x32_bf16 a[4:7], a[228:231], a[240:243], 0
    v_add_u32 v16, 0x8000, v16
    v_add_u32 v19, 0x8000, v19
    s_waitcnt lgkmcnt(4)
    v_mfma_f32_16x16x32_bf16 a[8:11], a[232:235], a[240:243], 0
    ds_read_b64_tr_b16 a[228:229], v21
    ds_read_b64_tr_b16 a[230:231], v21 offset:2048
    v_mfma_f32_16x16x32_bf16 a[40:43], a[232:235], a[244:247], 0
    s_cbranch_vccnz L_wt32
    buffer_store_dwordx4 v[160:163], v27, s[4:7], s60 offen offset:0
L_wr32:
    v_mfma_f32_16x16x32_bf16 a[168:171], a[232:235], a[248:251], 0
    s_cbranch_vccnz L_wt33
    buffer_store_dwordx4 v[168:171], v27, s[4:7], s60 offen offset:1024
L_wr33:
    v_mfma_f32_16x16x32_bf16 a[200:203], a[232:235], a[252:255], 0
    v_add_u32 v17, 0x8000, v17
    v_add_u32 v20, 0x8000, v20
    s_waitcnt lgkmcnt(4)
    v_mfma_f32_16x16x32_bf16 a[204:207], a[236:239], a[252:255], 0
    ds_read_b64_tr_b16 a[232:233], v22
    ds_read_b64_tr_b16 a[234:235], v22 offset:2048
    v_mfma_f32_16x16x32_bf16 a[172:175], a[236:239], a[248:251], 0
    s_add_u32 m0, s33, 32768
    s_add_u32 s49, s49, 262144
    buffer_load_dwordx4 v6, s[20:23], s50 offen lds
    v_mfma_f32_16x16x32_bf16 a[44:47], a[236:239], a[244:247], 0
    v_cvt_pk_bf16_f32 v226, v228, v229
    v_mfma_f32_16x16x32_bf16 a[12:15], a[236:239], a[240:243], 0
    v_add_u32 v18, 0x8000, v18
    v_add_u32 v21, 0x8000, v21
    s_waitcnt lgkmcnt(4)
    v_mfma_f32_16x16x32_bf16 a[16:19], a[224:227], a[240:243], 0
    ds_read_b64_tr_b16 a[236:237], v23
    ds_read_b64_tr_b16 a[238:239], v23 offset:2048
    v_mfma_f32_16x16x32_bf16 a[48:51], a[224:227], a[244:247], 0
    v_cvt_pk_bf16_f32 v227, v230, v231
    v_mfma_f32_16x16x32_bf16 a[176:179], a[224:227], a[248:251], 0
    buffer_load_dwordx4 v7, s[20:23], s50 offen offset:1024 lds
    v_mfma_f32_16x16x32_bf16 a[208:211], a[224:227], a[252:255], 0
    v_add_u32 v22, 0x8000, v22
    s_waitcnt lgkmcnt(4)
    v_mfma_f32_16x16x32_bf16 a[212:215], a[228:231], a[252:255], 0
    ds_read_b64_tr_b16 a[224:225], v10
    ds_read_b64_tr_b16 a[226:227], v10 offset:1024
    v_mfma_f32_16x16x32_bf16 a[180:183], a[228:231], a[248:251], 0
    s_cbranch_vccnz L_wt34
    buffer_store_dwordx4 v[176:179], v27, s[4:7], s60 offen offset:2048
L_wr34:
    v_mfma_f32_16x16x32_bf16 a[52:55], a[228:231], a[244:247], 0
    v_cvt_pk_bf16_f32 v232, v232, v233
    v_cvt_pk_bf16_f32 v233, v234, v235
    v_mfma_f32_16x16x32_bf16 a[20:23], a[228:231], a[240:243], 0
    v_add_u32 v23, 0x8000, v23
    s_waitcnt lgkmcnt(4)
    v_mfma_f32_16x16x32_bf16 a[24:27], a[232:235], a[240:243], 0
    ds_read_b64_tr_b16 a[228:229], v11
    ds_read_b64_tr_b16 a[230:231], v11 offset:1024
    v_mfma_f32_16x16x32_bf16 a[56:59], a[232:235], a[244:247], 0
    s_add_u32 m0, m0, 8192
    s_add_u32 s50, s50, 114688
    buffer_load_dwordx4 v27, s[4:7], s51 offen sc1 lds
    v_mfma_f32_16x16x32_bf16 a[184:187], a[232:235], a[248:251], 0
    s_cbranch_vccnz L_wt35
    buffer_store_dwordx4 v[184:187], v27, s[4:7], s60 offen offset:3072
L_wr35:
    s_add_u32 s60, s60, s96
    v_mfma_f32_16x16x32_bf16 a[216:219], a[232:235], a[252:255], 0
    v_add_u32 v10, 0x8000, v10
    s_waitcnt lgkmcnt(4)
    v_mfma_f32_16x16x32_bf16 a[220:223], a[236:239], a[252:255], 0
    ds_read_b64_tr_b16 a[232:233], v12
    ds_read_b64_tr_b16 a[234:235], v12 offset:1024
    v_mfma_f32_16x16x32_bf16 a[188:191], a[236:239], a[248:251], 0
    v_cvt_pk_bf16_f32 v234, v236, v237
    v_cvt_pk_bf16_f32 v235, v238, v239
    v_mfma_f32_16x16x32_bf16 a[60:63], a[236:239], a[244:247], 0
    buffer_load_dwordx4 v27, s[4:7], s51 offen offset:1024 sc1 lds
    s_add_u32 s51, s51, 2048
    s_cmp_eq_u32 s49, 3670016
    s_cselect_b32 s49, 0, s49
    s_cselect_b32 s50, s61, s50
    s_cselect_b32 s51, s62, s51
    v_mfma_f32_16x16x32_bf16 a[28:31], a[236:239], a[240:243], 0
    v_add_u32 v11, 0x8000, v11
    s_waitcnt lgkmcnt(4)
    v_mfma_f32_16x16x32_bf16 a[96:99], a[224:227], a[240:243], a[96:99]
    ds_read_b64_tr_b16 a[236:237], v13
    ds_read_b64_tr_b16 a[238:239], v13 offset:1024
    v_mfma_f32_16x16x32_bf16 a[112:115], a[224:227], a[244:247], a[112:115]
    s_cbranch_vccnz L_wt36
    buffer_store_dwordx4 v[192:195], v27, s[4:7], s60 offen offset:0
L_wr36:
    v_mfma_f32_16x16x32_bf16 a[128:131], a[224:227], a[248:251], a[128:131]
    s_waitcnt vmcnt(34)
    s_barrier
    v_mfma_f32_16x16x32_bf16 a[144:147], a[224:227], a[252:255], a[144:147]
    ds_read_b128 v[32:35], v8 offset:0
    v_add_u32 v12, 0x8000, v12
    s_waitcnt lgkmcnt(5)
    v_mfma_f32_16x16x32_bf16 a[148:151], a[228:231], a[252:255], a[148:151]
    ds_read_b64_tr_b16 a[224:225], v16
    ds_read_b64_tr_b16 a[226:227], v16 offset:2048
    v_mfma_f32_16x16x32_bf16 a[132:135], a[228:231], a[248:251], a[132:135]
    ds_read_b128 v[36:39], v8 offset:1024
    ds_read_b128 v[40:43], v8 offset:2048
    v_mfma_f32_16x16x32_bf16 a[116:119], a[228:231], a[244:247], a[116:119]
    ds_read_b128 v[44:47], v8 offset:3072
    v_cvt_pk_bf16_f32 v240, v240, v241
    v_mfma_f32_16x16x32_bf16 a[100:103], a[228:231], a[240:243], a[100:103]
    v_add_u32 v13, 0x8000, v13
    s_waitcnt lgkmcnt(8)
    v_mfma_f32_16x16x32_bf16 a[104:107], a[232:235], a[240:243], a[104:107]
    ds_read_b64_tr_b16 a[228:229], v17
    ds_read_b64_tr_b16 a[230:231], v17 offset:2048
    v_mfma_f32_16x16x32_bf16 a[120:123], a[232:235], a[244:247], a[120:123]
    s_add_u32 m0, s32, 65536
    s_nop 0
    buffer_load_dwordx4 v2, s[16:19], s49 offen lds
    v_mfma_f32_16x16x32_bf16 a[136:139], a[232:235], a[248:251], a[136:139]
    v_cvt_pk_bf16_f32 v241, v242, v243
    s_cbranch_vccnz L_wt37
    buffer_store_dwordx4 v[200:203], v27, s[4:7], s60 offen offset:1024
L_wr37:
    v_mfma_f32_16x16x32_bf16 a[152:155], a[232:235], a[252:255], a[152:155]
    v_cvt_pk_bf16_f32 v242, v244, v245
    s_waitcnt lgkmcnt(8)
    v_mfma_f32_16x16x32_bf16 a[156:159], a[236:239], a[252:255], a[156:159]
    ds_read_b64_tr_b16 a[232:233], v18
    ds_read_b64_tr_b16 a[234:235], v18 offset:2048
    v_mfma_f32_16x16x32_bf16 a[140:143], a[236:239], a[248:251], a[140:143]
    v_cvt_pk_bf16_f32 v243, v246, v247
    v_mfma_f32_16x16x32_bf16 a[124:127], a[236:239], a[244:247], a[124:127]
    buffer_load_dwordx4 v3, s[16:19], s49 offen offset:1024 lds
    v_mfma_f32_16x16x32_bf16 a[108:111], a[236:239], a[240:243], a[108:111]
    s_waitcnt lgkmcnt(7)
    s_waitcnt lgkmcnt(4)
    v_mfma_f32_16x16x32_bf16 a[0:3], a[224:227], v[32:35], a[0:3]
    ds_read_b64_tr_b16 a[236:237], v19
    ds_read_b64_tr_b16 a[238:239], v19 offset:2048
    v_mfma_f32_16x16x32_bf16 a[32:35], a[224:227], v[36:39], a[32:35]
    s_cbranch_vccnz L_wt38
    buffer_store_dwordx4 v[208:211], v27, s[4:7], s60 offen offset:2048
L_wr38:
    v_mfma_f32_16x16x32_bf16 a[160:163], a[224:227], v[40:43], a[160:163]
    buffer_load_dwordx4 v4, s[16:19], s49 offen offset:2048 lds
    v_mfma_f32_16x16x32_bf16 a[192:195], a[224:227], v[44:47], a[192:195]
    v_add_u32 v8, 0xfffe0000, v8
    s_waitcnt lgkmcnt(4)
    v_mfma_f32_16x16x32_bf16 a[196:199], a[228:231], v[44:47], a[196:199]
    ds_read_b64_tr_b16 a[224:225], v20
    ds_read_b64_tr_b16 a[226:227], v20 offset:2048
    v_mfma_f32_16x16x32_bf16 a[164:167], a[228:231], v[40:43], a[164:167]
    v_cvt_pk_bf16_f32 v248, v248, v249
    v_cvt_pk_bf16_f32 v249, v250, v251
    v_cvt_pk_bf16_f32 v250, v252, v253
    v_mfma_f32_16x16x32_bf16 a[36:39], a[228:231], v[36:39], a[36:39]
    buffer_load_dwordx4 v5, s[16:19], s49 offen offset:3072 lds
    v_mfma_f32_16x16x32_bf16 a[4:7], a[228:231], v[32:35], a[4:7]
    v_add_u32 v16, 0xfffe0000, v16
    v_add_u32 v19, 0xfffe0000, v19
    s_waitcnt lgkmcnt(4)
    v_mfma_f32_16x16x32_bf16 a[8:11], a[232:235], v[32:35], a[8:11]
    ds_read_b64_tr_b16 a[228:229], v21
    ds_read_b64_tr_b16 a[230:231], v21 offset:2048
    v_mfma_f32_16x16x32_bf16 a[40:43], a[232:235], v[36:39], a[40:43]
    v_cvt_pk_bf16_f32 v251, v254, v255
    v_mfma_f32_16x16x32_bf16 a[168:171], a[232:235], v[40:43], a[168:171]
    s_cbranch_vccnz L_wt39
    buffer_store_dwordx4 v[216:219], v27, s[4:7], s60 offen offset:3072
L_wr39:
    s_add_u32 s60, s60, s36
    v_mfma_f32_16x16x32_bf16 a[200:203], a[232:235], v[44:47], a[200:203]
    v_add_u32 v17, 0xfffe0000, v17
    v_add_u32 v20, 0xfffe0000, v20
    s_waitcnt lgkmcnt(4)
    v_mfma_f32_16x16x32_bf16 a[204:207], a[236:239], v[44:47], a[204:207]
    ds_read_b64_tr_b16 a[232:233], v22
    ds_read_b64_tr_b16 a[234:235], v22 offset:2048
    v_accvgpr_read_b32 v48, a64
    v_mfma_f32_16x16x32_bf16 a[172:175], a[236:239], v[40:43], a[172:175]
    s_add_u32 m0, s33, 65536
    s_add_u32 s49, s49, 262144
    buffer_load_dwordx4 v6, s[20:23], s50 offen lds
    v_mfma_f32_16x16x32_bf16 a[44:47], a[236:239], v[36:39], a[44:47]
    v_accvgpr_read_b32 v49, a65
    v_accvgpr_read_b32 v50, a66
    v_mfma_f32_16x16x32_bf16 a[12:15], a[236:239], v[32:35], a[12:15]
    v_add_u32 v18, 0xfffe0000, v18
    v_add_u32 v21, 0xfffe0000, v21
    s_waitcnt lgkmcnt(4)
    v_mfma_f32_16x16x32_bf16 a[16:19], a[224:227], v[32:35], a[16:19]
    ds_read_b64_tr_b16 a[236:237], v23
    ds_read_b64_tr_b16 a[238:239], v23 offset:2048
    v_mfma_f32_16x16x32_bf16 a[48:51], a[224:227], v[36:39], a[48:51]
    v_accvgpr_read_b32 v51, a67
    v_accvgpr_read_b32 v52, a68
    v_accvgpr_read_b32 v53, a69
    v_mfma_f32_16x16x32_bf16 a[176:179], a[224:227], v[40:43], a[176:179]
    buffer_load_dwordx4 v7, s[20:23], s50 offen offset:1024 lds
    v_mfma_f32_16x16x32_bf16 a[208:211], a[224:227], v[44:47], a[208:211]
    v_add_u32 v22, 0xfffe0000, v22
    s_waitcnt lgkmcnt(4)
    v_mfma_f32_16x16x32_bf16 a[212:215], a[228:231], v[44:47], a[212:215]
    ds_read_b64_tr_b16 a[224:225], v10
    ds_read_b64_tr_b16 a[226:227], v10 offset:1024
    v_mfma_f32_16x16x32_bf16 a[180:183], a[228:231], v[40:43], a[180:183]
    s_cbranch_vccnz L_wt40
    buffer_store_dwordx4 v[224:227], v27, s[4:7], s60 offen offset:0
L_wr40:
    v_mfma_f32_16x16x32_bf16 a[52:55], a[228:231], v[36:39], a[52:55]
    v_accvgpr_read_b32 v54, a70
    v_accvgpr_read_b32 v55, a71
    v_cvt_pk_bf16_f32 v48, v48, v49
    v_mfma_f32_16x16x32_bf16 a[20:23], a[228:231], v[32:35], a[20:23]
    v_add_u32 v23, 0xfffe0000, v23
    s_waitcnt lgkmcnt(4)
    v_mfma_f32_16x16x32_bf16 a[24:27], a[232:235], v[32:35], a[24:27]
    ds_read_b64_tr_b16 a[228:229], v11
    ds_read_b64_tr_b16 a[230:231], v11 offset:1024
    v_mfma_f32_16x16x32_bf16 a[56:59], a[232:235], v[36:39], a[56:59]
    s_add_u32 m0, m0, 8192
    s_add_u32 s50, s50, 114688
    buffer_load_dwordx4 v27, s[4:7], s51 offen sc1 lds
    v_mfma_f32_16x16x32_bf16 a[184:187], a[232:235], v[40:43], a[184:187]
    v_cvt_pk_bf16_f32 v49, v50, v51
    v_cvt_pk_bf16_f32 v50, v52, v53
    v_mfma_f32_16x16x32_bf16 a[216:219], a[232:235], v[44:47], a[216:219]
    v_add_u32 v10, 0xfffe0000, v10
    s_waitcnt lgkmcnt(4)
    v_mfma_f32_16x16x32_bf16 a[220:223], a[236:239], v[44:47], a[220:223]
    ds_read_b64_tr_b16 a[232:233], v12
    ds_read_b64_tr_b16 a[234:235], v12 offset:1024
    v_mfma_f32_16x16x32_bf16 a[188:191], a[236:239], v[40:43], a[188:191]
    v_cvt_pk_bf16_f32 v51, v54, v55
    s_cbranch_vccnz L_wt41
    buffer_store_dwordx4 v[232:235], v27, s[4:7], s60 offen offset:1024
L_wr41:
    v_mfma_f32_16x16x32_bf16 a[60:63], a[236:239], v[36:39], a[60:63]
    buffer_load_dwordx4 v27, s[4:7], s51 offen offset:1024 sc1 lds
    s_add_u32 s51, s51, 2048
    s_cmp_eq_u32 s49, 3670016
    s_cselect_b32 s49, 0, s49
    s_cselect_b32 s50, s61, s50
    s_cselect_b32 s51, s62, s51
    v_mfma_f32_16x16x32_bf16 a[28:31], a[236:239], v[32:35], a[28:31]
    v_add_u32 v11, 0xfffe0000, v11
    s_waitcnt lgkmcnt(4)
    v_mfma_f32_16x16x32_bf16 a[96:99], a[224:227], v[32:35], a[96:99]
    ds_read_b64_tr_b16 a[236:237], v13
    ds_read_b64_tr_b16 a[238:239], v13 offset:1024
    v_mfma_f32_16x16x32_bf16 a[112:115], a[224:227], v[36:39], a[112:115]
    v_accvgpr_read_b32 v56, a72
    v_accvgpr_read_b32 v57, a73
    v_accvgpr_read_b32 v58, a74
    v_mfma_f32_16x16x32_bf16 a[128:131], a[224:227], v[40:43], a[128:131]
    s_waitcnt vmcnt(28)
    s_barrier
    v_accvgpr_read_b32 v59, a75
    v_mfma_f32_16x16x32_bf16 a[144:147], a[224:227], v[44:47], a[144:147]
    ds_read_b128 a[240:243], v8 offset:0
    v_add_u32 v12, 0xfffe0000, v12
    s_waitcnt lgkmcnt(5)
    v_mfma_f32_16x16x32_bf16 a[148:151], a[228:231], v[44:47], a[148:151]
    ds_read_b64_tr_b16 a[224:225], v16
    ds_read_b64_tr_b16 a[226:227], v16 offset:2048
    v_mfma_f32_16x16x32_bf16 a[132:135], a[228:231], v[40:43], a[132:135]
    ds_read_b128 a[244:247], v8 offset:1024
    ds_read_b128 a[248:251], v8 offset:2048
    v_mfma_f32_16x16x32_bf16 a[116:119], a[228:231], v[36:39], a[116:119]
    ds_read_b128 a[252:255], v8 offset:3072
    v_accvgpr_read_b32 v60, a76
    v_accvgpr_read_b32 v61, a77
    v_mfma_f32_16x16x32_bf16 a[100:103], a[228:231], v[32:35], a[100:103]
    v_add_u32 v13, 0xfffe0000, v13
    s_cbranch_vccnz L_wt42
    buffer_store_dwordx4 v[240:243], v27, s[4:7], s60 offen offset:2048
L_wr42:
    s_waitcnt lgkmcnt(8)
    v_mfma_f32_16x16x32_bf16 a[104:107], a[232:235], v[32:35], a[104:107]
    ds_read_b64_tr_b16 a[228:229], v17
    ds_read_b64_tr_b16 a[230:231], v17 offset:2048
    v_mfma_f32_16x16x32_bf16 a[120:123], a[232:235], v[36:39], a[120:123]
    s_add_u32 m0, s32, 98304
    s_nop 0
    buffer_load_dwordx4 v2, s[16:19], s49 offen lds
    v_mfma_f32_16x16x32_bf16 a[136:139], a[232:235], v[40:43], a[136:139]
    v_accvgpr_read_b32 v62, a78
    v_accvgpr_read_b32 v63, a79
    v_mfma_f32_16x16x32_bf16 a[152:155], a[232:235], v[44:47], a[152:155]
    v_cvt_pk_bf16_f32 v56, v56, v57
    s_waitcnt lgkmcnt(8)
    v_mfma_f32_16x16x32_bf16 a[156:159], a[236:239], v[44:47], a[156:159]
    ds_read_b64_tr_b16 a[232:233], v18
    ds_read_b64_tr_b16 a[234:235], v18 offset:2048
    v_mfma_f32_16x16x32_bf16 a[140:143], a[236:239], v[40:43], a[140:143]
    v_cvt_pk_bf16_f32 v57, v58, v59
    v_cvt_pk_bf16_f32 v58, v60, v61
    v_mfma_f32_16x16x32_bf16 a[124:127], a[236:239], v[36:39], a[124:127]
    buffer_load_dwordx4 v3, s[16:19], s49 offen offset:1024 lds
    v_mfma_f32_16x16x32_bf16 a[108:111], a[236:239], v[32:35], a[108:111]
    v_cvt_pk_bf16_f32 v59, v62, v63
    s_waitcnt lgkmcnt(7)
    s_waitcnt lgkmcnt(4)
    v_mfma_f32_16x16x32_bf16 a[0:3], a[224:227], a[240:243], a[0:3]
    ds_read_b64_tr_b16 a[236:237], v19
    ds_read_b64_tr_b16 a[238:239], v19 offset:2048
    v_mfma_f32_16x16x32_bf16 a[32:35], a[224:227], a[244:247], a[32:35]
    s_cbranch_vccnz L_wt43
    buffer_store_dwordx4 v[248:251], v27, s[4:7], s60 offen offset:3072
L_wr43:
    s_add_u32 s60, s60, s96
    v_mfma_f32_16x16x32_bf16 a[160:163], a[224:227], a[248:251], a[160:163]
    buffer_load_dwordx4 v4, s[16:19], s49 offen offset:2048 lds
    v_mfma_f32_16x16x32_bf16 a[192:195], a[224:227], a[252:255], a[192:195]
    v_add_u32 v8, 0x8000, v8
    s_waitcnt lgkmcnt(4)
    v_mfma_f32_16x16x32_bf16 a[196:199], a[228:231], a[252:255], a[196:199]
    ds_read_b64_tr_b16 a[224:225], v20
    ds_read_b64_tr_b16 a[226:227], v20 offset:2048
    v_mfma_f32_16x16x32_bf16 a[164:167], a[228:231], a[248:251], a[164:167]
    v_accvgpr_read_b32 v64, a80
    v_accvgpr_read_b32 v65, a81
    v_accvgpr_read_b32 v66, a82
    v_mfma_f32_16x16x32_bf16 a[36:39], a[228:231], a[244:247], a[36:39]
    buffer_load_dwordx4 v5, s[16:19], s49 offen offset:3072 lds
    v_mfma_f32_16x16x32_bf16 a[4:7], a[228:231], a[240:243], a[4:7]
    v_add_u32 v16, 0x8000, v16
    v_add_u32 v19, 0x8000, v19
    s_waitcnt lgkmcnt(4)
    v_mfma_f32_16x16x32_bf16 a[8:11], a[232:235], a[240:243], a[8:11]
    ds_read_b64_tr_b16 a[228:229], v21
    ds_read_b64_tr_b16 a[230:231], v21 offset:2048
    v_mfma_f32_16x16x32_bf16 a[40:43], a[232:235], a[244:247], a[40:43]
    v_accvgpr_read_b32 v67, a83
    v_accvgpr_read_b32 v68, a84
    v_mfma_f32_16x16x32_bf16 a[168:171], a[232:235], a[248:251], a[168:171]
    v_accvgpr_read_b32 v69, a85
    v_mfma_f32_16x16x32_bf16 a[200:203], a[232:235], a[252:255], a[200:203]
    v_add_u32 v17, 0x8000, v17
    v_add_u32 v20, 0x8000, v20
    s_waitcnt lgkmcnt(4)
    v_mfma_f32_16x16x32_bf16 a[204:207], a[236:239], a[252:255], a[204:207]
    ds_read_b64_tr_b16 a[232:233], v22
    ds_read_b64_tr_b16 a[234:235], v22 offset:2048
    v_mfma_f32_16x16x32_bf16 a[172:175], a[236:239], a[248:251], a[172:175]
    s_add_u32 m0, s33, 98304
    s_add_u32 s49, s49, 262144
    buffer_load_dwordx4 v6, s[20:23], s50 offen lds
    v_mfma_f32_16x16x32_bf16 a[44:47], a[236:239], a[244:247], a[44:47]
    s_cbranch_vccnz L_wt44
    buffer_store_dwordx4 v[48:51], v27, s[4:7], s60 offen offset:0
L_wr44:
    v_mfma_f32_16x16x32_bf16 a[12:15], a[236:239], a[240:243], a[12:15]
    v_add_u32 v18, 0x8000, v18
    v_add_u32 v21, 0x8000, v21
    s_waitcnt lgkmcnt(4)
    v_mfma_f32_16x16x32_bf16 a[16:19], a[224:227], a[240:243], a[16:19]
    ds_read_b64_tr_b16 a[236:237], v23
    ds_read_b64_tr_b16 a[238:239], v23 offset:2048
    v_mfma_f32_16x16x32_bf16 a[48:51], a[224:227], a[244:247], a[48:51]
    v_accvgpr_read_b32 v70, a86
    v_accvgpr_read_b32 v71, a87
    v_cvt_pk_bf16_f32 v64, v64, v65
    v_mfma_f32_16x16x32_bf16 a[176:179], a[224:227], a[248:251], a[176:179]
    buffer_load_dwordx4 v7, s[20:23], s50 offen offset:1024 lds
    v_mfma_f32_16x16x32_bf16 a[208:211], a[224:227], a[252:255], a[208:211]
    v_add_u32 v22, 0x8000, v22
    s_waitcnt lgkmcnt(4)
    v_mfma_f32_16x16x32_bf16 a[212:215], a[228:231], a[252:255], a[212:215]
    ds_read_b64_tr_b16 a[224:225], v10
    ds_read_b64_tr_b16 a[226:227], v10 offset:1024
    v_mfma_f32_16x16x32_bf16 a[180:183], a[228:231], a[248:251], a[180:183]
    v_cvt_pk_bf16_f32 v65, v66, v67
    v_cvt_pk_bf16_f32 v66, v68, v69
    v_mfma_f32_16x16x32_bf16 a[52:55], a[228:231], a[244:247], a[52:55]
    v_cvt_pk_bf16_f32 v67, v70, v71
    v_mfma_f32_16x16x32_bf16 a[20:23], a[228:231], a[240:243], a[20:23]
    v_add_u32 v23, 0x8000, v23
    s_waitcnt lgkmcnt(4)
    v_mfma_f32_16x16x32_bf16 a[24:27], a[232:235], a[240:243], a[24:27]
    ds_read_b64_tr_b16 a[228:229], v11
    ds_read_b64_tr_b16 a[230:231], v11 offset:1024
    v_mfma_f32_16x16x32_bf16 a[56:59], a[232:235], a[244:247], a[56:59]
    s_add_u32 m0, m0, 8192
    s_add_u32 s50, s50, 114688
    buffer_load_dwordx4 v27, s[4:7], s51 offen sc1 lds
    v_mfma_f32_16x16x32_bf16 a[184:187], a[232:235], a[248:251], a[184:187]
    s_cbranch_vccnz L_wt45
    buffer_store_dwordx4 v[56:59], v27, s[4:7], s60 offen offset:1024
L_wr45:
    v_mfma_f32_16x16x32_bf16 a[216:219], a[232:235], a[252:255], a[216:219]
    v_add_u32 v10, 0x8000, v10
    v_accvgpr_read_b32 v72, a88
    s_waitcnt lgkmcnt(4)
    v_mfma_f32_16x16x32_bf16 a[220:223], a[236:239], a[252:255], a[220:223]
    ds_read_b64_tr_b16 a[232:233], v12
    ds_read_b64_tr_b16 a[234:235], v12 offset:1024
    v_mfma_f32_16x16x32_bf16 a[188:191], a[236:239], a[248:251], a[188:191]
    v_accvgpr_read_b32 v73, a89
    v_accvgpr_read_b32 v74, a90
    v_mfma_f32_16x16x32_bf16 a[60:63], a[236:239], a[244:247], a[60:63]
    buffer_load_dwordx4 v27, s[4:7], s51 offen offset:1024 sc1 lds
    s_add_u32 s51, s51, 2048
    s_cmp_eq_u32 s49, 3670016
    s_cselect_b32 s49, 0, s49
    s_cselect_b32 s50, s61, s50
    s_cselect_b32 s51, s62, s51
    v_mfma_f32_16x16x32_bf16 a[28:31], a[236:239], a[240:243], a[28:31]
    v_add_u32 v11, 0x8000, v11
    s_waitcnt lgkmcnt(4)
    v_mfma_f32_16x16x32_bf16 a[96:99], a[224:227], a[240:243], a[96:99]
    ds_read_b64_tr_b16 a[236:237], v13
    ds_read_b64_tr_b16 a[238:239], v13 offset:1024
    v_mfma_f32_16x16x32_bf16 a[112:115], a[224:227], a[244:247], a[112:115]
    v_accvgpr_read_b32 v75, a91
    v_accvgpr_read_b32 v76, a92
    v_accvgpr_read_b32 v77, a93
    v_mfma_f32_16x16x32_bf16 a[128:131], a[224:227], a[248:251], a[128:131]
    s_waitcnt vmcnt(26)
    s_barrier
    v_mfma_f32_16x16x32_bf16 a[144:147], a[224:227], a[252:255], a[144:147]
    ds_read_b128 v[32:35], v8 offset:0
    v_add_u32 v12, 0x8000, v12
    s_waitcnt lgkmcnt(5)
    v_mfma_f32_16x16x32_bf16 a[148:151], a[228:231], a[252:255], a[148:151]
    ds_read_b64_tr_b16 a[224:225], v16
    ds_read_b64_tr_b16 a[226:227], v16 offset:2048
    v_mfma_f32_16x16x32_bf16 a[132:135], a[228:231], a[248:251], a[132:135]
    ds_read_b128 v[36:39], v8 offset:1024
    ds_read_b128 v[40:43], v8 offset:2048
    v_mfma_f32_16x16x32_bf16 a[116:119], a[228:231], a[244:247], a[116:119]
    ds_read_b128 v[44:47], v8 offset:3072
    s_cbranch_vccnz L_wt46
    buffer_store_dwordx4 v[64:67], v27, s[4:7], s60 offen offset:2048
L_wr46:
    v_mfma_f32_16x16x32_bf16 a[100:103], a[228:231], a[240:243], a[100:103]
    v_add_u32 v13, 0x8000, v13
    v_accvgpr_read_b32 v78, a94
    s_waitcnt lgkmcnt(8)
    v_mfma_f32_16x16x32_bf16 a[104:107], a[232:235], a[240:243], a[104:107]
    ds_read_b64_tr_b16 a[228:229], v17
    ds_read_b64_tr_b16 a[230:231], v17 offset:2048
    v_mfma_f32_16x16x32_bf16 a[120:123], a[232:235], a[244:247], a[120:123]
    s_add_u32 m0, s32, 131072
    s_nop 0
    buffer_load_dwordx4 v2, s[16:19], s49 offen lds
    v_mfma_f32_16x16x32_bf16 a[136:139], a[232:235], a[248:251], a[136:139]
    v_accvgpr_read_b32 v79, a95
    v_cvt_pk_bf16_f32 v72, v72, v73
    v_mfma_f32_16x16x32_bf16 a[152:155], a[232:235], a[252:255], a[152:155]
    v_cvt_pk_bf16_f32 v73, v74, v75
    s_waitcnt lgkmcnt(8)
    v_mfma_f32_16x16x32_bf16 a[156:159], a[236:239], a[252:255], a[156:159]
    ds_read_b64_tr_b16 a[232:233], v18
    ds_read_b64_tr_b16 a[234:235], v18 offset:2048
    v_mfma_f32_16x16x32_bf16 a[140:143], a[236:239], a[248:251], a[140:143]
    v_cvt_pk_bf16_f32 v74, v76, v77
    v_cvt_pk_bf16_f32 v75, v78, v79
    v_mfma_f32_16x16x32_bf16 a[124:127], a[236:239], a[244:247], a[124:127]
    buffer_load_dwordx4 v3, s[16:19], s49 offen offset:1024 lds
    v_mfma_f32_16x16x32_bf16 a[108:111], a[236:239], a[240:243], a[108:111]
    s_cbranch_vccnz L_wt47
    buffer_store_dwordx4 v[72:75], v27, s[4:7], s60 offen offset:3072
L_wr47:
    s_add_u32 s60, s60, s36
    s_waitcnt lgkmcnt(7)
    s_waitcnt lgkmcnt(4)
    v_mfma_f32_16x16x32_bf16 a[0:3], a[224:227], v[32:35], a[0:3]
    ds_read_b64_tr_b16 a[236:237], v19
    ds_read_b64_tr_b16 a[238:239], v19 offset:2048
    v_mfma_f32_16x16x32_bf16 a[32:35], a[224:227], v[36:39], a[32:35]
    buffer_load_dwordx4 v4, s[16:19], s49 offen offset:2048 lds
    v_mfma_f32_16x16x32_bf16 a[160:163], a[224:227], v[40:43], a[160:163]
    v_mfma_f32_16x16x32_bf16 a[192:195], a[224:227], v[44:47], a[192:195]
    v_add_u32 v8, 0x8000, v8
    s_waitcnt lgkmcnt(4)
    v_mfma_f32_16x16x32_bf16 a[196:199], a[228:231], v[44:47], a[196:199]
    ds_read_b64_tr_b16 a[224:225], v20
    ds_read_b64_tr_b16 a[226:227], v20 offset:2048
    v_mfma_f32_16x16x32_bf16 a[164:167], a[228:231], v[40:43], a[164:167]
    buffer_load_dwordx4 v5, s[16:19], s49 offen offset:3072 lds
    v_mfma_f32_16x16x32_bf16 a[36:39], a[228:231], v[36:39], a[36:39]
    v_mfma_f32_16x16x32_bf16 a[4:7], a[228:231], v[32:35], a[4:7]
    v_add_u32 v16, 0x8000, v16
    v_add_u32 v19, 0x8000, v19
    s_waitcnt lgkmcnt(4)
    v_mfma_f32_16x16x32_bf16 a[8:11], a[232:235], v[32:35], a[8:11]
    ds_read_b64_tr_b16 a[228:229], v21
    ds_read_b64_tr_b16 a[230:231], v21 offset:2048
    v_mfma_f32_16x16x32_bf16 a[40:43], a[232:235], v[36:39], a[40:43]
    s_add_u32 m0, s33, 131072
    s_add_u32 s49, s49, 262144
    buffer_load_dwordx4 v6, s[20:23], s50 offen lds
    v_mfma_f32_16x16x32_bf16 a[168:171], a[232:235], v[40:43], a[168:171]
    v_mfma_f32_16x16x32_bf16 a[200:203], a[232:235], v[44:47], a[200:203]
    v_add_u32 v17, 0x8000, v17
    v_add_u32 v20, 0x8000, v20
    s_waitcnt lgkmcnt(4)
    v_mfma_f32_16x16x32_bf16 a[204:207], a[236:239], v[44:47], a[204:207]
    ds_read_b64_tr_b16 a[232:233], v22
    ds_read_b64_tr_b16 a[234:235], v22 offset:2048
    v_mfma_f32_16x16x32_bf16 a[172:175], a[236:239], v[40:43], a[172:175]
    buffer_load_dwordx4 v7, s[20:23], s50 offen offset:1024 lds
    v_mfma_f32_16x16x32_bf16 a[44:47], a[236:239], v[36:39], a[44:47]
    v_mfma_f32_16x16x32_bf16 a[12:15], a[236:239], v[32:35], a[12:15]
    v_add_u32 v18, 0x8000, v18
    v_add_u32 v21, 0x8000, v21
    s_waitcnt lgkmcnt(4)
    v_mfma_f32_16x16x32_bf16 a[16:19], a[224:227], v[32:35], a[16:19]
    ds_read_b64_tr_b16 a[236:237], v23
    ds_read_b64_tr_b16 a[238:239], v23 offset:2048
    v_mfma_f32_16x16x32_bf16 a[48:51], a[224:227], v[36:39], a[48:51]
    s_add_u32 m0, m0, 8192
    s_add_u32 s50, s50, 114688
    buffer_load_dwordx4 v27, s[4:7], s51 offen sc1 lds
    v_mfma_f32_16x16x32_bf16 a[176:179], a[224:227], v[40:43], a[176:179]
    v_mfma_f32_16x16x32_bf16 a[208:211], a[224:227], v[44:47], a[208:211]
    v_add_u32 v22, 0x8000, v22
    s_waitcnt lgkmcnt(4)
    v_mfma_f32_16x16x32_bf16 a[212:215], a[228:231], v[44:47], a[212:215]
    ds_read_b64_tr_b16 a[224:225], v10
    ds_read_b64_tr_b16 a[226:227], v10 offset:1024
    v_mfma_f32_16x16x32_bf16 a[180:183], a[228:231], v[40:43], a[180:183]
    buffer_load_dwordx4 v27, s[4:7], s51 offen offset:1024 sc1 lds
    s_add_u32 s51, s51, 2048
    s_cmp_eq_u32 s49, 3670016
    s_cselect_b32 s49, 0, s49
    s_cselect_b32 s50, s61, s50
    s_cselect_b32 s51, s62, s51
    v_mfma_f32_16x16x32_bf16 a[52:55], a[228:231], v[36:39], a[52:55]
    v_mfma_f32_16x16x32_bf16 a[20:23], a[228:231], v[32:35], a[20:23]
    v_add_u32 v23, 0x8000, v23
    s_waitcnt lgkmcnt(4)
    v_mfma_f32_16x16x32_bf16 a[24:27], a[232:235], v[32:35], a[24:27]
    ds_read_b64_tr_b16 a[228:229], v11
    ds_read_b64_tr_b16 a[230:231], v11 offset:1024
    v_mfma_f32_16x16x32_bf16 a[56:59], a[232:235], v[36:39], a[56:59]
    v_mfma_f32_16x16x32_bf16 a[184:187], a[232:235], v[40:43], a[184:187]
    v_mfma_f32_16x16x32_bf16 a[216:219], a[232:235], v[44:47], a[216:219]
    v_add_u32 v10, 0x8000, v10
    s_waitcnt lgkmcnt(4)
    v_mfma_f32_16x16x32_bf16 a[220:223], a[236:239], v[44:47], a[220:223]
    ds_read_b64_tr_b16 a[232:233], v12
    ds_read_b64_tr_b16 a[234:235], v12 offset:1024
    v_mfma_f32_16x16x32_bf16 a[188:191], a[236:239], v[40:43], a[188:191]
    v_mfma_f32_16x16x32_bf16 a[60:63], a[236:239], v[36:39], a[60:63]
    v_mfma_f32_16x16x32_bf16 a[28:31], a[236:239], v[32:35], a[28:31]
    v_add_u32 v11, 0x8000, v11
    s_waitcnt lgkmcnt(4)
    v_mfma_f32_16x16x32_bf16 a[96:99], a[224:227], v[32:35], a[96:99]
    ds_read_b64_tr_b16 a[236:237], v13
    ds_read_b64_tr_b16 a[238:239], v13 offset:1024
    v_mfma_f32_16x16x32_bf16 a[112:115], a[224:227], v[36:39], a[112:115]
    v_mfma_f32_16x16x32_bf16 a[128:131], a[224:227], v[40:43], a[128:131]
    s_waitcnt vmcnt(0)
    s_barrier
    s_cmp_lg_u32 s24, 0
    s_cbranch_scc1 L_sig2
    v_mov_b32 v28, 0
    v_mov_b32 v29, 1
    s_mov_b64 exec, 1
    buffer_atomic_add v29, v28, s[4:7], s97 offen
    s_mov_b64 exec, -1
L_sig2:
    v_mfma_f32_16x16x32_bf16 a[144:147], a[224:227], v[44:47], a[144:147]
    ds_read_b128 a[240:243], v8 offset:0
    v_add_u32 v12, 0x8000, v12
    s_waitcnt lgkmcnt(5)
    v_mfma_f32_16x16x32_bf16 a[148:151], a[228:231], v[44:47], a[148:151]
    ds_read_b64_tr_b16 a[224:225], v16
    ds_read_b64_tr_b16 a[226:227], v16 offset:2048
    v_mfma_f32_16x16x32_bf16 a[132:135], a[228:231], v[40:43], a[132:135]
    ds_read_b128 a[244:247], v8 offset:1024
    ds_read_b128 a[248:251], v8 offset:2048
    v_mfma_f32_16x16x32_bf16 a[116:119], a[228:231], v[36:39], a[116:119]
    ds_read_b128 a[252:255], v8 offset:3072
    v_mfma_f32_16x16x32_bf16 a[100:103], a[228:231], v[32:35], a[100:103]
    v_add_u32 v13, 0x8000, v13
    s_waitcnt lgkmcnt(8)
    v_mfma_f32_16x16x32_bf16 a[104:107], a[232:235], v[32:35], a[104:107]
    ds_read_b64_tr_b16 a[228:229], v17
    ds_read_b64_tr_b16 a[230:231], v17 offset:2048
    v_mfma_f32_16x16x32_bf16 a[120:123], a[232:235], v[36:39], a[120:123]
    s_add_u32 m0, s32, 0
    s_nop 0
    buffer_load_dwordx4 v2, s[16:19], s49 offen lds
    v_mfma_f32_16x16x32_bf16 a[136:139], a[232:235], v[40:43], a[136:139]
    v_mfma_f32_16x16x32_bf16 a[152:155], a[232:235], v[44:47], a[152:155]
    s_waitcnt lgkmcnt(8)
    v_mfma_f32_16x16x32_bf16 a[156:159], a[236:239], v[44:47], a[156:159]
    ds_read_b64_tr_b16 a[232:233], v18
    ds_read_b64_tr_b16 a[234:235], v18 offset:2048
    v_mfma_f32_16x16x32_bf16 a[140:143], a[236:239], v[40:43], a[140:143]
    v_mfma_f32_16x16x32_bf16 a[124:127], a[236:239], v[36:39], a[124:127]
    buffer_load_dwordx4 v3, s[16:19], s49 offen offset:1024 lds
    v_mfma_f32_16x16x32_bf16 a[108:111], a[236:239], v[32:35], a[108:111]
    s_waitcnt lgkmcnt(7)
    s_waitcnt lgkmcnt(4)
    v_mfma_f32_16x16x32_bf16 a[0:3], a[224:227], a[240:243], a[0:3]
    ds_read_b64_tr_b16 a[236:237], v19
    ds_read_b64_tr_b16 a[238:239], v19 offset:2048
    v_mfma_f32_16x16x32_bf16 a[32:35], a[224:227], a[244:247], a[32:35]
    v_mfma_f32_16x16x32_bf16 a[160:163], a[224:227], a[248:251], a[160:163]
    buffer_load_dwordx4 v4, s[16:19], s49 offen offset:2048 lds
    v_mfma_f32_16x16x32_bf16 a[192:195], a[224:227], a[252:255], a[192:195]
    v_add_u32 v8, 0x8000, v8
    s_waitcnt lgkmcnt(4)
    v_mfma_f32_16x16x32_bf16 a[196:199], a[228:231], a[252:255], a[196:199]
    ds_read_b64_tr_b16 a[224:225], v20
    ds_read_b64_tr_b16 a[226:227], v20 offset:2048
    v_mfma_f32_16x16x32_bf16 a[164:167], a[228:231], a[248:251], a[164:167]
    v_mfma_f32_16x16x32_bf16 a[36:39], a[228:231], a[244:247], a[36:39]
    buffer_load_dwordx4 v5, s[16:19], s49 offen offset:3072 lds
    v_mfma_f32_16x16x32_bf16 a[4:7], a[228:231], a[240:243], a[4:7]
    v_add_u32 v16, 0x8000, v16
    v_add_u32 v19, 0x8000, v19
    s_waitcnt lgkmcnt(4)
    v_mfma_f32_16x16x32_bf16 a[8:11], a[232:235], a[240:243], a[8:11]
    ds_read_b64_tr_b16 a[228:229], v21
    ds_read_b64_tr_b16 a[230:231], v21 offset:2048
    v_mfma_f32_16x16x32_bf16 a[40:43], a[232:235], a[244:247], a[40:43]
    v_mfma_f32_16x16x32_bf16 a[168:171], a[232:235], a[248:251], a[168:171]
    v_mfma_f32_16x16x32_bf16 a[200:203], a[232:235], a[252:255], a[200:203]
    v_add_u32 v17, 0x8000, v17
    v_add_u32 v20, 0x8000, v20
    s_waitcnt lgkmcnt(4)
    v_mfma_f32_16x16x32_bf16 a[204:207], a[236:239], a[252:255], a[204:207]
    ds_read_b64_tr_b16 a[232:233], v22
    ds_read_b64_tr_b16 a[234:235], v22 offset:2048
    v_mfma_f32_16x16x32_bf16 a[172:175], a[236:239], a[248:251], a[172:175]
    s_add_u32 m0, s33, 0
    s_add_u32 s49, s49, 262144
    buffer_load_dwordx4 v6, s[20:23], s50 offen lds
    v_mfma_f32_16x16x32_bf16 a[44:47], a[236:239], a[244:247], a[44:47]
    v_mfma_f32_16x16x32_bf16 a[12:15], a[236:239], a[240:243], a[12:15]
    v_add_u32 v18, 0x8000, v18
    v_add_u32 v21, 0x8000, v21
    s_waitcnt lgkmcnt(4)
    v_mfma_f32_16x16x32_bf16 a[16:19], a[224:227], a[240:243], a[16:19]
    ds_read_b64_tr_b16 a[236:237], v23
    ds_read_b64_tr_b16 a[238:239], v23 offset:2048
    v_mfma_f32_16x16x32_bf16 a[48:51], a[224:227], a[244:247], a[48:51]
    v_mfma_f32_16x16x32_bf16 a[176:179], a[224:227], a[248:251], a[176:179]
    buffer_load_dwordx4 v7, s[20:23], s50 offen offset:1024 lds
    v_mfma_f32_16x16x32_bf16 a[208:211], a[224:227], a[252:255], a[208:211]
    v_add_u32 v22, 0x8000, v22
    s_waitcnt lgkmcnt(4)
    v_mfma_f32_16x16x32_bf16 a[212:215], a[228:231], a[252:255], a[212:215]
    ds_read_b64_tr_b16 a[224:225], v10
    ds_read_b64_tr_b16 a[226:227], v10 offset:1024
    v_mfma_f32_16x16x32_bf16 a[180:183], a[228:231], a[248:251], a[180:183]
    v_mfma_f32_16x16x32_bf16 a[52:55], a[228:231], a[244:247], a[52:55]
    v_mfma_f32_16x16x32_bf16 a[20:23], a[228:231], a[240:243], a[20:23]
    v_add_u32 v23, 0x8000, v23
    s_waitcnt lgkmcnt(4)
    v_mfma_f32_16x16x32_bf16 a[24:27], a[232:235], a[240:243], a[24:27]
    ds_read_b64_tr_b16 a[228:229], v11
    ds_read_b64_tr_b16 a[230:231], v11 offset:1024
    v_mfma_f32_16x16x32_bf16 a[56:59], a[232:235], a[244:247], a[56:59]
    s_add_u32 m0, m0, 8192
    s_add_u32 s50, s50, 114688
    buffer_load_dwordx4 v27, s[4:7], s51 offen sc1 lds
    v_mfma_f32_16x16x32_bf16 a[184:187], a[232:235], a[248:251], a[184:187]
    v_mfma_f32_16x16x32_bf16 a[216:219], a[232:235], a[252:255], a[216:219]
    v_add_u32 v10, 0x8000, v10
    s_waitcnt lgkmcnt(4)
    v_mfma_f32_16x16x32_bf16 a[220:223], a[236:239], a[252:255], a[220:223]
    ds_read_b64_tr_b16 a[232:233], v12
    ds_read_b64_tr_b16 a[234:235], v12 offset:1024
    v_mfma_f32_16x16x32_bf16 a[188:191], a[236:239], a[248:251], a[188:191]
    v_mfma_f32_16x16x32_bf16 a[60:63], a[236:239], a[244:247], a[60:63]
    buffer_load_dwordx4 v27, s[4:7], s51 offen offset:1024 sc1 lds
    s_add_u32 s51, s51, 2048
    s_cmp_eq_u32 s49, 3670016
    s_cselect_b32 s49, 0, s49
    s_cselect_b32 s50, s61, s50
    s_cselect_b32 s51, s62, s51
    v_mfma_f32_16x16x32_bf16 a[28:31], a[236:239], a[240:243], a[28:31]
    v_add_u32 v11, 0x8000, v11
    s_waitcnt lgkmcnt(4)
    v_mfma_f32_16x16x32_bf16 a[96:99], a[224:227], a[240:243], a[96:99]
    ds_read_b64_tr_b16 a[236:237], v13
    ds_read_b64_tr_b16 a[238:239], v13 offset:1024
    v_mfma_f32_16x16x32_bf16 a[112:115], a[224:227], a[244:247], a[112:115]
    v_mfma_f32_16x16x32_bf16 a[128:131], a[224:227], a[248:251], a[128:131]
    s_barrier
    v_mfma_f32_16x16x32_bf16 a[144:147], a[224:227], a[252:255], a[144:147]
    ds_read_b128 v[32:35], v8 offset:0
    v_add_u32 v12, 0x8000, v12
    s_waitcnt lgkmcnt(5)
    v_mfma_f32_16x16x32_bf16 a[148:151], a[228:231], a[252:255], a[148:151]
    ds_read_b64_tr_b16 a[224:225], v16
    ds_read_b64_tr_b16 a[226:227], v16 offset:2048
    v_mfma_f32_16x16x32_bf16 a[132:135], a[228:231], a[248:251], a[132:135]
    ds_read_b128 v[36:39], v8 offset:1024
    ds_read_b128 v[40:43], v8 offset:2048
    v_mfma_f32_16x16x32_bf16 a[116:119], a[228:231], a[244:247], a[116:119]
    ds_read_b128 v[44:47], v8 offset:3072
    v_mfma_f32_16x16x32_bf16 a[100:103], a[228:231], a[240:243], a[100:103]
    v_add_u32 v13, 0x8000, v13
    s_waitcnt lgkmcnt(8)
    v_mfma_f32_16x16x32_bf16 a[104:107], a[232:235], a[240:243], a[104:107]
    ds_read_b64_tr_b16 a[228:229], v17
    ds_read_b64_tr_b16 a[230:231], v17 offset:2048
    v_mfma_f32_16x16x32_bf16 a[120:123], a[232:235], a[244:247], a[120:123]
    s_add_u32 m0, s32, 32768
    s_nop 0
    buffer_load_dwordx4 v2, s[16:19], s49 offen lds
    v_mfma_f32_16x16x32_bf16 a[136:139], a[232:235], a[248:251], a[136:139]
    v_mfma_f32_16x16x32_bf16 a[152:155], a[232:235], a[252:255], a[152:155]
    s_waitcnt lgkmcnt(8)
    v_mfma_f32_16x16x32_bf16 a[156:159], a[236:239], a[252:255], a[156:159]
    ds_read_b64_tr_b16 a[232:233], v18
    ds_read_b64_tr_b16 a[234:235], v18 offset:2048
    v_mfma_f32_16x16x32_bf16 a[140:143], a[236:239], a[248:251], a[140:143]
    v_mfma_f32_16x16x32_bf16 a[124:127], a[236:239], a[244:247], a[124:127]
    buffer_load_dwordx4 v3, s[16:19], s49 offen offset:1024 lds
    v_mfma_f32_16x16x32_bf16 a[108:111], a[236:239], a[240:243], a[108:111]
    s_waitcnt lgkmcnt(7)
    s_waitcnt lgkmcnt(4)
    v_mfma_f32_16x16x32_bf16 a[0:3], a[224:227], v[32:35], a[0:3]
    ds_read_b64_tr_b16 a[236:237], v19
    ds_read_b64_tr_b16 a[238:239], v19 offset:2048
    v_mfma_f32_16x16x32_bf16 a[32:35], a[224:227], v[36:39], a[32:35]
    v_mfma_f32_16x16x32_bf16 a[160:163], a[224:227], v[40:43], a[160:163]
    buffer_load_dwordx4 v4, s[16:19], s49 offen offset:2048 lds
    v_mfma_f32_16x16x32_bf16 a[192:195], a[224:227], v[44:47], a[192:195]
    v_add_u32 v8, 0x8000, v8
    s_waitcnt lgkmcnt(4)
    v_mfma_f32_16x16x32_bf16 a[196:199], a[228:231], v[44:47], a[196:199]
    ds_read_b64_tr_b16 a[224:225], v20
    ds_read_b64_tr_b16 a[226:227], v20 offset:2048
    v_mfma_f32_16x16x32_bf16 a[164:167], a[228:231], v[40:43], a[164:167]
    v_mfma_f32_16x16x32_bf16 a[36:39], a[228:231], v[36:39], a[36:39]
    buffer_load_dwordx4 v5, s[16:19], s49 offen offset:3072 lds
    v_mfma_f32_16x16x32_bf16 a[4:7], a[228:231], v[32:35], a[4:7]
    v_add_u32 v16, 0x8000, v16
    v_add_u32 v19, 0x8000, v19
    s_waitcnt lgkmcnt(4)
    v_mfma_f32_16x16x32_bf16 a[8:11], a[232:235], v[32:35], a[8:11]
    ds_read_b64_tr_b16 a[228:229], v21
    ds_read_b64_tr_b16 a[230:231], v21 offset:2048
    v_mfma_f32_16x16x32_bf16 a[40:43], a[232:235], v[36:39], a[40:43]
    v_mfma_f32_16x16x32_bf16 a[168:171], a[232:235], v[40:43], a[168:171]
    v_mfma_f32_16x16x32_bf16 a[200:203], a[232:235], v[44:47], a[200:203]
    v_add_u32 v17, 0x8000, v17
    v_add_u32 v20, 0x8000, v20
    s_waitcnt lgkmcnt(4)
    v_mfma_f32_16x16x32_bf16 a[204:207], a[236:239], v[44:47], a[204:207]
    ds_read_b64_tr_b16 a[232:233], v22
    ds_read_b64_tr_b16 a[234:235], v22 offset:2048
    v_mfma_f32_16x16x32_bf16 a[172:175], a[236:239], v[40:43], a[172:175]
    s_add_u32 m0, s33, 32768
    s_add_u32 s49, s49, 262144
    buffer_load_dwordx4 v6, s[20:23], s50 offen lds
    v_mfma_f32_16x16x32_bf16 a[44:47], a[236:239], v[36:39], a[44:47]
    v_mfma_f32_16x16x32_bf16 a[12:15], a[236:239], v[32:35], a[12:15]
    v_add_u32 v18, 0x8000, v18
    v_add_u32 v21, 0x8000, v21
    s_waitcnt lgkmcnt(4)
    v_mfma_f32_16x16x32_bf16 a[16:19], a[224:227], v[32:35], a[16:19]
    ds_read_b64_tr_b16 a[236:237], v23
    ds_read_b64_tr_b16 a[238:239], v23 offset:2048
    v_mfma_f32_16x16x32_bf16 a[48:51], a[224:227], v[36:39], a[48:51]
    v_mfma_f32_16x16x32_bf16 a[176:179], a[224:227], v[40:43], a[176:179]
    buffer_load_dwordx4 v7, s[20:23], s50 offen offset:1024 lds
    v_mfma_f32_16x16x32_bf16 a[208:211], a[224:227], v[44:47], a[208:211]
    v_add_u32 v22, 0x8000, v22
    s_waitcnt lgkmcnt(4)
    v_mfma_f32_16x16x32_bf16 a[212:215], a[228:231], v[44:47], a[212:215]
    ds_read_b64_tr_b16 a[224:225], v10
    ds_read_b64_tr_b16 a[226:227], v10 offset:1024
    v_mfma_f32_16x16x32_bf16 a[180:183], a[228:231], v[40:43], a[180:183]
    v_mfma_f32_16x16x32_bf16 a[52:55], a[228:231], v[36:39], a[52:55]
    v_mfma_f32_16x16x32_bf16 a[20:23], a[228:231], v[32:35], a[20:23]
    v_add_u32 v23, 0x8000, v23
    s_waitcnt lgkmcnt(4)
    v_mfma_f32_16x16x32_bf16 a[24:27], a[232:235], v[32:35], a[24:27]
    ds_read_b64_tr_b16 a[228:229], v11
    ds_read_b64_tr_b16 a[230:231], v11 offset:1024
    v_mfma_f32_16x16x32_bf16 a[56:59], a[232:235], v[36:39], a[56:59]
    s_add_u32 m0, m0, 8192
    s_add_u32 s50, s50, 114688
    buffer_load_dwordx4 v27, s[4:7], s51 offen sc1 lds
    v_mfma_f32_16x16x32_bf16 a[184:187], a[232:235], v[40:43], a[184:187]
    v_mfma_f32_16x16x32_bf16 a[216:219], a[232:235], v[44:47], a[216:219]
    v_add_u32 v10, 0x8000, v10
    s_waitcnt lgkmcnt(4)
    v_mfma_f32_16x16x32_bf16 a[220:223], a[236:239], v[44:47], a[220:223]
    ds_read_b64_tr_b16 a[232:233], v12
    ds_read_b64_tr_b16 a[234:235], v12 offset:1024
    v_mfma_f32_16x16x32_bf16 a[188:191], a[236:239], v[40:43], a[188:191]
    v_mfma_f32_16x16x32_bf16 a[60:63], a[236:239], v[36:39], a[60:63]
    buffer_load_dwordx4 v27, s[4:7], s51 offen offset:1024 sc1 lds
    s_add_u32 s51, s51, 2048
    s_cmp_eq_u32 s49, 3670016
    s_cselect_b32 s49, 0, s49
    s_cselect_b32 s50, s61, s50
    s_cselect_b32 s51, s62, s51
    v_mfma_f32_16x16x32_bf16 a[28:31], a[236:239], v[32:35], a[28:31]
    v_add_u32 v11, 0x8000, v11
    s_waitcnt lgkmcnt(4)
    v_mfma_f32_16x16x32_bf16 a[96:99], a[224:227], v[32:35], a[96:99]
    ds_read_b64_tr_b16 a[236:237], v13
    ds_read_b64_tr_b16 a[238:239], v13 offset:1024
    v_mfma_f32_16x16x32_bf16 a[112:115], a[224:227], v[36:39], a[112:115]
    v_mfma_f32_16x16x32_bf16 a[128:131], a[224:227], v[40:43], a[128:131]
    s_barrier
    v_mfma_f32_16x16x32_bf16 a[144:147], a[224:227], v[44:47], a[144:147]
    ds_read_b128 a[240:243], v8 offset:0
    v_add_u32 v12, 0x8000, v12
    s_waitcnt lgkmcnt(5)
    v_mfma_f32_16x16x32_bf16 a[148:151], a[228:231], v[44:47], a[148:151]
    ds_read_b64_tr_b16 a[224:225], v16
    ds_read_b64_tr_b16 a[226:227], v16 offset:2048
    v_mfma_f32_16x16x32_bf16 a[132:135], a[228:231], v[40:43], a[132:135]
    ds_read_b128 a[244:247], v8 offset:1024
    ds_read_b128 a[248:251], v8 offset:2048
    v_mfma_f32_16x16x32_bf16 a[116:119], a[228:231], v[36:39], a[116:119]
    ds_read_b128 a[252:255], v8 offset:3072
    v_mfma_f32_16x16x32_bf16 a[100:103], a[228:231], v[32:35], a[100:103]
    v_add_u32 v13, 0x8000, v13
    s_waitcnt lgkmcnt(8)
    v_mfma_f32_16x16x32_bf16 a[104:107], a[232:235], v[32:35], a[104:107]
    ds_read_b64_tr_b16 a[228:229], v17
    ds_read_b64_tr_b16 a[230:231], v17 offset:2048
    v_mfma_f32_16x16x32_bf16 a[120:123], a[232:235], v[36:39], a[120:123]
    s_add_u32 m0, s32, 65536
    s_nop 0
    buffer_load_dwordx4 v2, s[16:19], s49 offen lds
    v_mfma_f32_16x16x32_bf16 a[136:139], a[232:235], v[40:43], a[136:139]
    v_mfma_f32_16x16x32_bf16 a[152:155], a[232:235], v[44:47], a[152:155]
    s_waitcnt lgkmcnt(8)
    v_mfma_f32_16x16x32_bf16 a[156:159], a[236:239], v[44:47], a[156:159]
    ds_read_b64_tr_b16 a[232:233], v18
    ds_read_b64_tr_b16 a[234:235], v18 offset:2048
    v_mfma_f32_16x16x32_bf16 a[140:143], a[236:239], v[40:43], a[140:143]
    v_mfma_f32_16x16x32_bf16 a[124:127], a[236:239], v[36:39], a[124:127]
    buffer_load_dwordx4 v3, s[16:19], s49 offen offset:1024 lds
    v_mfma_f32_16x16x32_bf16 a[108:111], a[236:239], v[32:35], a[108:111]
    s_waitcnt lgkmcnt(7)
    s_waitcnt lgkmcnt(4)
    v_mfma_f32_16x16x32_bf16 a[0:3], a[224:227], a[240:243], a[0:3]
    ds_read_b64_tr_b16 a[236:237], v19
    ds_read_b64_tr_b16 a[238:239], v19 offset:2048
    v_mfma_f32_16x16x32_bf16 a[32:35], a[224:227], a[244:247], a[32:35]
    v_mfma_f32_16x16x32_bf16 a[160:163], a[224:227], a[248:251], a[160:163]
    buffer_load_dwordx4 v4, s[16:19], s49 offen offset:2048 lds
    v_mfma_f32_16x16x32_bf16 a[192:195], a[224:227], a[252:255], a[192:195]
    v_add_u32 v8, 0xfffe0000, v8
    s_waitcnt lgkmcnt(4)
    v_mfma_f32_16x16x32_bf16 a[196:199], a[228:231], a[252:255], a[196:199]
    ds_read_b64_tr_b16 a[224:225], v20
    ds_read_b64_tr_b16 a[226:227], v20 offset:2048
    v_mfma_f32_16x16x32_bf16 a[164:167], a[228:231], a[248:251], a[164:167]
    v_mfma_f32_16x16x32_bf16 a[36:39], a[228:231], a[244:247], a[36:39]
    buffer_load_dwordx4 v5, s[16:19], s49 offen offset:3072 lds
    v_mfma_f32_16x16x32_bf16 a[4:7], a[228:231], a[240:243], a[4:7]
    v_add_u32 v16, 0xfffe0000, v16
    v_add_u32 v19, 0xfffe0000, v19
    s_waitcnt lgkmcnt(4)
    v_mfma_f32_16x16x32_bf16 a[8:11], a[232:235], a[240:243], a[8:11]
    ds_read_b64_tr_b16 a[228:229], v21
    ds_read_b64_tr_b16 a[230:231], v21 offset:2048
    v_mfma_f32_16x16x32_bf16 a[40:43], a[232:235], a[244:247], a[40:43]
    v_mfma_f32_16x16x32_bf16 a[168:171], a[232:235], a[248:251], a[168:171]
    v_mfma_f32_16x16x32_bf16 a[200:203], a[232:235], a[252:255], a[200:203]
    v_add_u32 v17, 0xfffe0000, v17
    v_add_u32 v20, 0xfffe0000, v20
    s_waitcnt lgkmcnt(4)
    v_mfma_f32_16x16x32_bf16 a[204:207], a[236:239], a[252:255], a[204:207]
    ds_read_b64_tr_b16 a[232:233], v22
    ds_read_b64_tr_b16 a[234:235], v22 offset:2048
    v_mfma_f32_16x16x32_bf16 a[172:175], a[236:239], a[248:251], a[172:175]
    s_add_u32 m0, s33, 65536
    s_add_u32 s49, s49, 262144
    buffer_load_dwordx4 v6, s[20:23], s50 offen lds
    v_mfma_f32_16x16x32_bf16 a[44:47], a[236:239], a[244:247], a[44:47]
    v_mfma_f32_16x16x32_bf16 a[12:15], a[236:239], a[240:243], a[12:15]
    v_add_u32 v18, 0xfffe0000, v18
    v_add_u32 v21, 0xfffe0000, v21
    s_waitcnt lgkmcnt(4)
    v_mfma_f32_16x16x32_bf16 a[16:19], a[224:227], a[240:243], a[16:19]
    ds_read_b64_tr_b16 a[236:237], v23
    ds_read_b64_tr_b16 a[238:239], v23 offset:2048
    v_mfma_f32_16x16x32_bf16 a[48:51], a[224:227], a[244:247], a[48:51]
    v_mfma_f32_16x16x32_bf16 a[176:179], a[224:227], a[248:251], a[176:179]
    buffer_load_dwordx4 v7, s[20:23], s50 offen offset:1024 lds
    v_mfma_f32_16x16x32_bf16 a[208:211], a[224:227], a[252:255], a[208:211]
    v_add_u32 v22, 0xfffe0000, v22
    s_waitcnt lgkmcnt(4)
    v_mfma_f32_16x16x32_bf16 a[212:215], a[228:231], a[252:255], a[212:215]
    ds_read_b64_tr_b16 a[224:225], v10
    ds_read_b64_tr_b16 a[226:227], v10 offset:1024
    v_mfma_f32_16x16x32_bf16 a[180:183], a[228:231], a[248:251], a[180:183]
    v_mfma_f32_16x16x32_bf16 a[52:55], a[228:231], a[244:247], a[52:55]
    v_mfma_f32_16x16x32_bf16 a[20:23], a[228:231], a[240:243], a[20:23]
    v_add_u32 v23, 0xfffe0000, v23
    s_waitcnt lgkmcnt(4)
    v_mfma_f32_16x16x32_bf16 a[24:27], a[232:235], a[240:243], a[24:27]
    ds_read_b64_tr_b16 a[228:229], v11
    ds_read_b64_tr_b16 a[230:231], v11 offset:1024
    v_mfma_f32_16x16x32_bf16 a[56:59], a[232:235], a[244:247], a[56:59]
    s_add_u32 m0, m0, 8192
    s_add_u32 s50, s50, 114688
    buffer_load_dwordx4 v27, s[4:7], s51 offen sc1 lds
    v_mfma_f32_16x16x32_bf16 a[184:187], a[232:235], a[248:251], a[184:187]
    v_mfma_f32_16x16x32_bf16 a[216:219], a[232:235], a[252:255], a[216:219]
    v_add_u32 v10, 0xfffe0000, v10
    s_waitcnt lgkmcnt(4)
    v_mfma_f32_16x16x32_bf16 a[220:223], a[236:239], a[252:255], a[220:223]
    ds_read_b64_tr_b16 a[232:233], v12
    ds_read_b64_tr_b16 a[234:235], v12 offset:1024
    v_mfma_f32_16x16x32_bf16 a[188:191], a[236:239], a[248:251], a[188:191]
    v_mfma_f32_16x16x32_bf16 a[60:63], a[236:239], a[244:247], a[60:63]
    buffer_load_dwordx4 v27, s[4:7], s51 offen offset:1024 sc1 lds
    s_add_u32 s51, s51, 2048
    s_cmp_eq_u32 s49, 3670016
    s_cselect_b32 s49, 0, s49
    s_cselect_b32 s50, s61, s50
    s_cselect_b32 s51, s62, s51
    v_mfma_f32_16x16x32_bf16 a[28:31], a[236:239], a[240:243], a[28:31]
    v_add_u32 v11, 0xfffe0000, v11
    s_waitcnt lgkmcnt(4)
    v_mfma_f32_16x16x32_bf16 a[96:99], a[224:227], a[240:243], a[96:99]
    ds_read_b64_tr_b16 a[236:237], v13
    ds_read_b64_tr_b16 a[238:239], v13 offset:1024
    v_mfma_f32_16x16x32_bf16 a[112:115], a[224:227], a[244:247], a[112:115]
    v_mfma_f32_16x16x32_bf16 a[128:131], a[224:227], a[248:251], a[128:131]
    s_waitcnt vmcnt(16)
    s_barrier
    v_mfma_f32_16x16x32_bf16 a[144:147], a[224:227], a[252:255], a[144:147]
    ds_read_b128 v[32:35], v8 offset:0
    v_add_u32 v12, 0xfffe0000, v12
    s_waitcnt lgkmcnt(5)
    v_mfma_f32_16x16x32_bf16 a[148:151], a[228:231], a[252:255], a[148:151]
    ds_read_b64_tr_b16 a[224:225], v16
    ds_read_b64_tr_b16 a[226:227], v16 offset:2048
    v_mfma_f32_16x16x32_bf16 a[132:135], a[228:231], a[248:251], a[132:135]
    ds_read_b128 v[36:39], v8 offset:1024
    ds_read_b128 v[40:43], v8 offset:2048
    v_mfma_f32_16x16x32_bf16 a[116:119], a[228:231], a[244:247], a[116:119]
    ds_read_b128 v[44:47], v8 offset:3072
    v_mfma_f32_16x16x32_bf16 a[100:103], a[228:231], a[240:243], a[100:103]
    v_add_u32 v13, 0xfffe0000, v13
    s_waitcnt lgkmcnt(8)
    v_mfma_f32_16x16x32_bf16 a[104:107], a[232:235], a[240:243], a[104:107]
    ds_read_b64_tr_b16 a[228:229], v17
    ds_read_b64_tr_b16 a[230:231], v17 offset:2048
    v_mfma_f32_16x16x32_bf16 a[120:123], a[232:235], a[244:247], a[120:123]
    s_add_u32 m0, s32, 98304
    s_nop 0
    buffer_load_dwordx4 v2, s[16:19], s49 offen lds
    v_mfma_f32_16x16x32_bf16 a[136:139], a[232:235], a[248:251], a[136:139]
    v_mfma_f32_16x16x32_bf16 a[152:155], a[232:235], a[252:255], a[152:155]
    s_waitcnt lgkmcnt(8)
    v_mfma_f32_16x16x32_bf16 a[156:159], a[236:239], a[252:255], a[156:159]
    ds_read_b64_tr_b16 a[232:233], v18
    ds_read_b64_tr_b16 a[234:235], v18 offset:2048
    v_mfma_f32_16x16x32_bf16 a[140:143], a[236:239], a[248:251], a[140:143]
    v_mfma_f32_16x16x32_bf16 a[124:127], a[236:239], a[244:247], a[124:127]
    buffer_load_dwordx4 v3, s[16:19], s49 offen offset:1024 lds
    v_mfma_f32_16x16x32_bf16 a[108:111], a[236:239], a[240:243], a[108:111]
    s_waitcnt lgkmcnt(7)
    s_waitcnt lgkmcnt(4)
    v_mfma_f32_16x16x32_bf16 a[0:3], a[224:227], v[32:35], a[0:3]
    ds_read_b64_tr_b16 a[236:237], v19
    ds_read_b64_tr_b16 a[238:239], v19 offset:2048
    v_mfma_f32_16x16x32_bf16 a[32:35], a[224:227], v[36:39], a[32:35]
    v_mfma_f32_16x16x32_bf16 a[160:163], a[224:227], v[40:43], a[160:163]
    buffer_load_dwordx4 v4, s[16:19], s49 offen offset:2048 lds
    v_mfma_f32_16x16x32_bf16 a[192:195], a[224:227], v[44:47], a[192:195]
    v_add_u32 v8, 0x8000, v8
    s_waitcnt lgkmcnt(4)
    v_mfma_f32_16x16x32_bf16 a[196:199], a[228:231], v[44:47], a[196:199]
    ds_read_b64_tr_b16 a[224:225], v20
    ds_read_b64_tr_b16 a[226:227], v20 offset:2048
    v_mfma_f32_16x16x32_bf16 a[164:167], a[228:231], v[40:43], a[164:167]
    v_mfma_f32_16x16x32_bf16 a[36:39], a[228:231], v[36:39], a[36:39]
    buffer_load_dwordx4 v5, s[16:19], s49 offen offset:3072 lds
    v_mfma_f32_16x16x32_bf16 a[4:7], a[228:231], v[32:35], a[4:7]
    v_add_u32 v16, 0x8000, v16
    v_add_u32 v19, 0x8000, v19
    s_waitcnt lgkmcnt(4)
    v_mfma_f32_16x16x32_bf16 a[8:11], a[232:235], v[32:35], a[8:11]
    ds_read_b64_tr_b16 a[228:229], v21
    ds_read_b64_tr_b16 a[230:231], v21 offset:2048
    v_mfma_f32_16x16x32_bf16 a[40:43], a[232:235], v[36:39], a[40:43]
    v_mfma_f32_16x16x32_bf16 a[168:171], a[232:235], v[40:43], a[168:171]
    v_mfma_f32_16x16x32_bf16 a[200:203], a[232:235], v[44:47], a[200:203]
    v_add_u32 v17, 0x8000, v17
    v_add_u32 v20, 0x8000, v20
    s_waitcnt lgkmcnt(4)
    v_mfma_f32_16x16x32_bf16 a[204:207], a[236:239], v[44:47], a[204:207]
    ds_read_b64_tr_b16 a[232:233], v22
    ds_read_b64_tr_b16 a[234:235], v22 offset:2048
    v_mfma_f32_16x16x32_bf16 a[172:175], a[236:239], v[40:43], a[172:175]
    s_add_u32 m0, s33, 98304
    s_add_u32 s49, s49, 262144
    buffer_load_dwordx4 v6, s[20:23], s50 offen lds
    v_mfma_f32_16x16x32_bf16 a[44:47], a[236:239], v[36:39], a[44:47]
    v_mfma_f32_16x16x32_bf16 a[12:15], a[236:239], v[32:35], a[12:15]
    v_add_u32 v18, 0x8000, v18
    v_add_u32 v21, 0x8000, v21
    s_waitcnt lgkmcnt(4)
    v_mfma_f32_16x16x32_bf16 a[16:19], a[224:227], v[32:35], a[16:19]
    ds_read_b64_tr_b16 a[236:237], v23
    ds_read_b64_tr_b16 a[238:239], v23 offset:2048
    v_mfma_f32_16x16x32_bf16 a[48:51], a[224:227], v[36:39], a[48:51]
    v_mfma_f32_16x16x32_bf16 a[176:179], a[224:227], v[40:43], a[176:179]
    buffer_load_dwordx4 v7, s[20:23], s50 offen offset:1024 lds
    v_mfma_f32_16x16x32_bf16 a[208:211], a[224:227], v[44:47], a[208:211]
    v_add_u32 v22, 0x8000, v22
    s_waitcnt lgkmcnt(4)
    v_mfma_f32_16x16x32_bf16 a[212:215], a[228:231], v[44:47], a[212:215]
    ds_read_b64_tr_b16 a[224:225], v10
    ds_read_b64_tr_b16 a[226:227], v10 offset:1024
    v_mfma_f32_16x16x32_bf16 a[180:183], a[228:231], v[40:43], a[180:183]
    v_mfma_f32_16x16x32_bf16 a[52:55], a[228:231], v[36:39], a[52:55]
    v_mfma_f32_16x16x32_bf16 a[20:23], a[228:231], v[32:35], a[20:23]
    v_add_u32 v23, 0x8000, v23
    s_waitcnt lgkmcnt(4)
    v_mfma_f32_16x16x32_bf16 a[24:27], a[232:235], v[32:35], a[24:27]
    ds_read_b64_tr_b16 a[228:229], v11
    ds_read_b64_tr_b16 a[230:231], v11 offset:1024
    v_mfma_f32_16x16x32_bf16 a[56:59], a[232:235], v[36:39], a[56:59]
    s_add_u32 m0, m0, 8192
    s_add_u32 s50, s50, 114688
    buffer_load_dwordx4 v27, s[4:7], s51 offen sc1 lds
    v_mfma_f32_16x16x32_bf16 a[184:187], a[232:235], v[40:43], a[184:187]
    v_mfma_f32_16x16x32_bf16 a[216:219], a[232:235], v[44:47], a[216:219]
    v_add_u32 v10, 0x8000, v10
    s_waitcnt lgkmcnt(4)
    v_mfma_f32_16x16x32_bf16 a[220:223], a[236:239], v[44:47], a[220:223]
    ds_read_b64_tr_b16 a[232:233], v12
    ds_read_b64_tr_b16 a[234:235], v12 offset:1024
    v_mfma_f32_16x16x32_bf16 a[188:191], a[236:239], v[40:43], a[188:191]
    v_mfma_f32_16x16x32_bf16 a[60:63], a[236:239], v[36:39], a[60:63]
    buffer_load_dwordx4 v27, s[4:7], s51 offen offset:1024 sc1 lds
    s_add_u32 s51, s51, 2048
    s_cmp_eq_u32 s49, 3670016
    s_cselect_b32 s49, 0, s49
    s_cselect_b32 s50, s61, s50
    s_cselect_b32 s51, s62, s51
    v_mfma_f32_16x16x32_bf16 a[28:31], a[236:239], v[32:35], a[28:31]
    v_add_u32 v11, 0x8000, v11
    s_waitcnt lgkmcnt(4)
    v_mfma_f32_16x16x32_bf16 a[96:99], a[224:227], v[32:35], a[96:99]
    ds_read_b64_tr_b16 a[236:237], v13
    ds_read_b64_tr_b16 a[238:239], v13 offset:1024
    v_mfma_f32_16x16x32_bf16 a[112:115], a[224:227], v[36:39], a[112:115]
    v_mfma_f32_16x16x32_bf16 a[128:131], a[224:227], v[40:43], a[128:131]
    s_waitcnt vmcnt(16)
    s_barrier
    v_mfma_f32_16x16x32_bf16 a[144:147], a[224:227], v[44:47], a[144:147]
    ds_read_b128 a[240:243], v8 offset:0
    v_add_u32 v12, 0x8000, v12
    s_waitcnt lgkmcnt(5)
    v_mfma_f32_16x16x32_bf16 a[148:151], a[228:231], v[44:47], a[148:151]
    ds_read_b64_tr_b16 a[224:225], v16
    ds_read_b64_tr_b16 a[226:227], v16 offset:2048
    v_mfma_f32_16x16x32_bf16 a[132:135], a[228:231], v[40:43], a[132:135]
    ds_read_b128 a[244:247], v8 offset:1024
    ds_read_b128 a[248:251], v8 offset:2048
    v_mfma_f32_16x16x32_bf16 a[116:119], a[228:231], v[36:39], a[116:119]
    ds_read_b128 a[252:255], v8 offset:3072
    v_mfma_f32_16x16x32_bf16 a[100:103], a[228:231], v[32:35], a[100:103]
    v_add_u32 v13, 0x8000, v13
    s_waitcnt lgkmcnt(8)
    v_mfma_f32_16x16x32_bf16 a[104:107], a[232:235], v[32:35], a[104:107]
    ds_read_b64_tr_b16 a[228:229], v17
    ds_read_b64_tr_b16 a[230:231], v17 offset:2048
    v_mfma_f32_16x16x32_bf16 a[120:123], a[232:235], v[36:39], a[120:123]
    s_add_u32 m0, s32, 131072
    s_nop 0
    buffer_load_dwordx4 v2, s[16:19], s49 offen lds
    v_mfma_f32_16x16x32_bf16 a[136:139], a[232:235], v[40:43], a[136:139]
    v_mfma_f32_16x16x32_bf16 a[152:155], a[232:235], v[44:47], a[152:155]
    s_waitcnt lgkmcnt(8)
    v_mfma_f32_16x16x32_bf16 a[156:159], a[236:239], v[44:47], a[156:159]
    ds_read_b64_tr_b16 a[232:233], v18
    ds_read_b64_tr_b16 a[234:235], v18 offset:2048
    v_mfma_f32_16x16x32_bf16 a[140:143], a[236:239], v[40:43], a[140:143]
    v_mfma_f32_16x16x32_bf16 a[124:127], a[236:239], v[36:39], a[124:127]
    buffer_load_dwordx4 v3, s[16:19], s49 offen offset:1024 lds
    v_mfma_f32_16x16x32_bf16 a[108:111], a[236:239], v[32:35], a[108:111]
    s_waitcnt lgkmcnt(7)
    s_waitcnt lgkmcnt(4)
    v_mfma_f32_16x16x32_bf16 a[0:3], a[224:227], a[240:243], a[0:3]
    ds_read_b64_tr_b16 a[236:237], v19
    ds_read_b64_tr_b16 a[238:239], v19 offset:2048
    v_mfma_f32_16x16x32_bf16 a[32:35], a[224:227], a[244:247], a[32:35]
    v_mfma_f32_16x16x32_bf16 a[160:163], a[224:227], a[248:251], a[160:163]
    buffer_load_dwordx4 v4, s[16:19], s49 offen offset:2048 lds
    v_mfma_f32_16x16x32_bf16 a[192:195], a[224:227], a[252:255], a[192:195]
    v_add_u32 v8, 0x8000, v8
    s_waitcnt lgkmcnt(4)
    v_mfma_f32_16x16x32_bf16 a[196:199], a[228:231], a[252:255], a[196:199]
    ds_read_b64_tr_b16 a[224:225], v20
    ds_read_b64_tr_b16 a[226:227], v20 offset:2048
    v_mfma_f32_16x16x32_bf16 a[164:167], a[228:231], a[248:251], a[164:167]
    v_mfma_f32_16x16x32_bf16 a[36:39], a[228:231], a[244:247], a[36:39]
    buffer_load_dwordx4 v5, s[16:19], s49 offen offset:3072 lds
    v_mfma_f32_16x16x32_bf16 a[4:7], a[228:231], a[240:243], a[4:7]
    v_add_u32 v16, 0x8000, v16
    v_add_u32 v19, 0x8000, v19
    s_waitcnt lgkmcnt(4)
    v_mfma_f32_16x16x32_bf16 a[8:11], a[232:235], a[240:243], a[8:11]
    ds_read_b64_tr_b16 a[228:229], v21
    ds_read_b64_tr_b16 a[230:231], v21 offset:2048
    v_mfma_f32_16x16x32_bf16 a[40:43], a[232:235], a[244:247], a[40:43]
    v_mfma_f32_16x16x32_bf16 a[168:171], a[232:235], a[248:251], a[168:171]
    v_mfma_f32_16x16x32_bf16 a[200:203], a[232:235], a[252:255], a[200:203]
    v_add_u32 v17, 0x8000, v17
    v_add_u32 v20, 0x8000, v20
    s_waitcnt lgkmcnt(4)
    v_mfma_f32_16x16x32_bf16 a[204:207], a[236:239], a[252:255], a[204:207]
    ds_read_b64_tr_b16 a[232:233], v22
    ds_read_b64_tr_b16 a[234:235], v22 offset:2048
    v_mfma_f32_16x16x32_bf16 a[172:175], a[236:239], a[248:251], a[172:175]
    s_add_u32 m0, s33, 131072
    s_add_u32 s49, s49, 262144
    buffer_load_dwordx4 v6, s[20:23], s50 offen lds
    v_mfma_f32_16x16x32_bf16 a[44:47], a[236:239], a[244:247], a[44:47]
    v_mfma_f32_16x16x32_bf16 a[12:15], a[236:239], a[240:243], a[12:15]
    v_add_u32 v18, 0x8000, v18
    v_add_u32 v21, 0x8000, v21
    s_waitcnt lgkmcnt(4)
    v_mfma_f32_16x16x32_bf16 a[16:19], a[224:227], a[240:243], a[16:19]
    ds_read_b64_tr_b16 a[236:237], v23
    ds_read_b64_tr_b16 a[238:239], v23 offset:2048
    v_mfma_f32_16x16x32_bf16 a[48:51], a[224:227], a[244:247], a[48:51]
    v_mfma_f32_16x16x32_bf16 a[176:179], a[224:227], a[248:251], a[176:179]
    buffer_load_dwordx4 v7, s[20:23], s50 offen offset:1024 lds
    v_mfma_f32_16x16x32_bf16 a[208:211], a[224:227], a[252:255], a[208:211]
    v_add_u32 v22, 0x8000, v22
    s_waitcnt lgkmcnt(4)
    v_mfma_f32_16x16x32_bf16 a[212:215], a[228:231], a[252:255], a[212:215]
    ds_read_b64_tr_b16 a[224:225], v10
    ds_read_b64_tr_b16 a[226:227], v10 offset:1024
    v_mfma_f32_16x16x32_bf16 a[180:183], a[228:231], a[248:251], a[180:183]
    v_mfma_f32_16x16x32_bf16 a[52:55], a[228:231], a[244:247], a[52:55]
    v_mfma_f32_16x16x32_bf16 a[20:23], a[228:231], a[240:243], a[20:23]
    v_add_u32 v23, 0x8000, v23
    s_waitcnt lgkmcnt(4)
    v_mfma_f32_16x16x32_bf16 a[24:27], a[232:235], a[240:243], a[24:27]
    ds_read_b64_tr_b16 a[228:229], v11
    ds_read_b64_tr_b16 a[230:231], v11 offset:1024
    v_mfma_f32_16x16x32_bf16 a[56:59], a[232:235], a[244:247], a[56:59]
    s_add_u32 m0, m0, 8192
    s_add_u32 s50, s50, 114688
    buffer_load_dwordx4 v27, s[4:7], s51 offen sc1 lds
    v_mfma_f32_16x16x32_bf16 a[184:187], a[232:235], a[248:251], a[184:187]
    v_mfma_f32_16x16x32_bf16 a[216:219], a[232:235], a[252:255], a[216:219]
    v_add_u32 v10, 0x8000, v10
    s_waitcnt lgkmcnt(4)
    v_mfma_f32_16x16x32_bf16 a[220:223], a[236:239], a[252:255], a[220:223]
    ds_read_b64_tr_b16 a[232:233], v12
    ds_read_b64_tr_b16 a[234:235], v12 offset:1024
    v_mfma_f32_16x16x32_bf16 a[188:191], a[236:239], a[248:251], a[188:191]
    v_mfma_f32_16x16x32_bf16 a[60:63], a[236:239], a[244:247], a[60:63]
    buffer_load_dwordx4 v27, s[4:7], s51 offen offset:1024 sc1 lds
    s_add_u32 s51, s51, 2048
    s_cmp_eq_u32 s49, 3670016
    s_cselect_b32 s49, 0, s49
    s_cselect_b32 s50, s61, s50
    s_cselect_b32 s51, s62, s51
    v_mfma_f32_16x16x32_bf16 a[28:31], a[236:239], a[240:243], a[28:31]
    v_add_u32 v11, 0x8000, v11
    s_waitcnt lgkmcnt(4)
    v_mfma_f32_16x16x32_bf16 a[96:99], a[224:227], a[240:243], a[96:99]
    ds_read_b64_tr_b16 a[236:237], v13
    ds_read_b64_tr_b16 a[238:239], v13 offset:1024
    v_mfma_f32_16x16x32_bf16 a[112:115], a[224:227], a[244:247], a[112:115]
    v_mfma_f32_16x16x32_bf16 a[128:131], a[224:227], a[248:251], a[128:131]
    s_waitcnt vmcnt(16)
    s_barrier
    v_mfma_f32_16x16x32_bf16 a[144:147], a[224:227], a[252:255], a[144:147]
    ds_read_b128 v[32:35], v8 offset:0
    v_add_u32 v12, 0x8000, v12
    s_waitcnt lgkmcnt(5)
    v_mfma_f32_16x16x32_bf16 a[148:151], a[228:231], a[252:255], a[148:151]
    ds_read_b64_tr_b16 a[224:225], v16
    ds_read_b64_tr_b16 a[226:227], v16 offset:2048
    v_mfma_f32_16x16x32_bf16 a[132:135], a[228:231], a[248:251], a[132:135]
    ds_read_b128 v[36:39], v8 offset:1024
    ds_read_b128 v[40:43], v8 offset:2048
    v_mfma_f32_16x16x32_bf16 a[116:119], a[228:231], a[244:247], a[116:119]
    ds_read_b128 v[44:47], v8 offset:3072
    v_mfma_f32_16x16x32_bf16 a[100:103], a[228:231], a[240:243], a[100:103]
    v_add_u32 v13, 0x8000, v13
    s_waitcnt lgkmcnt(8)
    v_mfma_f32_16x16x32_bf16 a[104:107], a[232:235], a[240:243], a[104:107]
    ds_read_b64_tr_b16 a[228:229], v17
    ds_read_b64_tr_b16 a[230:231], v17 offset:2048
    v_mfma_f32_16x16x32_bf16 a[120:123], a[232:235], a[244:247], a[120:123]
    s_add_u32 m0, s32, 0
    s_nop 0
    buffer_load_dwordx4 v2, s[16:19], s49 offen lds
    v_mfma_f32_16x16x32_bf16 a[136:139], a[232:235], a[248:251], a[136:139]
    v_mfma_f32_16x16x32_bf16 a[152:155], a[232:235], a[252:255], a[152:155]
    s_waitcnt lgkmcnt(8)
    v_mfma_f32_16x16x32_bf16 a[156:159], a[236:239], a[252:255], a[156:159]
    ds_read_b64_tr_b16 a[232:233], v18
    ds_read_b64_tr_b16 a[234:235], v18 offset:2048
    v_mfma_f32_16x16x32_bf16 a[140:143], a[236:239], a[248:251], a[140:143]
    v_mfma_f32_16x16x32_bf16 a[124:127], a[236:239], a[244:247], a[124:127]
    buffer_load_dwordx4 v3, s[16:19], s49 offen offset:1024 lds
    v_mfma_f32_16x16x32_bf16 a[108:111], a[236:239], a[240:243], a[108:111]
    s_waitcnt lgkmcnt(7)
    s_waitcnt lgkmcnt(4)
    v_mfma_f32_16x16x32_bf16 a[0:3], a[224:227], v[32:35], a[0:3]
    ds_read_b64_tr_b16 a[236:237], v19
    ds_read_b64_tr_b16 a[238:239], v19 offset:2048
    v_mfma_f32_16x16x32_bf16 a[32:35], a[224:227], v[36:39], a[32:35]
    v_mfma_f32_16x16x32_bf16 a[160:163], a[224:227], v[40:43], a[160:163]
    buffer_load_dwordx4 v4, s[16:19], s49 offen offset:2048 lds
    v_mfma_f32_16x16x32_bf16 a[192:195], a[224:227], v[44:47], a[192:195]
    v_add_u32 v8, 0x8000, v8
    s_waitcnt lgkmcnt(4)
    v_mfma_f32_16x16x32_bf16 a[196:199], a[228:231], v[44:47], a[196:199]
    ds_read_b64_tr_b16 a[224:225], v20
    ds_read_b64_tr_b16 a[226:227], v20 offset:2048
    v_mfma_f32_16x16x32_bf16 a[164:167], a[228:231], v[40:43], a[164:167]
    v_mfma_f32_16x16x32_bf16 a[36:39], a[228:231], v[36:39], a[36:39]
    buffer_load_dwordx4 v5, s[16:19], s49 offen offset:3072 lds
    v_mfma_f32_16x16x32_bf16 a[4:7], a[228:231], v[32:35], a[4:7]
    v_add_u32 v16, 0x8000, v16
    v_add_u32 v19, 0x8000, v19
    s_waitcnt lgkmcnt(4)
    v_mfma_f32_16x16x32_bf16 a[8:11], a[232:235], v[32:35], a[8:11]
    ds_read_b64_tr_b16 a[228:229], v21
    ds_read_b64_tr_b16 a[230:231], v21 offset:2048
    v_mfma_f32_16x16x32_bf16 a[40:43], a[232:235], v[36:39], a[40:43]
    v_mfma_f32_16x16x32_bf16 a[168:171], a[232:235], v[40:43], a[168:171]
    v_mfma_f32_16x16x32_bf16 a[200:203], a[232:235], v[44:47], a[200:203]
    v_add_u32 v17, 0x8000, v17
    v_add_u32 v20, 0x8000, v20
    s_waitcnt lgkmcnt(4)
    v_mfma_f32_16x16x32_bf16 a[204:207], a[236:239], v[44:47], a[204:207]
    ds_read_b64_tr_b16 a[232:233], v22
    ds_read_b64_tr_b16 a[234:235], v22 offset:2048
    v_mfma_f32_16x16x32_bf16 a[172:175], a[236:239], v[40:43], a[172:175]
    s_add_u32 m0, s33, 0
    s_add_u32 s49, s49, 262144
    buffer_load_dwordx4 v6, s[20:23], s50 offen lds
    v_mfma_f32_16x16x32_bf16 a[44:47], a[236:239], v[36:39], a[44:47]
    v_mfma_f32_16x16x32_bf16 a[12:15], a[236:239], v[32:35], a[12:15]
    v_add_u32 v18, 0x8000, v18
    v_add_u32 v21, 0x8000, v21
    s_waitcnt lgkmcnt(4)
    v_mfma_f32_16x16x32_bf16 a[16:19], a[224:227], v[32:35], a[16:19]
    ds_read_b64_tr_b16 a[236:237], v23
    ds_read_b64_tr_b16 a[238:239], v23 offset:2048
    v_mfma_f32_16x16x32_bf16 a[48:51], a[224:227], v[36:39], a[48:51]
    v_mfma_f32_16x16x32_bf16 a[176:179], a[224:227], v[40:43], a[176:179]
    buffer_load_dwordx4 v7, s[20:23], s50 offen offset:1024 lds
    v_mfma_f32_16x16x32_bf16 a[208:211], a[224:227], v[44:47], a[208:211]
    v_add_u32 v22, 0x8000, v22
    s_waitcnt lgkmcnt(4)
    v_mfma_f32_16x16x32_bf16 a[212:215], a[228:231], v[44:47], a[212:215]
    ds_read_b64_tr_b16 a[224:225], v10
    ds_read_b64_tr_b16 a[226:227], v10 offset:1024
    v_mfma_f32_16x16x32_bf16 a[180:183], a[228:231], v[40:43], a[180:183]
    v_mfma_f32_16x16x32_bf16 a[52:55], a[228:231], v[36:39], a[52:55]
    v_mfma_f32_16x16x32_bf16 a[20:23], a[228:231], v[32:35], a[20:23]
    v_add_u32 v23, 0x8000, v23
    s_waitcnt lgkmcnt(4)
    v_mfma_f32_16x16x32_bf16 a[24:27], a[232:235], v[32:35], a[24:27]
    ds_read_b64_tr_b16 a[228:229], v11
    ds_read_b64_tr_b16 a[230:231], v11 offset:1024
    v_mfma_f32_16x16x32_bf16 a[56:59], a[232:235], v[36:39], a[56:59]
    s_add_u32 m0, m0, 8192
    s_add_u32 s50, s50, 114688
    buffer_load_dwordx4 v27, s[4:7], s51 offen sc1 lds
    v_mfma_f32_16x16x32_bf16 a[184:187], a[232:235], v[40:43], a[184:187]
    v_mfma_f32_16x16x32_bf16 a[216:219], a[232:235], v[44:47], a[216:219]
    v_add_u32 v10, 0x8000, v10
    s_waitcnt lgkmcnt(4)
    v_mfma_f32_16x16x32_bf16 a[220:223], a[236:239], v[44:47], a[220:223]
    ds_read_b64_tr_b16 a[232:233], v12
    ds_read_b64_tr_b16 a[234:235], v12 offset:1024
    v_mfma_f32_16x16x32_bf16 a[188:191], a[236:239], v[40:43], a[188:191]
    v_mfma_f32_16x16x32_bf16 a[60:63], a[236:239], v[36:39], a[60:63]
    buffer_load_dwordx4 v27, s[4:7], s51 offen offset:1024 sc1 lds
    s_add_u32 s51, s51, 2048
    s_cmp_eq_u32 s49, 3670016
    s_cselect_b32 s49, 0, s49
    s_cselect_b32 s50, s61, s50
    s_cselect_b32 s51, s62, s51
    v_mfma_f32_16x16x32_bf16 a[28:31], a[236:239], v[32:35], a[28:31]
    v_add_u32 v11, 0x8000, v11
    s_waitcnt lgkmcnt(4)
    v_mfma_f32_16x16x32_bf16 a[96:99], a[224:227], v[32:35], a[96:99]
    ds_read_b64_tr_b16 a[236:237], v13
    ds_read_b64_tr_b16 a[238:239], v13 offset:1024
    v_mfma_f32_16x16x32_bf16 a[112:115], a[224:227], v[36:39], a[112:115]
    v_mfma_f32_16x16x32_bf16 a[128:131], a[224:227], v[40:43], a[128:131]
    s_waitcnt vmcnt(16)
    s_barrier
    v_mfma_f32_16x16x32_bf16 a[144:147], a[224:227], v[44:47], a[144:147]
    ds_read_b128 a[240:243], v8 offset:0
    v_add_u32 v12, 0x8000, v12
    s_waitcnt lgkmcnt(5)
    v_mfma_f32_16x16x32_bf16 a[148:151], a[228:231], v[44:47], a[148:151]
    ds_read_b64_tr_b16 a[224:225], v16
    ds_read_b64_tr_b16 a[226:227], v16 offset:2048
    v_mfma_f32_16x16x32_bf16 a[132:135], a[228:231], v[40:43], a[132:135]
    ds_read_b128 a[244:247], v8 offset:1024
    ds_read_b128 a[248:251], v8 offset:2048
    v_mfma_f32_16x16x32_bf16 a[116:119], a[228:231], v[36:39], a[116:119]
    ds_read_b128 a[252:255], v8 offset:3072
    v_mfma_f32_16x16x32_bf16 a[100:103], a[228:231], v[32:35], a[100:103]
    v_add_u32 v13, 0x8000, v13
    s_waitcnt lgkmcnt(8)
    v_mfma_f32_16x16x32_bf16 a[104:107], a[232:235], v[32:35], a[104:107]
    ds_read_b64_tr_b16 a[228:229], v17
    ds_read_b64_tr_b16 a[230:231], v17 offset:2048
    v_mfma_f32_16x16x32_bf16 a[120:123], a[232:235], v[36:39], a[120:123]
    s_add_u32 m0, s32, 32768
    s_nop 0
    buffer_load_dwordx4 v2, s[16:19], s49 offen lds
    v_mfma_f32_16x16x32_bf16 a[136:139], a[232:235], v[40:43], a[136:139]
    v_mfma_f32_16x16x32_bf16 a[152:155], a[232:235], v[44:47], a[152:155]
    s_waitcnt lgkmcnt(8)
    v_mfma_f32_16x16x32_bf16 a[156:159], a[236:239], v[44:47], a[156:159]
    ds_read_b64_tr_b16 a[232:233], v18
    ds_read_b64_tr_b16 a[234:235], v18 offset:2048
    v_mfma_f32_16x16x32_bf16 a[140:143], a[236:239], v[40:43], a[140:143]
    v_mfma_f32_16x16x32_bf16 a[124:127], a[236:239], v[36:39], a[124:127]
    buffer_load_dwordx4 v3, s[16:19], s49 offen offset:1024 lds
    v_mfma_f32_16x16x32_bf16 a[108:111], a[236:239], v[32:35], a[108:111]
    s_cmp_lg_u32 s24, 0
    s_cbranch_scc1 L_ld2
    s_lshl_b32 s42, s27, 7
    s_add_u32 s42, s42, 83886080
    buffer_load_dword v29, v28, s[4:7], s42 offen sc1
L_ld2:
    s_waitcnt lgkmcnt(7)
    s_waitcnt lgkmcnt(4)
    v_mfma_f32_16x16x32_bf16 a[0:3], a[224:227], a[240:243], a[0:3]
    ds_read_b64_tr_b16 a[236:237], v19
    ds_read_b64_tr_b16 a[238:239], v19 offset:2048
    v_mfma_f32_16x16x32_bf16 a[32:35], a[224:227], a[244:247], a[32:35]
    v_mfma_f32_16x16x32_bf16 a[160:163], a[224:227], a[248:251], a[160:163]
    buffer_load_dwordx4 v4, s[16:19], s49 offen offset:2048 lds
    v_mfma_f32_16x16x32_bf16 a[192:195], a[224:227], a[252:255], a[192:195]
    v_add_u32 v8, 0x8000, v8
    s_waitcnt lgkmcnt(4)
    v_mfma_f32_16x16x32_bf16 a[196:199], a[228:231], a[252:255], a[196:199]
    ds_read_b64_tr_b16 a[224:225], v20
    ds_read_b64_tr_b16 a[226:227], v20 offset:2048
    v_mfma_f32_16x16x32_bf16 a[164:167], a[228:231], a[248:251], a[164:167]
    v_mfma_f32_16x16x32_bf16 a[36:39], a[228:231], a[244:247], a[36:39]
    buffer_load_dwordx4 v5, s[16:19], s49 offen offset:3072 lds
    v_mfma_f32_16x16x32_bf16 a[4:7], a[228:231], a[240:243], a[4:7]
    v_add_u32 v16, 0x8000, v16
    v_add_u32 v19, 0x8000, v19
    s_waitcnt lgkmcnt(4)
    v_mfma_f32_16x16x32_bf16 a[8:11], a[232:235], a[240:243], a[8:11]
    ds_read_b64_tr_b16 a[228:229], v21
    ds_read_b64_tr_b16 a[230:231], v21 offset:2048
    v_mfma_f32_16x16x32_bf16 a[40:43], a[232:235], a[244:247], a[40:43]
    v_mfma_f32_16x16x32_bf16 a[168:171], a[232:235], a[248:251], a[168:171]
    v_mfma_f32_16x16x32_bf16 a[200:203], a[232:235], a[252:255], a[200:203]
    v_add_u32 v17, 0x8000, v17
    v_add_u32 v20, 0x8000, v20
    s_waitcnt lgkmcnt(4)
    v_mfma_f32_16x16x32_bf16 a[204:207], a[236:239], a[252:255], a[204:207]
    ds_read_b64_tr_b16 a[232:233], v22
    ds_read_b64_tr_b16 a[234:235], v22 offset:2048
    v_mfma_f32_16x16x32_bf16 a[172:175], a[236:239], a[248:251], a[172:175]
    s_add_u32 m0, s33, 32768
    s_add_u32 s49, s49, 262144
    buffer_load_dwordx4 v6, s[20:23], s50 offen lds
    v_mfma_f32_16x16x32_bf16 a[44:47], a[236:239], a[244:247], a[44:47]
    v_mfma_f32_16x16x32_bf16 a[12:15], a[236:239], a[240:243], a[12:15]
    v_add_u32 v18, 0x8000, v18
    v_add_u32 v21, 0x8000, v21
    s_waitcnt lgkmcnt(4)
    v_mfma_f32_16x16x32_bf16 a[16:19], a[224:227], a[240:243], a[16:19]
    ds_read_b64_tr_b16 a[236:237], v23
    ds_read_b64_tr_b16 a[238:239], v23 offset:2048
    v_mfma_f32_16x16x32_bf16 a[48:51], a[224:227], a[244:247], a[48:51]
    v_mfma_f32_16x16x32_bf16 a[176:179], a[224:227], a[248:251], a[176:179]
    buffer_load_dwordx4 v7, s[20:23], s50 offen offset:1024 lds
    v_mfma_f32_16x16x32_bf16 a[208:211], a[224:227], a[252:255], a[208:211]
    v_add_u32 v22, 0x8000, v22
    s_waitcnt lgkmcnt(4)
    v_mfma_f32_16x16x32_bf16 a[212:215], a[228:231], a[252:255], a[212:215]
    ds_read_b64_tr_b16 a[224:225], v10
    ds_read_b64_tr_b16 a[226:227], v10 offset:1024
    v_mfma_f32_16x16x32_bf16 a[180:183], a[228:231], a[248:251], a[180:183]
    v_mfma_f32_16x16x32_bf16 a[52:55], a[228:231], a[244:247], a[52:55]
    v_mfma_f32_16x16x32_bf16 a[20:23], a[228:231], a[240:243], a[20:23]
    v_add_u32 v23, 0x8000, v23
    s_waitcnt lgkmcnt(4)
    v_mfma_f32_16x16x32_bf16 a[24:27], a[232:235], a[240:243], a[24:27]
    ds_read_b64_tr_b16 a[228:229], v11
    ds_read_b64_tr_b16 a[230:231], v11 offset:1024
    v_mfma_f32_16x16x32_bf16 a[56:59], a[232:235], a[244:247], a[56:59]
    s_add_u32 m0, m0, 8192
    s_add_u32 s50, s50, 114688
    buffer_load_dwordx4 v27, s[4:7], s51 offen sc1 lds
    v_mfma_f32_16x16x32_bf16 a[184:187], a[232:235], a[248:251], a[184:187]
    v_mfma_f32_16x16x32_bf16 a[216:219], a[232:235], a[252:255], a[216:219]
    v_add_u32 v10, 0x8000, v10
    s_waitcnt lgkmcnt(4)
    v_mfma_f32_16x16x32_bf16 a[220:223], a[236:239], a[252:255], a[220:223]
    ds_read_b64_tr_b16 a[232:233], v12
    ds_read_b64_tr_b16 a[234:235], v12 offset:1024
    v_mfma_f32_16x16x32_bf16 a[188:191], a[236:239], a[248:251], a[188:191]
    v_mfma_f32_16x16x32_bf16 a[60:63], a[236:239], a[244:247], a[60:63]
    buffer_load_dwordx4 v27, s[4:7], s51 offen offset:1024 sc1 lds
    s_add_u32 s51, s51, 2048
    s_cmp_eq_u32 s49, 3670016
    s_cselect_b32 s49, 0, s49
    s_cselect_b32 s50, s61, s50
    s_cselect_b32 s51, s62, s51
    v_mfma_f32_16x16x32_bf16 a[28:31], a[236:239], a[240:243], a[28:31]
    v_add_u32 v11, 0x8000, v11
    s_waitcnt lgkmcnt(4)
    v_mfma_f32_16x16x32_bf16 a[96:99], a[224:227], a[240:243], a[96:99]
    ds_read_b64_tr_b16 a[236:237], v13
    ds_read_b64_tr_b16 a[238:239], v13 offset:1024
    v_mfma_f32_16x16x32_bf16 a[112:115], a[224:227], a[244:247], a[112:115]
    v_mfma_f32_16x16x32_bf16 a[128:131], a[224:227], a[248:251], a[128:131]
    s_waitcnt vmcnt(16)
    s_barrier
    v_mfma_f32_16x16x32_bf16 a[144:147], a[224:227], a[252:255], a[144:147]
    ds_read_b128 v[32:35], v8 offset:0
    v_add_u32 v12, 0x8000, v12
    s_waitcnt lgkmcnt(5)
    v_mfma_f32_16x16x32_bf16 a[148:151], a[228:231], a[252:255], a[148:151]
    ds_read_b64_tr_b16 a[224:225], v16
    ds_read_b64_tr_b16 a[226:227], v16 offset:2048
    v_mfma_f32_16x16x32_bf16 a[132:135], a[228:231], a[248:251], a[132:135]
    ds_read_b128 v[36:39], v8 offset:1024
    ds_read_b128 v[40:43], v8 offset:2048
    v_mfma_f32_16x16x32_bf16 a[116:119], a[228:231], a[244:247], a[116:119]
    ds_read_b128 v[44:47], v8 offset:3072
    v_mfma_f32_16x16x32_bf16 a[100:103], a[228:231], a[240:243], a[100:103]
    v_add_u32 v13, 0x8000, v13
    s_waitcnt lgkmcnt(8)
    v_mfma_f32_16x16x32_bf16 a[104:107], a[232:235], a[240:243], a[104:107]
    ds_read_b64_tr_b16 a[228:229], v17
    ds_read_b64_tr_b16 a[230:231], v17 offset:2048
    v_mfma_f32_16x16x32_bf16 a[120:123], a[232:235], a[244:247], a[120:123]
    v_mfma_f32_16x16x32_bf16 a[136:139], a[232:235], a[248:251], a[136:139]
    v_mfma_f32_16x16x32_bf16 a[152:155], a[232:235], a[252:255], a[152:155]
    s_waitcnt lgkmcnt(8)
    v_mfma_f32_16x16x32_bf16 a[156:159], a[236:239], a[252:255], a[156:159]
    ds_read_b64_tr_b16 a[232:233], v18
    ds_read_b64_tr_b16 a[234:235], v18 offset:2048
    v_mfma_f32_16x16x32_bf16 a[140:143], a[236:239], a[248:251], a[140:143]
    v_mfma_f32_16x16x32_bf16 a[124:127], a[236:239], a[244:247], a[124:127]
    v_mfma_f32_16x16x32_bf16 a[108:111], a[236:239], a[240:243], a[108:111]
    s_cmp_lg_u32 s24, 0
    s_cbranch_scc1 L_poll2
    s_mov_b32 s3, 0
    s_waitcnt vmcnt(6)
L_pl2:
    v_readfirstlane_b32 s98, v29
    s_add_u32 s3, s3, 1
    s_cmp_ge_u32 s98, 16
    s_cbranch_scc1 L_pl2_ok
    s_cmp_ge_u32 s3, 0x400000
    s_cbranch_scc1 L_pl2_ok
    s_sleep 1
    buffer_load_dword v29, v28, s[4:7], s42 offen sc1
    s_waitcnt vmcnt(0)
    s_branch L_pl2
L_pl2_ok:
L_poll2:
    s_waitcnt lgkmcnt(7)
    s_waitcnt lgkmcnt(4)
    v_mfma_f32_16x16x32_bf16 a[0:3], a[224:227], v[32:35], a[0:3]
    ds_read_b64_tr_b16 a[236:237], v19
    ds_read_b64_tr_b16 a[238:239], v19 offset:2048
    v_mfma_f32_16x16x32_bf16 a[32:35], a[224:227], v[36:39], a[32:35]
    v_mfma_f32_16x16x32_bf16 a[160:163], a[224:227], v[40:43], a[160:163]
    v_mfma_f32_16x16x32_bf16 a[192:195], a[224:227], v[44:47], a[192:195]
    v_add_u32 v8, 0xfffe0000, v8
    s_waitcnt lgkmcnt(4)
    v_mfma_f32_16x16x32_bf16 a[196:199], a[228:231], v[44:47], a[196:199]
    ds_read_b64_tr_b16 a[224:225], v20
    ds_read_b64_tr_b16 a[226:227], v20 offset:2048
    v_mfma_f32_16x16x32_bf16 a[164:167], a[228:231], v[40:43], a[164:167]
    v_mfma_f32_16x16x32_bf16 a[36:39], a[228:231], v[36:39], a[36:39]
    v_mfma_f32_16x16x32_bf16 a[4:7], a[228:231], v[32:35], a[4:7]
    v_add_u32 v16, 0xfffe0000, v16
    v_add_u32 v19, 0xfffe0000, v19
    s_waitcnt lgkmcnt(4)
    v_mfma_f32_16x16x32_bf16 a[8:11], a[232:235], v[32:35], a[8:11]
    ds_read_b64_tr_b16 a[228:229], v21
    ds_read_b64_tr_b16 a[230:231], v21 offset:2048
    v_mfma_f32_16x16x32_bf16 a[40:43], a[232:235], v[36:39], a[40:43]
    v_mfma_f32_16x16x32_bf16 a[168:171], a[232:235], v[40:43], a[168:171]
    v_mfma_f32_16x16x32_bf16 a[200:203], a[232:235], v[44:47], a[200:203]
    v_add_u32 v17, 0xfffe0000, v17
    v_add_u32 v20, 0xfffe0000, v20
    s_waitcnt lgkmcnt(4)
    v_mfma_f32_16x16x32_bf16 a[204:207], a[236:239], v[44:47], a[204:207]
    ds_read_b64_tr_b16 a[232:233], v22
    ds_read_b64_tr_b16 a[234:235], v22 offset:2048
    v_mfma_f32_16x16x32_bf16 a[172:175], a[236:239], v[40:43], a[172:175]
    v_mfma_f32_16x16x32_bf16 a[44:47], a[236:239], v[36:39], a[44:47]
    v_mfma_f32_16x16x32_bf16 a[12:15], a[236:239], v[32:35], a[12:15]
    v_add_u32 v18, 0xfffe0000, v18
    v_add_u32 v21, 0xfffe0000, v21
    s_waitcnt lgkmcnt(4)
    v_mfma_f32_16x16x32_bf16 a[16:19], a[224:227], v[32:35], a[16:19]
    ds_read_b64_tr_b16 a[236:237], v23
    ds_read_b64_tr_b16 a[238:239], v23 offset:2048
    v_mfma_f32_16x16x32_bf16 a[48:51], a[224:227], v[36:39], a[48:51]
    v_mfma_f32_16x16x32_bf16 a[176:179], a[224:227], v[40:43], a[176:179]
    v_mfma_f32_16x16x32_bf16 a[208:211], a[224:227], v[44:47], a[208:211]
    v_add_u32 v22, 0xfffe0000, v22
    s_waitcnt lgkmcnt(4)
    v_mfma_f32_16x16x32_bf16 a[212:215], a[228:231], v[44:47], a[212:215]
    ds_read_b64_tr_b16 a[224:225], v10
    ds_read_b64_tr_b16 a[226:227], v10 offset:1024
    v_mfma_f32_16x16x32_bf16 a[180:183], a[228:231], v[40:43], a[180:183]
    v_mfma_f32_16x16x32_bf16 a[52:55], a[228:231], v[36:39], a[52:55]
    v_mfma_f32_16x16x32_bf16 a[20:23], a[228:231], v[32:35], a[20:23]
    v_add_u32 v23, 0xfffe0000, v23
    s_waitcnt lgkmcnt(4)
    v_mfma_f32_16x16x32_bf16 a[24:27], a[232:235], v[32:35], a[24:27]
    ds_read_b64_tr_b16 a[228:229], v11
    ds_read_b64_tr_b16 a[230:231], v11 offset:1024
    v_mfma_f32_16x16x32_bf16 a[56:59], a[232:235], v[36:39], a[56:59]
    v_mfma_f32_16x16x32_bf16 a[184:187], a[232:235], v[40:43], a[184:187]
    v_mfma_f32_16x16x32_bf16 a[216:219], a[232:235], v[44:47], a[216:219]
    v_add_u32 v10, 0xfffe0000, v10
    s_waitcnt lgkmcnt(4)
    v_mfma_f32_16x16x32_bf16 a[220:223], a[236:239], v[44:47], a[220:223]
    ds_read_b64_tr_b16 a[232:233], v12
    ds_read_b64_tr_b16 a[234:235], v12 offset:1024
    v_mfma_f32_16x16x32_bf16 a[188:191], a[236:239], v[40:43], a[188:191]
    v_mfma_f32_16x16x32_bf16 a[60:63], a[236:239], v[36:39], a[60:63]
    v_mfma_f32_16x16x32_bf16 a[28:31], a[236:239], v[32:35], a[28:31]
    v_add_u32 v11, 0xfffe0000, v11
    s_waitcnt lgkmcnt(4)
    v_mfma_f32_16x16x32_bf16 a[96:99], a[224:227], v[32:35], a[96:99]
    ds_read_b64_tr_b16 a[236:237], v13
    ds_read_b64_tr_b16 a[238:239], v13 offset:1024
    v_mfma_f32_16x16x32_bf16 a[112:115], a[224:227], v[36:39], a[112:115]
    v_mfma_f32_16x16x32_bf16 a[128:131], a[224:227], v[40:43], a[128:131]
    s_waitcnt vmcnt(8)
    s_barrier
    v_mfma_f32_16x16x32_bf16 a[144:147], a[224:227], v[44:47], a[144:147]
    ds_read_b128 a[240:243], v8 offset:0
    v_add_u32 v12, 0xfffe0000, v12
    s_waitcnt lgkmcnt(5)
    v_mfma_f32_16x16x32_bf16 a[148:151], a[228:231], v[44:47], a[148:151]
    ds_read_b64_tr_b16 a[224:225], v16
    ds_read_b64_tr_b16 a[226:227], v16 offset:2048
    v_mfma_f32_16x16x32_bf16 a[132:135], a[228:231], v[40:43], a[132:135]
    ds_read_b128 a[244:247], v8 offset:1024
    ds_read_b128 a[248:251], v8 offset:2048
    v_mfma_f32_16x16x32_bf16 a[116:119], a[228:231], v[36:39], a[116:119]
    ds_read_b128 a[252:255], v8 offset:3072
    v_mfma_f32_16x16x32_bf16 a[100:103], a[228:231], v[32:35], a[100:103]
    v_add_u32 v13, 0xfffe0000, v13
    s_waitcnt lgkmcnt(8)
    v_mfma_f32_16x16x32_bf16 a[104:107], a[232:235], v[32:35], a[104:107]
    ds_read_b64_tr_b16 a[228:229], v17
    ds_read_b64_tr_b16 a[230:231], v17 offset:2048
    v_mfma_f32_16x16x32_bf16 a[120:123], a[232:235], v[36:39], a[120:123]
    s_add_u32 m0, s31, 65536
    s_nop 0
    buffer_load_dwordx4 v27, s[4:7], s38 offen sc1 lds
    v_mfma_f32_16x16x32_bf16 a[136:139], a[232:235], v[40:43], a[136:139]
    v_mfma_f32_16x16x32_bf16 a[152:155], a[232:235], v[44:47], a[152:155]
    s_waitcnt lgkmcnt(8)
    v_mfma_f32_16x16x32_bf16 a[156:159], a[236:239], v[44:47], a[156:159]
    ds_read_b64_tr_b16 a[232:233], v18
    ds_read_b64_tr_b16 a[234:235], v18 offset:2048
    v_mfma_f32_16x16x32_bf16 a[140:143], a[236:239], v[40:43], a[140:143]
    buffer_load_dwordx4 v27, s[4:7], s38 offen offset:1024 sc1 lds
    v_mfma_f32_16x16x32_bf16 a[124:127], a[236:239], v[36:39], a[124:127]
    v_mfma_f32_16x16x32_bf16 a[108:111], a[236:239], v[32:35], a[108:111]
    s_waitcnt lgkmcnt(7)
    s_waitcnt lgkmcnt(4)
    v_mfma_f32_16x16x32_bf16 a[0:3], a[224:227], a[240:243], a[0:3]
    ds_read_b64_tr_b16 a[236:237], v19
    ds_read_b64_tr_b16 a[238:239], v19 offset:2048
    v_mfma_f32_16x16x32_bf16 a[32:35], a[224:227], a[244:247], a[32:35]
    buffer_load_dwordx4 v27, s[4:7], s38 offen offset:2048 sc1 lds
    v_mfma_f32_16x16x32_bf16 a[160:163], a[224:227], a[248:251], a[160:163]
    v_mfma_f32_16x16x32_bf16 a[192:195], a[224:227], a[252:255], a[192:195]
    v_add_u32 v8, 0x8000, v8
    s_waitcnt lgkmcnt(4)
    v_mfma_f32_16x16x32_bf16 a[196:199], a[228:231], a[252:255], a[196:199]
    ds_read_b64_tr_b16 a[224:225], v20
    ds_read_b64_tr_b16 a[226:227], v20 offset:2048
    buffer_load_dwordx4 v27, s[4:7], s38 offen offset:3072 sc1 lds
    s_add_u32 m0, m0, 4096
    v_mfma_f32_16x16x32_bf16 a[164:167], a[228:231], a[248:251], a[164:167]
    v_mfma_f32_16x16x32_bf16 a[36:39], a[228:231], a[244:247], a[36:39]
    v_mfma_f32_16x16x32_bf16 a[4:7], a[228:231], a[240:243], a[4:7]
    v_add_u32 v16, 0x8000, v16
    v_add_u32 v19, 0x8000, v19
    s_waitcnt lgkmcnt(4)
    v_mfma_f32_16x16x32_bf16 a[8:11], a[232:235], a[240:243], a[8:11]
    ds_read_b64_tr_b16 a[228:229], v21
    ds_read_b64_tr_b16 a[230:231], v21 offset:2048
    buffer_load_dwordx4 v26, s[4:7], s38 offen sc1 lds
    v_mfma_f32_16x16x32_bf16 a[40:43], a[232:235], a[244:247], a[40:43]
    v_mfma_f32_16x16x32_bf16 a[168:171], a[232:235], a[248:251], a[168:171]
    v_mfma_f32_16x16x32_bf16 a[200:203], a[232:235], a[252:255], a[200:203]
    v_add_u32 v17, 0x8000, v17
    v_add_u32 v20, 0x8000, v20
    s_waitcnt lgkmcnt(4)
    v_mfma_f32_16x16x32_bf16 a[204:207], a[236:239], a[252:255], a[204:207]
    ds_read_b64_tr_b16 a[232:233], v22
    ds_read_b64_tr_b16 a[234:235], v22 offset:2048
    buffer_load_dwordx4 v26, s[4:7], s38 offen offset:1024 sc1 lds
    v_mfma_f32_16x16x32_bf16 a[172:175], a[236:239], a[248:251], a[172:175]
    v_mfma_f32_16x16x32_bf16 a[44:47], a[236:239], a[244:247], a[44:47]
    v_mfma_f32_16x16x32_bf16 a[12:15], a[236:239], a[240:243], a[12:15]
    v_add_u32 v18, 0x8000, v18
    v_add_u32 v21, 0x8000, v21
    s_waitcnt lgkmcnt(4)
    v_mfma_f32_16x16x32_bf16 a[16:19], a[224:227], a[240:243], a[16:19]
    ds_read_b64_tr_b16 a[236:237], v23
    ds_read_b64_tr_b16 a[238:239], v23 offset:2048
    buffer_load_dwordx4 v26, s[4:7], s38 offen offset:2048 sc1 lds
    v_mfma_f32_16x16x32_bf16 a[48:51], a[224:227], a[244:247], a[48:51]
    v_mfma_f32_16x16x32_bf16 a[176:179], a[224:227], a[248:251], a[176:179]
    v_mfma_f32_16x16x32_bf16 a[208:211], a[224:227], a[252:255], a[208:211]
    v_add_u32 v22, 0x8000, v22
    s_waitcnt lgkmcnt(4)
    v_mfma_f32_16x16x32_bf16 a[212:215], a[228:231], a[252:255], a[212:215]
    ds_read_b64_tr_b16 a[224:225], v10
    ds_read_b64_tr_b16 a[226:227], v10 offset:1024
    buffer_load_dwordx4 v26, s[4:7], s38 offen offset:3072 sc1 lds
    s_add_u32 s38, s38, 32768
    s_cmp_eq_u32 s38, s44
    s_cselect_b32 s38, s46, s38
    v_mfma_f32_16x16x32_bf16 a[180:183], a[228:231], a[248:251], a[180:183]
    v_mfma_f32_16x16x32_bf16 a[52:55], a[228:231], a[244:247], a[52:55]
    v_mfma_f32_16x16x32_bf16 a[20:23], a[228:231], a[240:243], a[20:23]
    v_add_u32 v23, 0x8000, v23
    s_waitcnt lgkmcnt(4)
    v_mfma_f32_16x16x32_bf16 a[24:27], a[232:235], a[240:243], a[24:27]
    ds_read_b64_tr_b16 a[228:229], v11
    ds_read_b64_tr_b16 a[230:231], v11 offset:1024
    s_add_u32 m0, s31, 98304
    s_nop 0
    buffer_load_dwordx4 v27, s[4:7], s38 offen sc1 lds
    v_mfma_f32_16x16x32_bf16 a[56:59], a[232:235], a[244:247], a[56:59]
    v_mfma_f32_16x16x32_bf16 a[184:187], a[232:235], a[248:251], a[184:187]
    v_mfma_f32_16x16x32_bf16 a[216:219], a[232:235], a[252:255], a[216:219]
    v_add_u32 v10, 0x8000, v10
    s_waitcnt lgkmcnt(4)
    v_mfma_f32_16x16x32_bf16 a[220:223], a[236:239], a[252:255], a[220:223]
    ds_read_b64_tr_b16 a[232:233], v12
    ds_read_b64_tr_b16 a[234:235], v12 offset:1024
    buffer_load_dwordx4 v27, s[4:7], s38 offen offset:1024 sc1 lds
    v_mfma_f32_16x16x32_bf16 a[188:191], a[236:239], a[248:251], a[188:191]
    v_mfma_f32_16x16x32_bf16 a[60:63], a[236:239], a[244:247], a[60:63]
    v_mfma_f32_16x16x32_bf16 a[28:31], a[236:239], a[240:243], a[28:31]
    v_add_u32 v11, 0x8000, v11
    s_waitcnt lgkmcnt(4)
    v_mfma_f32_16x16x32_bf16 a[96:99], a[224:227], a[240:243], a[96:99]
    ds_read_b64_tr_b16 a[236:237], v13
    ds_read_b64_tr_b16 a[238:239], v13 offset:1024
    buffer_load_dwordx4 v27, s[4:7], s38 offen offset:2048 sc1 lds
    v_mfma_f32_16x16x32_bf16 a[112:115], a[224:227], a[244:247], a[112:115]
    v_mfma_f32_16x16x32_bf16 a[128:131], a[224:227], a[248:251], a[128:131]
    s_waitcnt vmcnt(11)
    s_barrier
    v_mfma_f32_16x16x32_bf16 a[144:147], a[224:227], a[252:255], a[144:147]
    ds_read_b128 v[32:35], v8 offset:0
    v_add_u32 v12, 0x8000, v12
    s_waitcnt lgkmcnt(5)
    v_mfma_f32_16x16x32_bf16 a[148:151], a[228:231], a[252:255], a[148:151]
    ds_read_b64_tr_b16 a[224:225], v16
    ds_read_b64_tr_b16 a[226:227], v16 offset:2048
    buffer_load_dwordx4 v27, s[4:7], s38 offen offset:3072 sc1 lds
    s_add_u32 m0, m0, 4096
    v_mfma_f32_16x16x32_bf16 a[132:135], a[228:231], a[248:251], a[132:135]
    ds_read_b128 v[36:39], v8 offset:1024
    ds_read_b128 v[40:43], v8 offset:2048
    v_mfma_f32_16x16x32_bf16 a[116:119], a[228:231], a[244:247], a[116:119]
    ds_read_b128 v[44:47], v8 offset:3072
    v_mfma_f32_16x16x32_bf16 a[100:103], a[228:231], a[240:243], a[100:103]
    v_add_u32 v13, 0x8000, v13
    s_waitcnt lgkmcnt(8)
    v_mfma_f32_16x16x32_bf16 a[104:107], a[232:235], a[240:243], a[104:107]
    ds_read_b64_tr_b16 a[228:229], v17
    ds_read_b64_tr_b16 a[230:231], v17 offset:2048
    buffer_load_dwordx4 v26, s[4:7], s38 offen sc1 lds
    v_mfma_f32_16x16x32_bf16 a[120:123], a[232:235], a[244:247], a[120:123]
    v_mfma_f32_16x16x32_bf16 a[136:139], a[232:235], a[248:251], a[136:139]
    v_mfma_f32_16x16x32_bf16 a[152:155], a[232:235], a[252:255], a[152:155]
    s_waitcnt lgkmcnt(8)
    v_mfma_f32_16x16x32_bf16 a[156:159], a[236:239], a[252:255], a[156:159]
    ds_read_b64_tr_b16 a[232:233], v18
    ds_read_b64_tr_b16 a[234:235], v18 offset:2048
    buffer_load_dwordx4 v26, s[4:7], s38 offen offset:1024 sc1 lds
    v_mfma_f32_16x16x32_bf16 a[140:143], a[236:239], a[248:251], a[140:143]
    v_mfma_f32_16x16x32_bf16 a[124:127], a[236:239], a[244:247], a[124:127]
    v_mfma_f32_16x16x32_bf16 a[108:111], a[236:239], a[240:243], a[108:111]
    s_waitcnt lgkmcnt(7)
    s_waitcnt lgkmcnt(4)
    v_mfma_f32_16x16x32_bf16 a[0:3], a[224:227], v[32:35], a[0:3]
    ds_read_b64_tr_b16 a[236:237], v19
    ds_read_b64_tr_b16 a[238:239], v19 offset:2048
    v_mfma_f32_16x16x32_bf16 a[32:35], a[224:227], v[36:39], a[32:35]
    buffer_load_dwordx4 v26, s[4:7], s38 offen offset:2048 sc1 lds
    v_mfma_f32_16x16x32_bf16 a[160:163], a[224:227], v[40:43], a[160:163]
    v_mfma_f32_16x16x32_bf16 a[192:195], a[224:227], v[44:47], a[192:195]
    s_waitcnt lgkmcnt(4)
    v_mfma_f32_16x16x32_bf16 a[196:199], a[228:231], v[44:47], a[196:199]
    ds_read_b64_tr_b16 a[224:225], v20
    ds_read_b64_tr_b16 a[226:227], v20 offset:2048
    v_mfma_f32_16x16x32_bf16 a[164:167], a[228:231], v[40:43], a[164:167]
    buffer_load_dwordx4 v26, s[4:7], s38 offen offset:3072 sc1 lds
    s_add_u32 s38, s38, 32768
    s_cmp_eq_u32 s38, s44
    s_cselect_b32 s38, s46, s38
    v_mfma_f32_16x16x32_bf16 a[36:39], a[228:231], v[36:39], a[36:39]
    v_mfma_f32_16x16x32_bf16 a[4:7], a[228:231], v[32:35], a[4:7]
    s_waitcnt lgkmcnt(4)
    v_mfma_f32_16x16x32_bf16 a[8:11], a[232:235], v[32:35], a[8:11]
    ds_read_b64_tr_b16 a[228:229], v21
    ds_read_b64_tr_b16 a[230:231], v21 offset:2048
    v_mfma_f32_16x16x32_bf16 a[40:43], a[232:235], v[36:39], a[40:43]
    s_add_u32 m0, s31, 131072
    s_nop 0
    buffer_load_dwordx4 v27, s[4:7], s39 offen sc1 lds
    v_mfma_f32_16x16x32_bf16 a[168:171], a[232:235], v[40:43], a[168:171]
    v_mfma_f32_16x16x32_bf16 a[200:203], a[232:235], v[44:47], a[200:203]
    s_waitcnt lgkmcnt(4)
    v_mfma_f32_16x16x32_bf16 a[204:207], a[236:239], v[44:47], a[204:207]
    ds_read_b64_tr_b16 a[232:233], v22
    ds_read_b64_tr_b16 a[234:235], v22 offset:2048
    v_mfma_f32_16x16x32_bf16 a[172:175], a[236:239], v[40:43], a[172:175]
    buffer_load_dwordx4 v27, s[4:7], s39 offen offset:1024 sc1 lds
    v_mfma_f32_16x16x32_bf16 a[44:47], a[236:239], v[36:39], a[44:47]
    v_mfma_f32_16x16x32_bf16 a[12:15], a[236:239], v[32:35], a[12:15]
    s_waitcnt lgkmcnt(4)
    v_mfma_f32_16x16x32_bf16 a[16:19], a[224:227], v[32:35], a[16:19]
    ds_read_b64_tr_b16 a[236:237], v23
    ds_read_b64_tr_b16 a[238:239], v23 offset:2048
    v_mfma_f32_16x16x32_bf16 a[48:51], a[224:227], v[36:39], a[48:51]
    v_mfma_f32_16x16x32_bf16 a[176:179], a[224:227], v[40:43], a[176:179]
    buffer_load_dwordx4 v27, s[4:7], s39 offen offset:2048 sc1 lds
    v_mfma_f32_16x16x32_bf16 a[208:211], a[224:227], v[44:47], a[208:211]
    s_waitcnt lgkmcnt(4)
    v_mfma_f32_16x16x32_bf16 a[212:215], a[228:231], v[44:47], a[212:215]
    ds_read_b64_tr_b16 a[224:225], v10
    ds_read_b64_tr_b16 a[226:227], v10 offset:1024
    v_mfma_f32_16x16x32_bf16 a[180:183], a[228:231], v[40:43], a[180:183]
    v_mfma_f32_16x16x32_bf16 a[52:55], a[228:231], v[36:39], a[52:55]
    buffer_load_dwordx4 v27, s[4:7], s39 offen offset:3072 sc1 lds
    s_add_u32 m0, m0, 4096
    v_mfma_f32_16x16x32_bf16 a[20:23], a[228:231], v[32:35], a[20:23]
    s_waitcnt lgkmcnt(4)
    v_mfma_f32_16x16x32_bf16 a[24:27], a[232:235], v[32:35], a[24:27]
    ds_read_b64_tr_b16 a[228:229], v11
    ds_read_b64_tr_b16 a[230:231], v11 offset:1024
    v_mfma_f32_16x16x32_bf16 a[56:59], a[232:235], v[36:39], a[56:59]
    v_mfma_f32_16x16x32_bf16 a[184:187], a[232:235], v[40:43], a[184:187]
    buffer_load_dwordx4 v26, s[4:7], s39 offen sc1 lds
    v_mfma_f32_16x16x32_bf16 a[216:219], a[232:235], v[44:47], a[216:219]
    s_waitcnt lgkmcnt(4)
    v_mfma_f32_16x16x32_bf16 a[220:223], a[236:239], v[44:47], a[220:223]
    ds_read_b64_tr_b16 a[232:233], v12
    ds_read_b64_tr_b16 a[234:235], v12 offset:1024
    v_mfma_f32_16x16x32_bf16 a[188:191], a[236:239], v[40:43], a[188:191]
    v_mfma_f32_16x16x32_bf16 a[60:63], a[236:239], v[36:39], a[60:63]
    v_mfma_f32_16x16x32_bf16 a[28:31], a[236:239], v[32:35], a[28:31]
    buffer_load_dwordx4 v26, s[4:7], s39 offen offset:1024 sc1 lds
    s_waitcnt lgkmcnt(4)
    v_mfma_f32_16x16x32_bf16 a[96:99], a[224:227], v[32:35], a[96:99]
    ds_read_b64_tr_b16 a[236:237], v13
    ds_read_b64_tr_b16 a[238:239], v13 offset:1024
    v_mfma_f32_16x16x32_bf16 a[112:115], a[224:227], v[36:39], a[112:115]
    v_mfma_f32_16x16x32_bf16 a[128:131], a[224:227], v[40:43], a[128:131]
    v_mfma_f32_16x16x32_bf16 a[144:147], a[224:227], v[44:47], a[144:147]
    buffer_load_dwordx4 v26, s[4:7], s39 offen offset:2048 sc1 lds
    s_waitcnt lgkmcnt(4)
    v_mfma_f32_16x16x32_bf16 a[148:151], a[228:231], v[44:47], a[148:151]
    v_mfma_f32_16x16x32_bf16 a[132:135], a[228:231], v[40:43], a[132:135]
    v_mfma_f32_16x16x32_bf16 a[116:119], a[228:231], v[36:39], a[116:119]
    v_mfma_f32_16x16x32_bf16 a[100:103], a[228:231], v[32:35], a[100:103]
    buffer_load_dwordx4 v26, s[4:7], s39 offen offset:3072 sc1 lds
    s_add_u32 s39, s39, 32768
    s_cmp_eq_u32 s39, s45
    s_cselect_b32 s39, s47, s39
    s_waitcnt lgkmcnt(2)
    v_mfma_f32_16x16x32_bf16 a[104:107], a[232:235], v[32:35], a[104:107]
    v_mfma_f32_16x16x32_bf16 a[120:123], a[232:235], v[36:39], a[120:123]
    v_mfma_f32_16x16x32_bf16 a[136:139], a[232:235], v[40:43], a[136:139]
    v_mfma_f32_16x16x32_bf16 a[152:155], a[232:235], v[44:47], a[152:155]
    s_waitcnt lgkmcnt(0)
    v_mfma_f32_16x16x32_bf16 a[156:159], a[236:239], v[44:47], a[156:159]
    v_mfma_f32_16x16x32_bf16 a[140:143], a[236:239], v[40:43], a[140:143]
    v_mfma_f32_16x16x32_bf16 a[124:127], a[236:239], v[36:39], a[124:127]
    v_mfma_f32_16x16x32_bf16 a[108:111], a[236:239], v[32:35], a[108:111]
    s_barrier
    s_mov_b32 s40, 0x3db8aa3b
    s_mov_b32 s41, s40
    s_lshl_b32 s42, s25, 14
    v_add_u32 v28, s42, v27
    s_lshl_b32 s43, s26, 15
    s_sub_u32 s42, 32768, s43
    s_lshl_b32 s43, s25, 12
    s_add_u32 s42, s42, s43
    v_add_u32 v29, s42, v27
    v_mov_b32 v96, 0
    v_mov_b32 v97, 0
    v_mov_b32 v98, 0
    v_mov_b32 v99, 0
    v_mov_b32 v100, 0
    v_mov_b32 v101, 0
    v_mov_b32 v102, 0
    v_mov_b32 v103, 0
    v_mov_b32 v104, 0
    v_mov_b32 v105, 0
    v_mov_b32 v106, 0
    v_mov_b32 v107, 0
    v_mov_b32 v108, 0
    v_mov_b32 v109, 0
    v_mov_b32 v110, 0
    v_mov_b32 v111, 0
    v_accvgpr_read_b32 v64, a0
    v_accvgpr_read_b32 v65, a1
    v_accvgpr_read_b32 v66, a2
    v_accvgpr_read_b32 v67, a3
    v_accvgpr_read_b32 v68, a4
    v_accvgpr_read_b32 v69, a5
    v_accvgpr_read_b32 v70, a6
    v_accvgpr_read_b32 v71, a7
    v_pk_mul_f32 v[64:65], v[64:65], s[40:41]
    v_pk_mul_f32 v[66:67], v[66:67], s[40:41]
    v_pk_mul_f32 v[68:69], v[68:69], s[40:41]
    v_pk_mul_f32 v[70:71], v[70:71], s[40:41]
    v_cvt_pk_bf16_f32 v32, v64, v65
    v_cvt_pk_bf16_f32 v33, v66, v67
    v_cvt_pk_bf16_f32 v34, v68, v69
    v_cvt_pk_bf16_f32 v35, v70, v71
    ds_write_b128 v29, v[32:35] offset:0
    v_mfma_f32_32x32x16_bf16 v[128:143], v[96:99], v[96:99], 0
    v_accvgpr_read_b32 v72, a8
    v_accvgpr_read_b32 v73, a9
    v_accvgpr_read_b32 v74, a10
    v_accvgpr_read_b32 v75, a11
    v_accvgpr_read_b32 v76, a12
    v_accvgpr_read_b32 v77, a13
    v_accvgpr_read_b32 v78, a14
    v_accvgpr_read_b32 v79, a15
    v_pk_mul_f32 v[72:73], v[72:73], s[40:41]
    v_pk_mul_f32 v[74:75], v[74:75], s[40:41]
    v_pk_mul_f32 v[76:77], v[76:77], s[40:41]
    v_pk_mul_f32 v[78:79], v[78:79], s[40:41]
    v_cvt_pk_bf16_f32 v36, v72, v73
    v_cvt_pk_bf16_f32 v37, v74, v75
    v_cvt_pk_bf16_f32 v38, v76, v77
    v_cvt_pk_bf16_f32 v39, v78, v79
    ds_write_b128 v29, v[36:39] offset:1024
    v_mfma_f32_32x32x16_bf16 v[144:159], v[96:99], v[96:99], 0
    v_accvgpr_read_b32 v80, a16
    v_accvgpr_read_b32 v81, a17
    v_accvgpr_read_b32 v82, a18
    v_accvgpr_read_b32 v83, a19
    v_accvgpr_read_b32 v84, a20
    v_accvgpr_read_b32 v85, a21
    v_accvgpr_read_b32 v86, a22
    v_accvgpr_read_b32 v87, a23
    v_pk_mul_f32 v[80:81], v[80:81], s[40:41]
    v_pk_mul_f32 v[82:83], v[82:83], s[40:41]
    v_pk_mul_f32 v[84:85], v[84:85], s[40:41]
    v_pk_mul_f32 v[86:87], v[86:87], s[40:41]
    v_cvt_pk_bf16_f32 v40, v80, v81
    v_cvt_pk_bf16_f32 v41, v82, v83
    v_cvt_pk_bf16_f32 v42, v84, v85
    v_cvt_pk_bf16_f32 v43, v86, v87
    ds_write_b128 v29, v[40:43] offset:2048
    v_mfma_f32_32x32x16_bf16 v[160:175], v[96:99], v[96:99], 0
    v_accvgpr_read_b32 v88, a24
    v_accvgpr_read_b32 v89, a25
    v_accvgpr_read_b32 v90, a26
    v_accvgpr_read_b32 v91, a27
    v_accvgpr_read_b32 v92, a28
    v_accvgpr_read_b32 v93, a29
    v_accvgpr_read_b32 v94, a30
    v_accvgpr_read_b32 v95, a31
    v_pk_mul_f32 v[88:89], v[88:89], s[40:41]
    v_pk_mul_f32 v[90:91], v[90:91], s[40:41]
    v_pk_mul_f32 v[92:93], v[92:93], s[40:41]
    v_pk_mul_f32 v[94:95], v[94:95], s[40:41]
    v_cvt_pk_bf16_f32 v44, v88, v89
    v_cvt_pk_bf16_f32 v45, v90, v91
    v_cvt_pk_bf16_f32 v46, v92, v93
    v_cvt_pk_bf16_f32 v47, v94, v95
    ds_write_b128 v29, v[44:47] offset:3072
    v_mfma_f32_32x32x16_bf16 v[176:191], v[96:99], v[96:99], 0
    v_accvgpr_read_b32 v64, a32
    v_accvgpr_read_b32 v65, a33
    v_accvgpr_read_b32 v66, a34
    v_accvgpr_read_b32 v67, a35
    v_accvgpr_read_b32 v68, a36
    v_accvgpr_read_b32 v69, a37
    v_accvgpr_read_b32 v70, a38
    v_accvgpr_read_b32 v71, a39
    v_pk_mul_f32 v[64:65], v[64:65], s[40:41]
    v_pk_mul_f32 v[66:67], v[66:67], s[40:41]
    v_pk_mul_f32 v[68:69], v[68:69], s[40:41]
    v_pk_mul_f32 v[70:71], v[70:71], s[40:41]
    v_cvt_pk_bf16_f32 v32, v64, v65
    v_cvt_pk_bf16_f32 v33, v66, v67
    v_cvt_pk_bf16_f32 v34, v68, v69
    v_cvt_pk_bf16_f32 v35, v70, v71
    ds_write_b128 v29, v[32:35] offset:8192
    v_mfma_f32_32x32x16_bf16 v[192:207], v[96:99], v[96:99], 0
    v_accvgpr_read_b32 v72, a40
    v_accvgpr_read_b32 v73, a41
    v_accvgpr_read_b32 v74, a42
    v_accvgpr_read_b32 v75, a43
    v_accvgpr_read_b32 v76, a44
    v_accvgpr_read_b32 v77, a45
    v_accvgpr_read_b32 v78, a46
    v_accvgpr_read_b32 v79, a47
    v_pk_mul_f32 v[72:73], v[72:73], s[40:41]
    v_pk_mul_f32 v[74:75], v[74:75], s[40:41]
    v_pk_mul_f32 v[76:77], v[76:77], s[40:41]
    v_pk_mul_f32 v[78:79], v[78:79], s[40:41]
    v_cvt_pk_bf16_f32 v36, v72, v73
    v_cvt_pk_bf16_f32 v37, v74, v75
    v_cvt_pk_bf16_f32 v38, v76, v77
    v_cvt_pk_bf16_f32 v39, v78, v79
    ds_write_b128 v29, v[36:39] offset:9216
    v_mfma_f32_32x32x16_bf16 v[208:223], v[96:99], v[96:99], 0
    v_accvgpr_read_b32 v80, a48
    v_accvgpr_read_b32 v81, a49
    v_accvgpr_read_b32 v82, a50
    v_accvgpr_read_b32 v83, a51
    v_accvgpr_read_b32 v84, a52
    v_accvgpr_read_b32 v85, a53
    v_accvgpr_read_b32 v86, a54
    v_accvgpr_read_b32 v87, a55
    v_pk_mul_f32 v[80:81], v[80:81], s[40:41]
    v_pk_mul_f32 v[82:83], v[82:83], s[40:41]
    v_pk_mul_f32 v[84:85], v[84:85], s[40:41]
    v_pk_mul_f32 v[86:87], v[86:87], s[40:41]
    v_cvt_pk_bf16_f32 v40, v80, v81
    v_cvt_pk_bf16_f32 v41, v82, v83
    v_cvt_pk_bf16_f32 v42, v84, v85
    v_cvt_pk_bf16_f32 v43, v86, v87
    ds_write_b128 v29, v[40:43] offset:10240
    v_mfma_f32_32x32x16_bf16 v[224:239], v[96:99], v[96:99], 0
    v_accvgpr_read_b32 v88, a56
    v_accvgpr_read_b32 v89, a57
    v_accvgpr_read_b32 v90, a58
    v_accvgpr_read_b32 v91, a59
    v_accvgpr_read_b32 v92, a60
    v_accvgpr_read_b32 v93, a61
    v_accvgpr_read_b32 v94, a62
    v_accvgpr_read_b32 v95, a63
    v_pk_mul_f32 v[88:89], v[88:89], s[40:41]
    v_pk_mul_f32 v[90:91], v[90:91], s[40:41]
    v_pk_mul_f32 v[92:93], v[92:93], s[40:41]
    v_pk_mul_f32 v[94:95], v[94:95], s[40:41]
    v_cvt_pk_bf16_f32 v44, v88, v89
    v_cvt_pk_bf16_f32 v45, v90, v91
    v_cvt_pk_bf16_f32 v46, v92, v93
    v_cvt_pk_bf16_f32 v47, v94, v95
    ds_write_b128 v29, v[44:47] offset:11264
    v_mfma_f32_32x32x16_bf16 v[240:255], v[96:99], v[96:99], 0
    v_accvgpr_read_b32 v64, a160
    v_accvgpr_read_b32 v65, a161
    v_accvgpr_read_b32 v66, a162
    v_accvgpr_read_b32 v67, a163
    v_accvgpr_read_b32 v68, a164
    v_accvgpr_read_b32 v69, a165
    v_accvgpr_read_b32 v70, a166
    v_accvgpr_read_b32 v71, a167
    v_pk_mul_f32 v[64:65], v[64:65], s[40:41]
    v_pk_mul_f32 v[66:67], v[66:67], s[40:41]
    v_pk_mul_f32 v[68:69], v[68:69], s[40:41]
    v_pk_mul_f32 v[70:71], v[70:71], s[40:41]
    v_cvt_pk_bf16_f32 v32, v64, v65
    v_cvt_pk_bf16_f32 v33, v66, v67
    v_cvt_pk_bf16_f32 v34, v68, v69
    v_cvt_pk_bf16_f32 v35, v70, v71
    ds_write_b128 v29, v[32:35] offset:16384
    v_mfma_f32_32x32x16_bf16 a[224:239], v[96:99], v[96:99], 0
    v_accvgpr_read_b32 v72, a168
    v_accvgpr_read_b32 v73, a169
    v_accvgpr_read_b32 v74, a170
    v_accvgpr_read_b32 v75, a171
    v_accvgpr_read_b32 v76, a172
    v_accvgpr_read_b32 v77, a173
    v_accvgpr_read_b32 v78, a174
    v_accvgpr_read_b32 v79, a175
    v_pk_mul_f32 v[72:73], v[72:73], s[40:41]
    v_pk_mul_f32 v[74:75], v[74:75], s[40:41]
    v_pk_mul_f32 v[76:77], v[76:77], s[40:41]
    v_pk_mul_f32 v[78:79], v[78:79], s[40:41]
    v_cvt_pk_bf16_f32 v36, v72, v73
    v_cvt_pk_bf16_f32 v37, v74, v75
    v_cvt_pk_bf16_f32 v38, v76, v77
    v_cvt_pk_bf16_f32 v39, v78, v79
    ds_write_b128 v29, v[36:39] offset:17408
    v_mfma_f32_32x32x16_bf16 a[240:255], v[96:99], v[96:99], 0
    v_accvgpr_read_b32 v80, a176
    v_accvgpr_read_b32 v81, a177
    v_accvgpr_read_b32 v82, a178
    v_accvgpr_read_b32 v83, a179
    v_accvgpr_read_b32 v84, a180
    v_accvgpr_read_b32 v85, a181
    v_accvgpr_read_b32 v86, a182
    v_accvgpr_read_b32 v87, a183
    v_pk_mul_f32 v[80:81], v[80:81], s[40:41]
    v_pk_mul_f32 v[82:83], v[82:83], s[40:41]
    v_pk_mul_f32 v[84:85], v[84:85], s[40:41]
    v_pk_mul_f32 v[86:87], v[86:87], s[40:41]
    v_cvt_pk_bf16_f32 v40, v80, v81
    v_cvt_pk_bf16_f32 v41, v82, v83
    v_cvt_pk_bf16_f32 v42, v84, v85
    v_cvt_pk_bf16_f32 v43, v86, v87
    ds_write_b128 v29, v[40:43] offset:18432
    v_mfma_f32_32x32x16_bf16 a[160:175], v[96:99], v[96:99], 0
    v_accvgpr_read_b32 v88, a184
    v_accvgpr_read_b32 v89, a185
    v_accvgpr_read_b32 v90, a186
    v_accvgpr_read_b32 v91, a187
    v_accvgpr_read_b32 v92, a188
    v_accvgpr_read_b32 v93, a189
    v_accvgpr_read_b32 v94, a190
    v_accvgpr_read_b32 v95, a191
    v_pk_mul_f32 v[88:89], v[88:89], s[40:41]
    v_pk_mul_f32 v[90:91], v[90:91], s[40:41]
    v_pk_mul_f32 v[92:93], v[92:93], s[40:41]
    v_pk_mul_f32 v[94:95], v[94:95], s[40:41]
    v_cvt_pk_bf16_f32 v44, v88, v89
    v_cvt_pk_bf16_f32 v45, v90, v91
    v_cvt_pk_bf16_f32 v46, v92, v93
    v_cvt_pk_bf16_f32 v47, v94, v95
    ds_write_b128 v29, v[44:47] offset:19456
    v_accvgpr_read_b32 v64, a192
    v_accvgpr_read_b32 v65, a193
    v_accvgpr_read_b32 v66, a194
    v_accvgpr_read_b32 v67, a195
    v_accvgpr_read_b32 v68, a196
    v_accvgpr_read_b32 v69, a197
    v_accvgpr_read_b32 v70, a198
    v_accvgpr_read_b32 v71, a199
    v_pk_mul_f32 v[64:65], v[64:65], s[40:41]
    v_pk_mul_f32 v[66:67], v[66:67], s[40:41]
    v_pk_mul_f32 v[68:69], v[68:69], s[40:41]
    v_pk_mul_f32 v[70:71], v[70:71], s[40:41]
    v_cvt_pk_bf16_f32 v32, v64, v65
    v_cvt_pk_bf16_f32 v33, v66, v67
    v_cvt_pk_bf16_f32 v34, v68, v69
    v_cvt_pk_bf16_f32 v35, v70, v71
    ds_write_b128 v29, v[32:35] offset:24576
    v_mfma_f32_32x32x16_bf16 a[176:191], v[96:99], v[96:99], 0
    v_accvgpr_read_b32 v72, a200
    v_accvgpr_read_b32 v73, a201
    v_accvgpr_read_b32 v74, a202
    v_accvgpr_read_b32 v75, a203
    v_accvgpr_read_b32 v76, a204
    v_accvgpr_read_b32 v77, a205
    v_accvgpr_read_b32 v78, a206
    v_accvgpr_read_b32 v79, a207
    v_pk_mul_f32 v[72:73], v[72:73], s[40:41]
    v_pk_mul_f32 v[74:75], v[74:75], s[40:41]
    v_pk_mul_f32 v[76:77], v[76:77], s[40:41]
    v_pk_mul_f32 v[78:79], v[78:79], s[40:41]
    v_cvt_pk_bf16_f32 v36, v72, v73
    v_cvt_pk_bf16_f32 v37, v74, v75
    v_cvt_pk_bf16_f32 v38, v76, v77
    v_cvt_pk_bf16_f32 v39, v78, v79
    ds_write_b128 v29, v[36:39] offset:25600
    v_accvgpr_read_b32 v80, a208
    v_accvgpr_read_b32 v81, a209
    v_accvgpr_read_b32 v82, a210
    v_accvgpr_read_b32 v83, a211
    v_accvgpr_read_b32 v84, a212
    v_accvgpr_read_b32 v85, a213
    v_accvgpr_read_b32 v86, a214
    v_accvgpr_read_b32 v87, a215
    v_pk_mul_f32 v[80:81], v[80:81], s[40:41]
    v_pk_mul_f32 v[82:83], v[82:83], s[40:41]
    v_pk_mul_f32 v[84:85], v[84:85], s[40:41]
    v_pk_mul_f32 v[86:87], v[86:87], s[40:41]
    v_cvt_pk_bf16_f32 v40, v80, v81
    v_cvt_pk_bf16_f32 v41, v82, v83
    v_cvt_pk_bf16_f32 v42, v84, v85
    v_cvt_pk_bf16_f32 v43, v86, v87
    ds_write_b128 v29, v[40:43] offset:26624
    v_mfma_f32_32x32x16_bf16 a[192:207], v[96:99], v[96:99], 0
    v_accvgpr_read_b32 v88, a216
    v_accvgpr_read_b32 v89, a217
    v_accvgpr_read_b32 v90, a218
    v_accvgpr_read_b32 v91, a219
    v_accvgpr_read_b32 v92, a220
    v_accvgpr_read_b32 v93, a221
    v_accvgpr_read_b32 v94, a222
    v_accvgpr_read_b32 v95, a223
    v_pk_mul_f32 v[88:89], v[88:89], s[40:41]
    v_pk_mul_f32 v[90:91], v[90:91], s[40:41]
    v_pk_mul_f32 v[92:93], v[92:93], s[40:41]
    v_pk_mul_f32 v[94:95], v[94:95], s[40:41]
    v_cvt_pk_bf16_f32 v44, v88, v89
    v_cvt_pk_bf16_f32 v45, v90, v91
    v_cvt_pk_bf16_f32 v46, v92, v93
    v_cvt_pk_bf16_f32 v47, v94, v95
    ds_write_b128 v29, v[44:47] offset:27648
    s_lshl_b32 s42, s2, 15
    s_add_u32 s42, s42, s31
    s_add_u32 s51, s42, 67108864
    s_mul_i32 s42, s25, 6144
    s_sub_u32 s49, s51, s42
    v_accvgpr_read_b32 v64, a96
    v_accvgpr_read_b32 v65, a97
    v_accvgpr_read_b32 v66, a98
    v_accvgpr_read_b32 v67, a99
    v_accvgpr_read_b32 v68, a100
    v_accvgpr_read_b32 v69, a101
    v_accvgpr_read_b32 v70, a102
    v_accvgpr_read_b32 v71, a103
    v_max_f32 v64, 0, v64
    v_max_f32 v65, 0, v65
    v_max_f32 v66, 0, v66
    v_max_f32 v67, 0, v67
    v_max_f32 v68, 0, v68
    v_max_f32 v69, 0, v69
    v_max_f32 v70, 0, v70
    v_max_f32 v71, 0, v71
    v_pk_mul_f32 v[64:65], v[64:65], v[64:65]
    v_pk_mul_f32 v[66:67], v[66:67], v[66:67]
    v_pk_mul_f32 v[68:69], v[68:69], v[68:69]
    v_pk_mul_f32 v[70:71], v[70:71], v[70:71]
    v_cvt_pk_bf16_f32 v48, v64, v65
    v_cvt_pk_bf16_f32 v49, v66, v67
    v_cvt_pk_bf16_f32 v50, v68, v69
    v_cvt_pk_bf16_f32 v51, v70, v71
    buffer_store_dwordx4 v[48:51], v27, s[4:7], s49 offen offset:0
    v_accvgpr_read_b32 v72, a104
    v_accvgpr_read_b32 v73, a105
    v_accvgpr_read_b32 v74, a106
    v_accvgpr_read_b32 v75, a107
    v_accvgpr_read_b32 v76, a108
    v_accvgpr_read_b32 v77, a109
    v_accvgpr_read_b32 v78, a110
    v_accvgpr_read_b32 v79, a111
    v_max_f32 v72, 0, v72
    v_max_f32 v73, 0, v73
    v_max_f32 v74, 0, v74
    v_max_f32 v75, 0, v75
    v_max_f32 v76, 0, v76
    v_max_f32 v77, 0, v77
    v_max_f32 v78, 0, v78
    v_max_f32 v79, 0, v79
    v_pk_mul_f32 v[72:73], v[72:73], v[72:73]
    v_pk_mul_f32 v[74:75], v[74:75], v[74:75]
    v_pk_mul_f32 v[76:77], v[76:77], v[76:77]
    v_pk_mul_f32 v[78:79], v[78:79], v[78:79]
    v_cvt_pk_bf16_f32 v52, v72, v73
    v_cvt_pk_bf16_f32 v53, v74, v75
    v_cvt_pk_bf16_f32 v54, v76, v77
    v_cvt_pk_bf16_f32 v55, v78, v79
    buffer_store_dwordx4 v[52:55], v27, s[4:7], s49 offen offset:1024
    s_add_u32 s49, s49, 4096
    v_accvgpr_read_b32 v80, a112
    v_accvgpr_read_b32 v81, a113
    v_accvgpr_read_b32 v82, a114
    v_accvgpr_read_b32 v83, a115
    v_accvgpr_read_b32 v84, a116
    v_accvgpr_read_b32 v85, a117
    v_accvgpr_read_b32 v86, a118
    v_accvgpr_read_b32 v87, a119
    v_max_f32 v80, 0, v80
    v_max_f32 v81, 0, v81
    v_max_f32 v82, 0, v82
    v_max_f32 v83, 0, v83
    v_max_f32 v84, 0, v84
    v_max_f32 v85, 0, v85
    v_max_f32 v86, 0, v86
    v_max_f32 v87, 0, v87
    v_pk_mul_f32 v[80:81], v[80:81], v[80:81]
    v_pk_mul_f32 v[82:83], v[82:83], v[82:83]
    v_pk_mul_f32 v[84:85], v[84:85], v[84:85]
    v_pk_mul_f32 v[86:87], v[86:87], v[86:87]
    v_cvt_pk_bf16_f32 v56, v80, v81
    v_cvt_pk_bf16_f32 v57, v82, v83
    v_cvt_pk_bf16_f32 v58, v84, v85
    v_cvt_pk_bf16_f32 v59, v86, v87
    buffer_store_dwordx4 v[56:59], v27, s[4:7], s49 offen offset:0
    v_accvgpr_read_b32 v88, a120
    v_accvgpr_read_b32 v89, a121
    v_accvgpr_read_b32 v90, a122
    v_accvgpr_read_b32 v91, a123
    v_accvgpr_read_b32 v92, a124
    v_accvgpr_read_b32 v93, a125
    v_accvgpr_read_b32 v94, a126
    v_accvgpr_read_b32 v95, a127
    v_max_f32 v88, 0, v88
    v_max_f32 v89, 0, v89
    v_max_f32 v90, 0, v90
    v_max_f32 v91, 0, v91
    v_max_f32 v92, 0, v92
    v_max_f32 v93, 0, v93
    v_max_f32 v94, 0, v94
    v_max_f32 v95, 0, v95
    v_pk_mul_f32 v[88:89], v[88:89], v[88:89]
    v_pk_mul_f32 v[90:91], v[90:91], v[90:91]
    v_pk_mul_f32 v[92:93], v[92:93], v[92:93]
    v_pk_mul_f32 v[94:95], v[94:95], v[94:95]
    v_cvt_pk_bf16_f32 v60, v88, v89
    v_cvt_pk_bf16_f32 v61, v90, v91
    v_cvt_pk_bf16_f32 v62, v92, v93
    v_cvt_pk_bf16_f32 v63, v94, v95
    buffer_store_dwordx4 v[60:63], v27, s[4:7], s49 offen offset:1024
    s_add_u32 s49, s49, 4096
    s_waitcnt lgkmcnt(0)
    s_barrier
    ds_read_b128 a[0:3], v28 offset:0
    ds_read_b128 a[4:7], v28 offset:1024
    ds_read_b128 a[8:11], v28 offset:2048
    ds_read_b128 a[12:15], v28 offset:3072
    ds_read_b128 a[16:19], v28 offset:4096
    ds_read_b128 a[20:23], v28 offset:5120
    ds_read_b128 a[24:27], v28 offset:6144
    ds_read_b128 a[28:31], v28 offset:7168
    ds_read_b128 a[32:35], v28 offset:8192
    ds_read_b128 a[36:39], v28 offset:9216
    ds_read_b128 a[40:43], v28 offset:10240
    ds_read_b128 a[44:47], v28 offset:11264
    ds_read_b128 a[48:51], v28 offset:12288
    ds_read_b128 a[52:55], v28 offset:13312
    ds_read_b128 a[56:59], v28 offset:14336
    ds_read_b128 a[60:63], v28 offset:15360
    ds_read_b128 a[64:67], v28 offset:32768
    ds_read_b128 a[68:71], v28 offset:33792
    ds_read_b128 a[72:75], v28 offset:34816
    ds_read_b128 a[76:79], v28 offset:35840
    ds_read_b128 a[80:83], v28 offset:36864
    ds_read_b128 a[84:87], v28 offset:37888
    ds_read_b128 a[88:91], v28 offset:38912
    ds_read_b128 a[92:95], v28 offset:39936
    ds_read_b128 a[96:99], v28 offset:40960
    ds_read_b128 a[100:103], v28 offset:41984
    ds_read_b128 a[104:107], v28 offset:43008
    ds_read_b128 a[108:111], v28 offset:44032
    ds_read_b128 a[112:115], v28 offset:45056
    ds_read_b128 a[116:119], v28 offset:46080
    ds_read_b128 a[120:123], v28 offset:47104
    ds_read_b128 a[124:127], v28 offset:48128
    v_mfma_f32_32x32x16_bf16 a[208:223], v[96:99], v[96:99], 0
    v_accvgpr_read_b32 v64, a128
    v_accvgpr_read_b32 v65, a129
    v_accvgpr_read_b32 v66, a130
    v_accvgpr_read_b32 v67, a131
    v_accvgpr_read_b32 v68, a132
    v_accvgpr_read_b32 v69, a133
    v_accvgpr_read_b32 v70, a134
    v_accvgpr_read_b32 v71, a135
    v_max_f32 v64, 0, v64
    v_max_f32 v65, 0, v65
    v_max_f32 v66, 0, v66
    v_max_f32 v67, 0, v67
    v_max_f32 v68, 0, v68
    v_max_f32 v69, 0, v69
    v_max_f32 v70, 0, v70
    v_max_f32 v71, 0, v71
    v_pk_mul_f32 v[64:65], v[64:65], v[64:65]
    v_pk_mul_f32 v[66:67], v[66:67], v[66:67]
    v_pk_mul_f32 v[68:69], v[68:69], v[68:69]
    v_pk_mul_f32 v[70:71], v[70:71], v[70:71]
    v_cvt_pk_bf16_f32 v48, v64, v65
    v_cvt_pk_bf16_f32 v49, v66, v67
    v_cvt_pk_bf16_f32 v50, v68, v69
    v_cvt_pk_bf16_f32 v51, v70, v71
    buffer_store_dwordx4 v[48:51], v27, s[4:7], s49 offen offset:0
    v_accvgpr_read_b32 v72, a136
    v_accvgpr_read_b32 v73, a137
    v_accvgpr_read_b32 v74, a138
    v_accvgpr_read_b32 v75, a139
    v_accvgpr_read_b32 v76, a140
    v_accvgpr_read_b32 v77, a141
    v_accvgpr_read_b32 v78, a142
    v_accvgpr_read_b32 v79, a143
    v_max_f32 v72, 0, v72
    v_max_f32 v73, 0, v73
    v_max_f32 v74, 0, v74
    v_max_f32 v75, 0, v75
    v_max_f32 v76, 0, v76
    v_max_f32 v77, 0, v77
    v_max_f32 v78, 0, v78
    v_max_f32 v79, 0, v79
    v_pk_mul_f32 v[72:73], v[72:73], v[72:73]
    v_pk_mul_f32 v[74:75], v[74:75], v[74:75]
    v_pk_mul_f32 v[76:77], v[76:77], v[76:77]
    v_pk_mul_f32 v[78:79], v[78:79], v[78:79]
    v_cvt_pk_bf16_f32 v52, v72, v73
    v_cvt_pk_bf16_f32 v53, v74, v75
    v_cvt_pk_bf16_f32 v54, v76, v77
    v_cvt_pk_bf16_f32 v55, v78, v79
    buffer_store_dwordx4 v[52:55], v27, s[4:7], s49 offen offset:1024
    s_add_u32 s49, s49, 4096
    v_mfma_f32_32x32x16_bf16 a[128:143], v[96:99], v[96:99], 0
    v_accvgpr_read_b32 v80, a144
    v_accvgpr_read_b32 v81, a145
    v_accvgpr_read_b32 v82, a146
    v_accvgpr_read_b32 v83, a147
    v_accvgpr_read_b32 v84, a148
    v_accvgpr_read_b32 v85, a149
    v_accvgpr_read_b32 v86, a150
    v_accvgpr_read_b32 v87, a151
    v_max_f32 v80, 0, v80
    v_max_f32 v81, 0, v81
    v_max_f32 v82, 0, v82
    v_max_f32 v83, 0, v83
    v_max_f32 v84, 0, v84
    v_max_f32 v85, 0, v85
    v_max_f32 v86, 0, v86
    v_max_f32 v87, 0, v87
    v_pk_mul_f32 v[80:81], v[80:81], v[80:81]
    v_pk_mul_f32 v[82:83], v[82:83], v[82:83]
    v_pk_mul_f32 v[84:85], v[84:85], v[84:85]
    v_pk_mul_f32 v[86:87], v[86:87], v[86:87]
    v_cvt_pk_bf16_f32 v56, v80, v81
    v_cvt_pk_bf16_f32 v57, v82, v83
    v_cvt_pk_bf16_f32 v58, v84, v85
    v_cvt_pk_bf16_f32 v59, v86, v87
    buffer_store_dwordx4 v[56:59], v27, s[4:7], s49 offen offset:0
    v_accvgpr_read_b32 v88, a152
    v_accvgpr_read_b32 v89, a153
    v_accvgpr_read_b32 v90, a154
    v_accvgpr_read_b32 v91, a155
    v_accvgpr_read_b32 v92, a156
    v_accvgpr_read_b32 v93, a157
    v_accvgpr_read_b32 v94, a158
    v_accvgpr_read_b32 v95, a159
    v_max_f32 v88, 0, v88
    v_max_f32 v89, 0, v89
    v_max_f32 v90, 0, v90
    v_max_f32 v91, 0, v91
    v_max_f32 v92, 0, v92
    v_max_f32 v93, 0, v93
    v_max_f32 v94, 0, v94
    v_max_f32 v95, 0, v95
    v_pk_mul_f32 v[88:89], v[88:89], v[88:89]
    v_pk_mul_f32 v[90:91], v[90:91], v[90:91]
    v_pk_mul_f32 v[92:93], v[92:93], v[92:93]
    v_pk_mul_f32 v[94:95], v[94:95], v[94:95]
    v_cvt_pk_bf16_f32 v60, v88, v89
    v_cvt_pk_bf16_f32 v61, v90, v91
    v_cvt_pk_bf16_f32 v62, v92, v93
    v_cvt_pk_bf16_f32 v63, v94, v95
    buffer_store_dwordx4 v[60:63], v27, s[4:7], s49 offen offset:1024
    s_add_u32 s49, s49, 4096
    v_mfma_f32_32x32x16_bf16 a[144:159], v[96:99], v[96:99], 0
    v_mov_b32 v20, 0
    v_mov_b32 v21, 0
    v_mov_b32 v2, 0
    v_mov_b32 v3, 0
    v_mov_b32 v4, 0
    v_mov_b32 v5, 0
    v_mov_b32 v6, 0
    v_mov_b32 v7, 0
    v_mov_b32 v8, 0
    v_mov_b32 v9, 0
    v_mov_b32 v10, 0
    v_mov_b32 v11, 0
    v_mov_b32 v12, 0
    v_mov_b32 v13, 0
    v_mov_b32 v14, 0
    v_mov_b32 v15, 0
    v_mov_b32 v16, 0
    v_mov_b32 v17, 0
    v_mov_b32 v120, 0x3f803f80
    v_mov_b32 v121, 0x3f803f80
    v_mov_b32 v122, 0x3f803f80
    v_mov_b32 v123, 0x3f803f80
    s_lshl_b32 s40, s26, 14
    v_add_u32 v23, s40, v27
    v_lshrrev_b32 v30, 4, v1
    v_lshlrev_b32 v30, 2, v30
    v_and_b32 v22, 15, v1
    v_sub_u32 v22, v22, v30
    s_add_u32 s48, s29, 1
    s_waitcnt lgkmcnt(0)
    s_mov_b32 s34, 0
    s_mov_b32 s35, 32768
    s_add_u32 m0, s31, s34
    s_add_u32 s34, s35, 32768
    s_cmp_eq_u32 s34, s37
    s_cselect_b32 s34, 0, s34
    s_waitcnt vmcnt(16)
    s_barrier
    v_add_u32 v25, s34, v23
    ds_read_b128 v[32:35], v25 offset:0
    ds_read_b128 v[36:39], v25 offset:1024
    ds_read_b128 v[40:43], v25 offset:2048
    ds_read_b128 v[44:47], v25 offset:3072
    ds_read_b128 v[48:51], v25 offset:4096
    ds_read_b128 v[52:55], v25 offset:5120
    ds_read_b128 v[56:59], v25 offset:6144
    ds_read_b128 v[60:63], v25 offset:7168
    buffer_load_dwordx4 v27, s[4:7], s38 offen offset:0 sc1 lds
    buffer_load_dwordx4 v27, s[4:7], s38 offen offset:1024 sc1 lds
    buffer_load_dwordx4 v27, s[4:7], s38 offen offset:2048 sc1 lds
    buffer_load_dwordx4 v27, s[4:7], s38 offen offset:3072 sc1 lds
    s_sub_i32 s48, s48, 1
    s_cmp_le_i32 s48, 0
    s_cbranch_scc0 L_pm0
    s_lshl_b32 s40, s48, 5
    v_add_u32 v31, s40, v22
    v_mov_b32 v24, 0xf149f2ca
    s_nop 3
    v_cmp_gt_i32 s[60:61], 0, v31
    v_cmp_gt_i32 s[62:63], 1, v31
    v_cmp_gt_i32 s[96:97], 2, v31
    v_cmp_gt_i32 s[98:99], 3, v31
    v_cndmask_b32 v96, v96, v24, s[60:61]
    v_cndmask_b32 v97, v97, v24, s[62:63]
    v_cndmask_b32 v98, v98, v24, s[96:97]
    v_cndmask_b32 v99, v99, v24, s[98:99]
    v_cmp_gt_i32 s[60:61], 16, v31
    v_cmp_gt_i32 s[62:63], 17, v31
    v_cmp_gt_i32 s[96:97], 18, v31
    v_cmp_gt_i32 s[98:99], 19, v31
    v_cndmask_b32 v100, v100, v24, s[60:61]
    v_cndmask_b32 v101, v101, v24, s[62:63]
    v_cndmask_b32 v102, v102, v24, s[96:97]
    v_cndmask_b32 v103, v103, v24, s[98:99]
    v_cmp_gt_i32 s[60:61], -16, v31
    v_cmp_gt_i32 s[62:63], -15, v31
    v_cmp_gt_i32 s[96:97], -14, v31
    v_cmp_gt_i32 s[98:99], -13, v31
    v_cndmask_b32 v104, v104, v24, s[60:61]
    v_cndmask_b32 v105, v105, v24, s[62:63]
    v_cndmask_b32 v106, v106, v24, s[96:97]
    v_cndmask_b32 v107, v107, v24, s[98:99]
    v_cmp_gt_i32 s[60:61], 0, v31
    v_cmp_gt_i32 s[62:63], 1, v31
    v_cmp_gt_i32 s[96:97], 2, v31
    v_cmp_gt_i32 s[98:99], 3, v31
    v_cndmask_b32 v108, v108, v24, s[60:61]
    v_cndmask_b32 v109, v109, v24, s[62:63]
    v_cndmask_b32 v110, v110, v24, s[96:97]
    v_cndmask_b32 v111, v111, v24, s[98:99]
    s_nop 1
L_pm0:
    s_cmp_eq_u32 s26, 0
    s_cbranch_scc0 L_Ystart
    s_waitcnt lgkmcnt(4)
    v_mfma_f32_16x16x32_bf16 v[64:67], v[32:35], a[64:67], v[96:99]
    s_add_u32 m0, m0, 4096
    v_mfma_f32_16x16x32_bf16 v[64:67], v[36:39], a[68:71], v[64:67]
    v_mfma_f32_16x16x32_bf16 v[72:75], v[36:39], a[100:103], v[104:107]
    buffer_load_dwordx4 v26, s[4:7], s38 offen offset:0 sc1 lds
    v_mfma_f32_16x16x32_bf16 v[72:75], v[32:35], a[96:99], v[72:75]
    ds_read_b128 v[32:35], v25 offset:8192
    v_mfma_f32_16x16x32_bf16 v[72:75], v[40:43], a[104:107], v[72:75]
    s_add_u32 s42, s34, 32768
    ds_read_b128 v[36:39], v25 offset:9216
    v_mfma_f32_16x16x32_bf16 v[72:75], v[44:47], a[108:111], v[72:75]
    v_mfma_f32_16x16x32_bf16 v[64:67], v[44:47], a[76:79], v[64:67]
    buffer_load_dwordx4 v26, s[4:7], s38 offen offset:1024 sc1 lds
    v_mfma_f32_16x16x32_bf16 v[64:67], v[40:43], a[72:75], v[64:67]
    ds_read_b128 v[40:43], v25 offset:10240
    s_waitcnt lgkmcnt(3)
    v_mfma_f32_16x16x32_bf16 v[64:67], v[48:51], a[80:83], v[64:67]
    s_cmp_eq_u32 s42, s37
    ds_read_b128 v[44:47], v25 offset:11264
    v_mfma_f32_16x16x32_bf16 v[64:67], v[52:55], a[84:87], v[64:67]
    v_mfma_f32_16x16x32_bf16 v[72:75], v[52:55], a[116:119], v[72:75]
    buffer_load_dwordx4 v26, s[4:7], s38 offen offset:2048 sc1 lds
    v_mfma_f32_16x16x32_bf16 v[72:75], v[48:51], a[112:115], v[72:75]
    s_cselect_b32 s42, 0, s42
    ds_read_b128 v[48:51], v25 offset:12288
    v_mfma_f32_16x16x32_bf16 v[72:75], v[56:59], a[120:123], v[72:75]
    ds_read_b128 v[52:55], v25 offset:13312
    v_mfma_f32_16x16x32_bf16 v[72:75], v[60:63], a[124:127], v[72:75]
    v_mfma_f32_16x16x32_bf16 v[64:67], v[60:63], a[92:95], v[64:67]
    buffer_load_dwordx4 v26, s[4:7], s38 offen offset:3072 sc1 lds
    v_mfma_f32_16x16x32_bf16 v[64:67], v[56:59], a[88:91], v[64:67]
    ds_read_b128 v[56:59], v25 offset:14336
    s_waitcnt lgkmcnt(3)
    v_mfma_f32_16x16x32_bf16 v[68:71], v[32:35], a[64:67], v[100:103]
    s_add_u32 m0, s31, s35
    ds_read_b128 v[60:63], v25 offset:15360
    v_mfma_f32_16x16x32_bf16 v[68:71], v[36:39], a[68:71], v[68:71]
    s_waitcnt vmcnt(16)
    s_barrier
    v_mfma_f32_16x16x32_bf16 v[76:79], v[36:39], a[100:103], v[108:111]
    buffer_load_dwordx4 v27, s[4:7], s39 offen offset:0 sc1 lds
    v_mfma_f32_16x16x32_bf16 v[76:79], v[32:35], a[96:99], v[76:79]
    v_add_u32 v25, s42, v23
    ds_read_b128 v[32:35], v25 offset:0
    v_mfma_f32_16x16x32_bf16 v[76:79], v[40:43], a[104:107], v[76:79]
    s_mov_b32 s35, s42
    ds_read_b128 v[36:39], v25 offset:1024
    v_mfma_f32_16x16x32_bf16 v[76:79], v[44:47], a[108:111], v[76:79]
    v_mfma_f32_16x16x32_bf16 v[68:71], v[44:47], a[76:79], v[68:71]
    buffer_load_dwordx4 v27, s[4:7], s39 offen offset:1024 sc1 lds
    v_mfma_f32_16x16x32_bf16 v[68:71], v[40:43], a[72:75], v[68:71]
    ds_read_b128 v[40:43], v25 offset:2048
    s_waitcnt lgkmcnt(3)
    v_mfma_f32_16x16x32_bf16 v[68:71], v[48:51], a[80:83], v[68:71]
    ds_read_b128 v[44:47], v25 offset:3072
    s_add_u32 s38, s38, 32768
    s_cmp_eq_u32 s38, s44
    s_cselect_b32 s38, s46, s38
    v_mfma_f32_16x16x32_bf16 v[68:71], v[52:55], a[84:87], v[68:71]
    v_mfma_f32_16x16x32_bf16 v[76:79], v[52:55], a[116:119], v[76:79]
    buffer_load_dwordx4 v27, s[4:7], s39 offen offset:2048 sc1 lds
    v_mfma_f32_16x16x32_bf16 v[76:79], v[48:51], a[112:115], v[76:79]
    ds_read_b128 v[48:51], v25 offset:4096
    v_mfma_f32_16x16x32_bf16 v[76:79], v[56:59], a[120:123], v[76:79]
    ds_read_b128 v[52:55], v25 offset:5120
    v_mfma_f32_16x16x32_bf16 v[76:79], v[60:63], a[124:127], v[76:79]
    v_mfma_f32_16x16x32_bf16 v[68:71], v[60:63], a[92:95], v[68:71]
    buffer_load_dwordx4 v27, s[4:7], s39 offen offset:3072 sc1 lds
    v_mfma_f32_16x16x32_bf16 v[68:71], v[56:59], a[88:91], v[68:71]
    ds_read_b128 v[56:59], v25 offset:6144
    ds_read_b128 v[60:63], v25 offset:7168
    s_mov_b32 s43, 32
    s_nop 7
    s_branch L_eFB
L_Ystart:
    s_waitcnt lgkmcnt(4)
    v_mfma_f32_16x16x32_bf16 v[64:67], v[32:35], a[0:3], v[96:99]
    s_add_u32 m0, m0, 4096
    v_mfma_f32_16x16x32_bf16 v[64:67], v[36:39], a[4:7], v[64:67]
    v_mfma_f32_16x16x32_bf16 v[72:75], v[36:39], a[36:39], v[104:107]
    buffer_load_dwordx4 v26, s[4:7], s38 offen offset:0 sc1 lds
    v_mfma_f32_16x16x32_bf16 v[72:75], v[32:35], a[32:35], v[72:75]
    ds_read_b128 v[32:35], v25 offset:8192
    v_mfma_f32_16x16x32_bf16 v[72:75], v[40:43], a[40:43], v[72:75]
    s_add_u32 s42, s34, 32768
    ds_read_b128 v[36:39], v25 offset:9216
    v_mfma_f32_16x16x32_bf16 v[72:75], v[44:47], a[44:47], v[72:75]
    v_mfma_f32_16x16x32_bf16 v[64:67], v[44:47], a[12:15], v[64:67]
    buffer_load_dwordx4 v26, s[4:7], s38 offen offset:1024 sc1 lds
    v_mfma_f32_16x16x32_bf16 v[64:67], v[40:43], a[8:11], v[64:67]
    ds_read_b128 v[40:43], v25 offset:10240
    s_waitcnt lgkmcnt(3)
    v_mfma_f32_16x16x32_bf16 v[64:67], v[48:51], a[16:19], v[64:67]
    s_cmp_eq_u32 s42, s37
    ds_read_b128 v[44:47], v25 offset:11264
    v_mfma_f32_16x16x32_bf16 v[64:67], v[52:55], a[20:23], v[64:67]
    v_mfma_f32_16x16x32_bf16 v[72:75], v[52:55], a[52:55], v[72:75]
    buffer_load_dwordx4 v26, s[4:7], s38 offen offset:2048 sc1 lds
    v_mfma_f32_16x16x32_bf16 v[72:75], v[48:51], a[48:51], v[72:75]
    s_cselect_b32 s42, 0, s42
    ds_read_b128 v[48:51], v25 offset:12288
    v_mfma_f32_16x16x32_bf16 v[72:75], v[56:59], a[56:59], v[72:75]
    ds_read_b128 v[52:55], v25 offset:13312
    v_mfma_f32_16x16x32_bf16 v[72:75], v[60:63], a[60:63], v[72:75]
    v_mfma_f32_16x16x32_bf16 v[64:67], v[60:63], a[28:31], v[64:67]
    buffer_load_dwordx4 v26, s[4:7], s38 offen offset:3072 sc1 lds
    v_mfma_f32_16x16x32_bf16 v[64:67], v[56:59], a[24:27], v[64:67]
    ds_read_b128 v[56:59], v25 offset:14336
    s_waitcnt lgkmcnt(3)
    v_mfma_f32_16x16x32_bf16 v[68:71], v[32:35], a[0:3], v[100:103]
    s_add_u32 m0, s31, s35
    ds_read_b128 v[60:63], v25 offset:15360
    v_mfma_f32_16x16x32_bf16 v[68:71], v[36:39], a[4:7], v[68:71]
    s_waitcnt vmcnt(16)
    s_barrier
    v_mfma_f32_16x16x32_bf16 v[76:79], v[36:39], a[36:39], v[108:111]
    buffer_load_dwordx4 v27, s[4:7], s39 offen offset:0 sc1 lds
    v_mfma_f32_16x16x32_bf16 v[76:79], v[32:35], a[32:35], v[76:79]
    v_add_u32 v25, s42, v23
    ds_read_b128 v[32:35], v25 offset:0
    v_mfma_f32_16x16x32_bf16 v[76:79], v[40:43], a[40:43], v[76:79]
    s_mov_b32 s35, s42
    ds_read_b128 v[36:39], v25 offset:1024
    v_mfma_f32_16x16x32_bf16 v[76:79], v[44:47], a[44:47], v[76:79]
    v_mfma_f32_16x16x32_bf16 v[68:71], v[44:47], a[12:15], v[68:71]
    buffer_load_dwordx4 v27, s[4:7], s39 offen offset:1024 sc1 lds
    v_mfma_f32_16x16x32_bf16 v[68:71], v[40:43], a[8:11], v[68:71]
    ds_read_b128 v[40:43], v25 offset:2048
    s_waitcnt lgkmcnt(3)
    v_mfma_f32_16x16x32_bf16 v[68:71], v[48:51], a[16:19], v[68:71]
    ds_read_b128 v[44:47], v25 offset:3072
    s_add_u32 s38, s38, 32768
    s_cmp_eq_u32 s38, s44
    s_cselect_b32 s38, s46, s38
    v_mfma_f32_16x16x32_bf16 v[68:71], v[52:55], a[20:23], v[68:71]
    v_mfma_f32_16x16x32_bf16 v[76:79], v[52:55], a[52:55], v[76:79]
    buffer_load_dwordx4 v27, s[4:7], s39 offen offset:2048 sc1 lds
    v_mfma_f32_16x16x32_bf16 v[76:79], v[48:51], a[48:51], v[76:79]
    ds_read_b128 v[48:51], v25 offset:4096
    v_mfma_f32_16x16x32_bf16 v[76:79], v[56:59], a[56:59], v[76:79]
    ds_read_b128 v[52:55], v25 offset:5120
    v_mfma_f32_16x16x32_bf16 v[76:79], v[60:63], a[60:63], v[76:79]
    v_mfma_f32_16x16x32_bf16 v[68:71], v[60:63], a[28:31], v[68:71]
    buffer_load_dwordx4 v27, s[4:7], s39 offen offset:3072 sc1 lds
    v_mfma_f32_16x16x32_bf16 v[68:71], v[56:59], a[24:27], v[68:71]
    ds_read_b128 v[56:59], v25 offset:6144
    ds_read_b128 v[60:63], v25 offset:7168
    s_nop 7
    s_branch L_eFA
L_segA:
    s_cmp_eq_u32 s28, 0
    s_cbranch_scc1 L_coldA2
    s_mov_b32 s8, s88
    s_and_b32 s9, s89, 0xffff
    s_mov_b32 s10, 3670016
    s_mov_b32 s11, 0x00020000
    s_mov_b32 s12, s90
    s_and_b32 s13, s91, 0xffff
    s_mov_b32 s14, 1605632
    s_mov_b32 s15, 0x00020000
    s_lshl_b32 s40, s27, 4
    s_add_u32 s40, s40, s28
    s_lshl_b32 s40, s40, 1
    s_add_u32 s40, s40, s25
    s_mul_i32 s49, s40, 7168
    s_lshr_b32 s50, s49, 1
    v_lshlrev_b32 v126, 7, v1
    v_min_u32 v125, 7040, v126
    v_min_u32 v126, 3456, v126
    buffer_load_dword v127, v125, s[8:11], s49 offen
    buffer_load_dword v127, v126, s[12:15], s50 offen
    s_lshl_b32 s43, s28, 1
    s_cmp_eq_u32 s28, 0
    s_cbranch_scc1 L_coldA2
    s_sub_u32 s43, s43, 1
    s_sub_i32 s48, s48, s43
    s_sub_u32 s43, s43, 1
    s_waitcnt lgkmcnt(4)
    v_mfma_f32_16x16x32_bf16 v[64:67], v[32:35], a[0:3], v[96:99]
.p2align 3
L_hotA:
    s_add_u32 m0, m0, 4096
    v_mfma_f32_16x16x32_bf16 v[64:67], v[36:39], a[4:7], v[64:67]
    v_cvt_pk_bf16_f32 v112, v80, v81
    v_cvt_pk_bf16_f32 v113, v82, v83
    v_mfma_f32_16x16x32_bf16 v[72:75], v[36:39], a[36:39], v[104:107]
    v_mfma_f32_16x16x32_bf16 v[72:75], v[32:35], a[32:35], v[72:75]
    ds_read_b128 v[32:35], v25 offset:8192
    v_mfma_f32_16x16x32_bf16 v[72:75], v[40:43], a[40:43], v[72:75]
    s_add_u32 s42, s35, 32768
    ds_read_b128 v[36:39], v25 offset:9216
    v_mfma_f32_16x16x32_bf16 v[72:75], v[44:47], a[44:47], v[72:75]
    v_cvt_pk_bf16_f32 v116, v88, v89
    v_cvt_pk_bf16_f32 v117, v90, v91
    v_mfma_f32_16x16x32_bf16 v[64:67], v[44:47], a[12:15], v[64:67]
    v_mfma_f32_16x16x32_bf16 v[64:67], v[40:43], a[8:11], v[64:67]
    ds_read_b128 v[40:43], v25 offset:10240
    s_waitcnt lgkmcnt(3)
    v_mfma_f32_16x16x32_bf16 v[64:67], v[48:51], a[16:19], v[64:67]
    s_cmp_eq_u32 s42, s37
    ds_read_b128 v[44:47], v25 offset:11264
    v_mfma_f32_16x16x32_bf16 v[64:67], v[52:55], a[20:23], v[64:67]
    v_cvt_pk_bf16_f32 v114, v84, v85
    v_cvt_pk_bf16_f32 v115, v86, v87
    v_mfma_f32_16x16x32_bf16 v[72:75], v[52:55], a[52:55], v[72:75]
    v_mfma_f32_16x16x32_bf16 v[72:75], v[48:51], a[48:51], v[72:75]
    s_cselect_b32 s42, 0, s42
    ds_read_b128 v[48:51], v25 offset:12288
    v_mfma_f32_16x16x32_bf16 v[72:75], v[56:59], a[56:59], v[72:75]
    ds_read_b128 v[52:55], v25 offset:13312
    v_mfma_f32_16x16x32_bf16 v[72:75], v[60:63], a[60:63], v[72:75]
    v_cvt_pk_bf16_f32 v118, v92, v93
    v_cvt_pk_bf16_f32 v119, v94, v95
    v_mfma_f32_16x16x32_bf16 v[64:67], v[60:63], a[28:31], v[64:67]
    v_mfma_f32_16x16x32_bf16 v[64:67], v[56:59], a[24:27], v[64:67]
    ds_read_b128 v[56:59], v25 offset:14336
    s_waitcnt lgkmcnt(3)
    v_mfma_f32_16x16x32_bf16 v[68:71], v[32:35], a[0:3], v[100:103]
    s_add_u32 m0, s31, s34
    ds_read_b128 v[60:63], v25 offset:15360
    v_mfma_f32_16x16x32_bf16 v[68:71], v[36:39], a[4:7], v[68:71]
    s_waitcnt vmcnt(16)
    s_barrier
    v_mfma_f32_16x16x32_bf16 v[76:79], v[36:39], a[36:39], v[108:111]
    v_mfma_f32_16x16x32_bf16 v[76:79], v[32:35], a[32:35], v[76:79]
    v_add_u32 v25, s42, v27
    ds_read_b128 v[32:35], v25 offset:0
    v_mfma_f32_16x16x32_bf16 v[76:79], v[40:43], a[40:43], v[76:79]
    s_mov_b32 s34, s42
    ds_read_b128 v[36:39], v25 offset:1024
    v_mfma_f32_16x16x32_bf16 v[76:79], v[44:47], a[44:47], v[76:79]
    v_exp_f32 v80, v64
    v_mfma_f32_16x16x32_bf16 v[68:71], v[44:47], a[12:15], v[68:71]
    v_mfma_f32_16x16x32_bf16 v[68:71], v[40:43], a[8:11], v[68:71]
    ds_read_b128 v[40:43], v25 offset:2048
    s_waitcnt lgkmcnt(3)
    v_mfma_f32_16x16x32_bf16 v[68:71], v[48:51], a[16:19], v[68:71]
    ds_read_b128 v[44:47], v25 offset:3072
    v_mfma_f32_16x16x32_bf16 v[68:71], v[52:55], a[20:23], v[68:71]
    v_exp_f32 v81, v65
    v_mfma_f32_16x16x32_bf16 v[76:79], v[52:55], a[52:55], v[76:79]
    v_mfma_f32_16x16x32_bf16 v[76:79], v[48:51], a[48:51], v[76:79]
    ds_read_b128 v[48:51], v25 offset:4096
    v_exp_f32 v82, v66
    v_mfma_f32_16x16x32_bf16 v[76:79], v[56:59], a[56:59], v[76:79]
    ds_read_b128 v[52:55], v25 offset:5120
    v_exp_f32 v83, v67
    v_mfma_f32_16x16x32_bf16 v[76:79], v[60:63], a[60:63], v[76:79]
    v_exp_f32 v88, v72
    v_mfma_f32_16x16x32_bf16 v[68:71], v[60:63], a[28:31], v[68:71]
    v_mfma_f32_16x16x32_bf16 v[68:71], v[56:59], a[24:27], v[68:71]
    ds_read_b128 v[56:59], v25 offset:6144
    ds_read_b128 v[60:63], v25 offset:7168
    s_waitcnt lgkmcnt(4)
    v_mfma_f32_16x16x32_bf16 a[128:131], v[32:35], v[112:115], a[128:131]
    s_add_u32 m0, m0, 4096
    v_max3_f32 v30, v64, v65, v66
    v_mfma_f32_16x16x32_bf16 a[192:195], v[32:35], v[116:119], a[192:195]
    v_exp_f32 v89, v73
    v_mfma_f32_16x16x32_bf16 a[196:199], v[36:39], v[116:119], a[196:199]
    v_max3_f32 v30, v30, v67, v72
    v_mfma_f32_16x16x32_bf16 a[132:135], v[36:39], v[112:115], a[132:135]
    ds_read_b128 v[32:35], v25 offset:8192
    v_exp_f32 v90, v74
    v_mfma_f32_16x16x32_bf16 a[136:139], v[40:43], v[112:115], a[136:139]
    s_add_u32 s42, s34, 32768
    ds_read_b128 v[36:39], v25 offset:9216
    v_mfma_f32_16x16x32_bf16 a[200:203], v[40:43], v[116:119], a[200:203]
    v_exp_f32 v91, v75
    v_mfma_f32_16x16x32_bf16 a[204:207], v[44:47], v[116:119], a[204:207]
    v_max3_f32 v30, v30, v73, v74
    v_mfma_f32_16x16x32_bf16 a[140:143], v[44:47], v[112:115], a[140:143]
    ds_read_b128 v[40:43], v25 offset:10240
    s_waitcnt lgkmcnt(3)
    v_mfma_f32_16x16x32_bf16 a[144:147], v[48:51], v[112:115], a[144:147]
    s_cmp_eq_u32 s42, s37
    ds_read_b128 v[44:47], v25 offset:11264
    v_mfma_f32_16x16x32_bf16 a[208:211], v[48:51], v[116:119], a[208:211]
    v_exp_f32 v84, v68
    v_mfma_f32_16x16x32_bf16 a[212:215], v[52:55], v[116:119], a[212:215]
    v_max3_f32 v30, v30, v75, v68
    v_mfma_f32_16x16x32_bf16 a[148:151], v[52:55], v[112:115], a[148:151]
    s_cselect_b32 s42, 0, s42
    ds_read_b128 v[48:51], v25 offset:12288
    v_mfma_f32_16x16x32_bf16 a[152:155], v[56:59], v[112:115], a[152:155]
    ds_read_b128 v[52:55], v25 offset:13312
    v_exp_f32 v85, v69
    v_mfma_f32_16x16x32_bf16 a[216:219], v[56:59], v[116:119], a[216:219]
    v_exp_f32 v86, v70
    v_mfma_f32_16x16x32_bf16 a[220:223], v[60:63], v[116:119], a[220:223]
    v_max3_f32 v30, v30, v69, v70
    v_mfma_f32_16x16x32_bf16 a[156:159], v[60:63], v[112:115], a[156:159]
    ds_read_b128 v[56:59], v25 offset:14336
    s_waitcnt lgkmcnt(3)
    v_mfma_f32_16x16x32_bf16 a[160:163], v[32:35], v[112:115], a[160:163]
    s_add_u32 m0, s31, s35
    ds_read_b128 v[60:63], v25 offset:15360
    v_mfma_f32_16x16x32_bf16 a[224:227], v[32:35], v[116:119], a[224:227]
    s_waitcnt vmcnt(16)
    s_barrier
    v_mfma_f32_16x16x32_bf16 a[228:231], v[36:39], v[116:119], a[228:231]
    v_max3_f32 v30, v30, v71, v76
    v_mfma_f32_16x16x32_bf16 a[164:167], v[36:39], v[112:115], a[164:167]
    v_add_u32 v25, s42, v27
    ds_read_b128 v[32:35], v25 offset:0
    v_mfma_f32_16x16x32_bf16 a[168:171], v[40:43], v[112:115], a[168:171]
    s_mov_b32 s35, s42
    ds_read_b128 v[36:39], v25 offset:1024
    v_mfma_f32_16x16x32_bf16 a[232:235], v[40:43], v[116:119], a[232:235]
    v_exp_f32 v87, v71
    v_mfma_f32_16x16x32_bf16 a[236:239], v[44:47], v[116:119], a[236:239]
    v_max3_f32 v30, v30, v77, v78
    v_mfma_f32_16x16x32_bf16 a[172:175], v[44:47], v[112:115], a[172:175]
    ds_read_b128 v[40:43], v25 offset:2048
    s_waitcnt lgkmcnt(3)
    v_mfma_f32_16x16x32_bf16 a[176:179], v[48:51], v[112:115], a[176:179]
    ds_read_b128 v[44:47], v25 offset:3072
    v_mfma_f32_16x16x32_bf16 a[240:243], v[48:51], v[116:119], a[240:243]
    v_exp_f32 v92, v76
    v_mfma_f32_16x16x32_bf16 a[244:247], v[52:55], v[116:119], a[244:247]
    v_max_f32 v30, v30, v79
    v_mfma_f32_16x16x32_bf16 a[180:183], v[52:55], v[112:115], a[180:183]
    ds_read_b128 v[48:51], v25 offset:4096
    v_exp_f32 v93, v77
    v_mfma_f32_16x16x32_bf16 a[184:187], v[56:59], v[112:115], a[184:187]
    ds_read_b128 v[52:55], v25 offset:5120
    v_exp_f32 v94, v78
    v_mfma_f32_16x16x32_bf16 a[248:251], v[56:59], v[116:119], a[248:251]
    v_exp_f32 v95, v79
    v_mfma_f32_16x16x32_bf16 a[252:255], v[60:63], v[116:119], a[252:255]
    v_mfma_f32_16x16x32_bf16 a[188:191], v[60:63], v[112:115], a[188:191]
    ds_read_b128 v[56:59], v25 offset:6144
    v_cmp_lt_f32 vcc, 0x41000000, v30
    v_mfma_f32_16x16x32_bf16 v[2:5], v[120:123], v[112:115], v[2:5]
    ds_read_b128 v[60:63], v25 offset:7168
    v_mfma_f32_16x16x32_bf16 v[6:9], v[120:123], v[116:119], v[6:9]
    s_cbranch_vccnz L_eA0
L_rA0:
    s_sub_u32 s43, s43, 1
    s_waitcnt lgkmcnt(4)
    v_mfma_f32_16x16x32_bf16 v[64:67], v[32:35], a[0:3], v[96:99]
    s_cbranch_scc0 L_hotA
    s_mov_b32 s36, 0
    s_mov_b32 s38, s46
    s_sub_u32 s39, s45, 65536
    s_branch L_coldA
L_coldA2:
    s_mov_b32 s36, 16384
L_coldA:
    s_sub_i32 s48, s48, 1
    s_cmp_le_i32 s48, 0
    s_cbranch_scc0 L_pm1
    s_lshl_b32 s40, s48, 5
    v_add_u32 v31, s40, v22
    v_mov_b32 v24, 0xf149f2ca
    s_nop 3
    v_cmp_gt_i32 s[60:61], 0, v31
    v_cmp_gt_i32 s[62:63], 1, v31
    v_cmp_gt_i32 s[96:97], 2, v31
    v_cmp_gt_i32 s[98:99], 3, v31
    v_cndmask_b32 v96, v96, v24, s[60:61]
    v_cndmask_b32 v97, v97, v24, s[62:63]
    v_cndmask_b32 v98, v98, v24, s[96:97]
    v_cndmask_b32 v99, v99, v24, s[98:99]
    v_cmp_gt_i32 s[60:61], 16, v31
    v_cmp_gt_i32 s[62:63], 17, v31
    v_cmp_gt_i32 s[96:97], 18, v31
    v_cmp_gt_i32 s[98:99], 19, v31
    v_cndmask_b32 v100, v100, v24, s[60:61]
    v_cndmask_b32 v101, v101, v24, s[62:63]
    v_cndmask_b32 v102, v102, v24, s[96:97]
    v_cndmask_b32 v103, v103, v24, s[98:99]
    v_cmp_gt_i32 s[60:61], -16, v31
    v_cmp_gt_i32 s[62:63], -15, v31
    v_cmp_gt_i32 s[96:97], -14, v31
    v_cmp_gt_i32 s[98:99], -13, v31
    v_cndmask_b32 v104, v104, v24, s[60:61]
    v_cndmask_b32 v105, v105, v24, s[62:63]
    v_cndmask_b32 v106, v106, v24, s[96:97]
    v_cndmask_b32 v107, v107, v24, s[98:99]
    v_cmp_gt_i32 s[60:61], 0, v31
    v_cmp_gt_i32 s[62:63], 1, v31
    v_cmp_gt_i32 s[96:97], 2, v31
    v_cmp_gt_i32 s[98:99], 3, v31
    v_cndmask_b32 v108, v108, v24, s[60:61]
    v_cndmask_b32 v109, v109, v24, s[62:63]
    v_cndmask_b32 v110, v110, v24, s[96:97]
    v_cndmask_b32 v111, v111, v24, s[98:99]
    s_nop 1
L_pm1:
    s_waitcnt lgkmcnt(4)
    v_mfma_f32_16x16x32_bf16 v[64:67], v[32:35], a[0:3], v[96:99]
    s_add_u32 m0, m0, 4096
    v_mfma_f32_16x16x32_bf16 v[64:67], v[36:39], a[4:7], v[64:67]
    v_cvt_pk_bf16_f32 v112, v80, v81
    v_cvt_pk_bf16_f32 v113, v82, v83
    v_mfma_f32_16x16x32_bf16 v[72:75], v[36:39], a[36:39], v[104:107]
    buffer_load_dwordx4 v26, s[4:7], s39 offen offset:0 sc1 lds
    v_mfma_f32_16x16x32_bf16 v[72:75], v[32:35], a[32:35], v[72:75]
    ds_read_b128 v[32:35], v25 offset:8192
    v_mfma_f32_16x16x32_bf16 v[72:75], v[40:43], a[40:43], v[72:75]
    s_add_u32 s42, s35, 32768
    ds_read_b128 v[36:39], v25 offset:9216
    v_mfma_f32_16x16x32_bf16 v[72:75], v[44:47], a[44:47], v[72:75]
    v_cvt_pk_bf16_f32 v116, v88, v89
    v_cvt_pk_bf16_f32 v117, v90, v91
    v_mfma_f32_16x16x32_bf16 v[64:67], v[44:47], a[12:15], v[64:67]
    buffer_load_dwordx4 v26, s[4:7], s39 offen offset:1024 sc1 lds
    v_mfma_f32_16x16x32_bf16 v[64:67], v[40:43], a[8:11], v[64:67]
    ds_read_b128 v[40:43], v25 offset:10240
    s_waitcnt lgkmcnt(3)
    v_mfma_f32_16x16x32_bf16 v[64:67], v[48:51], a[16:19], v[64:67]
    s_cmp_eq_u32 s42, s37
    ds_read_b128 v[44:47], v25 offset:11264
    v_mfma_f32_16x16x32_bf16 v[64:67], v[52:55], a[20:23], v[64:67]
    v_cvt_pk_bf16_f32 v114, v84, v85
    v_cvt_pk_bf16_f32 v115, v86, v87
    v_mfma_f32_16x16x32_bf16 v[72:75], v[52:55], a[52:55], v[72:75]
    buffer_load_dwordx4 v26, s[4:7], s39 offen offset:2048 sc1 lds
    v_mfma_f32_16x16x32_bf16 v[72:75], v[48:51], a[48:51], v[72:75]
    s_cselect_b32 s42, 0, s42
    ds_read_b128 v[48:51], v25 offset:12288
    v_mfma_f32_16x16x32_bf16 v[72:75], v[56:59], a[56:59], v[72:75]
    ds_read_b128 v[52:55], v25 offset:13312
    v_mfma_f32_16x16x32_bf16 v[72:75], v[60:63], a[60:63], v[72:75]
    v_cvt_pk_bf16_f32 v118, v92, v93
    v_cvt_pk_bf16_f32 v119, v94, v95
    v_mfma_f32_16x16x32_bf16 v[64:67], v[60:63], a[28:31], v[64:67]
    buffer_load_dwordx4 v26, s[4:7], s39 offen offset:3072 sc1 lds
    v_mfma_f32_16x16x32_bf16 v[64:67], v[56:59], a[24:27], v[64:67]
    ds_read_b128 v[56:59], v25 offset:14336
    s_waitcnt lgkmcnt(3)
    v_mfma_f32_16x16x32_bf16 v[68:71], v[32:35], a[0:3], v[100:103]
    s_add_u32 m0, s31, s34
    ds_read_b128 v[60:63], v25 offset:15360
    v_mfma_f32_16x16x32_bf16 v[68:71], v[36:39], a[4:7], v[68:71]
    s_waitcnt vmcnt(16)
    s_barrier
    v_mfma_f32_16x16x32_bf16 v[76:79], v[36:39], a[36:39], v[108:111]
    buffer_load_dwordx4 v27, s[4:7], s38 offen offset:0 sc1 lds
    v_mfma_f32_16x16x32_bf16 v[76:79], v[32:35], a[32:35], v[76:79]
    v_add_u32 v25, s42, v27
    ds_read_b128 v[32:35], v25 offset:0
    v_mfma_f32_16x16x32_bf16 v[76:79], v[40:43], a[40:43], v[76:79]
    s_mov_b32 s34, s42
    ds_read_b128 v[36:39], v25 offset:1024
    v_mfma_f32_16x16x32_bf16 v[76:79], v[44:47], a[44:47], v[76:79]
    v_exp_f32 v80, v64
    v_mfma_f32_16x16x32_bf16 v[68:71], v[44:47], a[12:15], v[68:71]
    buffer_load_dwordx4 v27, s[4:7], s38 offen offset:1024 sc1 lds
    v_mfma_f32_16x16x32_bf16 v[68:71], v[40:43], a[8:11], v[68:71]
    ds_read_b128 v[40:43], v25 offset:2048
    s_waitcnt lgkmcnt(3)
    v_mfma_f32_16x16x32_bf16 v[68:71], v[48:51], a[16:19], v[68:71]
    ds_read_b128 v[44:47], v25 offset:3072
    s_add_u32 s39, s39, 32768
    s_cmp_eq_u32 s39, s45
    s_cselect_b32 s39, s47, s39
    v_mfma_f32_16x16x32_bf16 v[68:71], v[52:55], a[20:23], v[68:71]
    v_exp_f32 v81, v65
    v_mfma_f32_16x16x32_bf16 v[76:79], v[52:55], a[52:55], v[76:79]
    buffer_load_dwordx4 v27, s[4:7], s38 offen offset:2048 sc1 lds
    v_mfma_f32_16x16x32_bf16 v[76:79], v[48:51], a[48:51], v[76:79]
    ds_read_b128 v[48:51], v25 offset:4096
    v_exp_f32 v82, v66
    v_mfma_f32_16x16x32_bf16 v[76:79], v[56:59], a[56:59], v[76:79]
    ds_read_b128 v[52:55], v25 offset:5120
    v_exp_f32 v83, v67
    v_mfma_f32_16x16x32_bf16 v[76:79], v[60:63], a[60:63], v[76:79]
    v_exp_f32 v88, v72
    v_mfma_f32_16x16x32_bf16 v[68:71], v[60:63], a[28:31], v[68:71]
    buffer_load_dwordx4 v27, s[4:7], s38 offen offset:3072 sc1 lds
    v_mfma_f32_16x16x32_bf16 v[68:71], v[56:59], a[24:27], v[68:71]
    ds_read_b128 v[56:59], v25 offset:6144
    ds_read_b128 v[60:63], v25 offset:7168
    s_waitcnt lgkmcnt(4)
    v_mfma_f32_16x16x32_bf16 a[128:131], v[32:35], v[112:115], a[128:131]
    s_add_u32 m0, m0, 4096
    v_max3_f32 v30, v64, v65, v66
    v_mfma_f32_16x16x32_bf16 a[192:195], v[32:35], v[116:119], a[192:195]
    v_exp_f32 v89, v73
    v_mfma_f32_16x16x32_bf16 a[196:199], v[36:39], v[116:119], a[196:199]
    buffer_load_dwordx4 v26, s[4:7], s38 offen offset:0 sc1 lds
    v_max3_f32 v30, v30, v67, v72
    v_mfma_f32_16x16x32_bf16 a[132:135], v[36:39], v[112:115], a[132:135]
    ds_read_b128 v[32:35], v25 offset:8192
    v_exp_f32 v90, v74
    v_mfma_f32_16x16x32_bf16 a[136:139], v[40:43], v[112:115], a[136:139]
    s_add_u32 s42, s34, 32768
    ds_read_b128 v[36:39], v25 offset:9216
    v_mfma_f32_16x16x32_bf16 a[200:203], v[40:43], v[116:119], a[200:203]
    v_exp_f32 v91, v75
    v_mfma_f32_16x16x32_bf16 a[204:207], v[44:47], v[116:119], a[204:207]
    buffer_load_dwordx4 v26, s[4:7], s38 offen offset:1024 sc1 lds
    v_max3_f32 v30, v30, v73, v74
    v_mfma_f32_16x16x32_bf16 a[140:143], v[44:47], v[112:115], a[140:143]
    ds_read_b128 v[40:43], v25 offset:10240
    s_waitcnt lgkmcnt(3)
    v_mfma_f32_16x16x32_bf16 a[144:147], v[48:51], v[112:115], a[144:147]
    s_cmp_eq_u32 s42, s37
    ds_read_b128 v[44:47], v25 offset:11264
    v_mfma_f32_16x16x32_bf16 a[208:211], v[48:51], v[116:119], a[208:211]
    v_exp_f32 v84, v68
    v_mfma_f32_16x16x32_bf16 a[212:215], v[52:55], v[116:119], a[212:215]
    buffer_load_dwordx4 v26, s[4:7], s38 offen offset:2048 sc1 lds
    v_max3_f32 v30, v30, v75, v68
    v_mfma_f32_16x16x32_bf16 a[148:151], v[52:55], v[112:115], a[148:151]
    s_cselect_b32 s42, 0, s42
    ds_read_b128 v[48:51], v25 offset:12288
    v_mfma_f32_16x16x32_bf16 a[152:155], v[56:59], v[112:115], a[152:155]
    ds_read_b128 v[52:55], v25 offset:13312
    v_exp_f32 v85, v69
    v_mfma_f32_16x16x32_bf16 a[216:219], v[56:59], v[116:119], a[216:219]
    v_exp_f32 v86, v70
    v_mfma_f32_16x16x32_bf16 a[220:223], v[60:63], v[116:119], a[220:223]
    buffer_load_dwordx4 v26, s[4:7], s38 offen offset:3072 sc1 lds
    v_max3_f32 v30, v30, v69, v70
    v_mfma_f32_16x16x32_bf16 a[156:159], v[60:63], v[112:115], a[156:159]
    ds_read_b128 v[56:59], v25 offset:14336
    s_waitcnt lgkmcnt(3)
    v_mfma_f32_16x16x32_bf16 a[160:163], v[32:35], v[112:115], a[160:163]
    s_add_u32 m0, s31, s35
    ds_read_b128 v[60:63], v25 offset:15360
    v_mfma_f32_16x16x32_bf16 a[224:227], v[32:35], v[116:119], a[224:227]
    s_waitcnt vmcnt(16)
    s_barrier
    v_mfma_f32_16x16x32_bf16 a[228:231], v[36:39], v[116:119], a[228:231]
    buffer_load_dwordx4 v27, s[4:7], s39 offen offset:0 sc1 lds
    v_max3_f32 v30, v30, v71, v76
    v_mfma_f32_16x16x32_bf16 a[164:167], v[36:39], v[112:115], a[164:167]
    s_add_u32 s40, s42, s36
    v_add_u32 v25, s40, v27
    ds_read_b128 v[32:35], v25 offset:0
    v_mfma_f32_16x16x32_bf16 a[168:171], v[40:43], v[112:115], a[168:171]
    s_mov_b32 s35, s42
    ds_read_b128 v[36:39], v25 offset:1024
    v_mfma_f32_16x16x32_bf16 a[232:235], v[40:43], v[116:119], a[232:235]
    v_exp_f32 v87, v71
    v_mfma_f32_16x16x32_bf16 a[236:239], v[44:47], v[116:119], a[236:239]
    buffer_load_dwordx4 v27, s[4:7], s39 offen offset:1024 sc1 lds
    v_max3_f32 v30, v30, v77, v78
    v_mfma_f32_16x16x32_bf16 a[172:175], v[44:47], v[112:115], a[172:175]
    ds_read_b128 v[40:43], v25 offset:2048
    s_waitcnt lgkmcnt(3)
    v_mfma_f32_16x16x32_bf16 a[176:179], v[48:51], v[112:115], a[176:179]
    ds_read_b128 v[44:47], v25 offset:3072
    s_add_u32 s38, s38, 32768
    s_cmp_eq_u32 s38, s44
    s_cselect_b32 s38, s46, s38
    v_mfma_f32_16x16x32_bf16 a[240:243], v[48:51], v[116:119], a[240:243]
    v_exp_f32 v92, v76
    v_mfma_f32_16x16x32_bf16 a[244:247], v[52:55], v[116:119], a[244:247]
    buffer_load_dwordx4 v27, s[4:7], s39 offen offset:2048 sc1 lds
    v_max_f32 v30, v30, v79
    v_mfma_f32_16x16x32_bf16 a[180:183], v[52:55], v[112:115], a[180:183]
    ds_read_b128 v[48:51], v25 offset:4096
    v_exp_f32 v93, v77
    v_mfma_f32_16x16x32_bf16 a[184:187], v[56:59], v[112:115], a[184:187]
    ds_read_b128 v[52:55], v25 offset:5120
    v_exp_f32 v94, v78
    v_mfma_f32_16x16x32_bf16 a[248:251], v[56:59], v[116:119], a[248:251]
    v_exp_f32 v95, v79
    v_mfma_f32_16x16x32_bf16 a[252:255], v[60:63], v[116:119], a[252:255]
    buffer_load_dwordx4 v27, s[4:7], s39 offen offset:3072 sc1 lds
    v_mfma_f32_16x16x32_bf16 a[188:191], v[60:63], v[112:115], a[188:191]
    ds_read_b128 v[56:59], v25 offset:6144
    v_cmp_lt_f32 vcc, 0x41000000, v30
    v_mfma_f32_16x16x32_bf16 v[2:5], v[120:123], v[112:115], v[2:5]
    ds_read_b128 v[60:63], v25 offset:7168
    v_mfma_f32_16x16x32_bf16 v[6:9], v[120:123], v[116:119], v[6:9]
    s_cbranch_vccnz L_eA1
L_rA1:
    s_cmp_eq_u32 s36, 0
    s_cbranch_scc1 L_coldA2
    v_mov_b32 v96, 0
    v_mov_b32 v97, 0
    v_mov_b32 v98, 0
    v_mov_b32 v99, 0
    v_mov_b32 v100, 0
    v_mov_b32 v101, 0
    v_mov_b32 v102, 0
    v_mov_b32 v103, 0
    v_mov_b32 v104, 0
    v_mov_b32 v105, 0
    v_mov_b32 v106, 0
    v_mov_b32 v107, 0
    v_mov_b32 v108, 0
    v_mov_b32 v109, 0
    v_mov_b32 v110, 0
    v_mov_b32 v111, 0
    v_mov_b32 v20, 0
    v_mov_b32 v21, 0
    s_sub_u32 s48, s30, 32
    s_sub_i32 s48, s48, 1
    s_cmp_le_i32 s48, 0
    s_cbranch_scc0 L_pm2
    s_lshl_b32 s40, s48, 5
    v_add_u32 v31, s40, v22
    v_mov_b32 v24, 0xf149f2ca
    s_nop 3
    v_cmp_gt_i32 s[60:61], 0, v31
    v_cmp_gt_i32 s[62:63], 1, v31
    v_cmp_gt_i32 s[96:97], 2, v31
    v_cmp_gt_i32 s[98:99], 3, v31
    v_cndmask_b32 v96, v96, v24, s[60:61]
    v_cndmask_b32 v97, v97, v24, s[62:63]
    v_cndmask_b32 v98, v98, v24, s[96:97]
    v_cndmask_b32 v99, v99, v24, s[98:99]
    v_cmp_gt_i32 s[60:61], 16, v31
    v_cmp_gt_i32 s[62:63], 17, v31
    v_cmp_gt_i32 s[96:97], 18, v31
    v_cmp_gt_i32 s[98:99], 19, v31
    v_cndmask_b32 v100, v100, v24, s[60:61]
    v_cndmask_b32 v101, v101, v24, s[62:63]
    v_cndmask_b32 v102, v102, v24, s[96:97]
    v_cndmask_b32 v103, v103, v24, s[98:99]
    v_cmp_gt_i32 s[60:61], -16, v31
    v_cmp_gt_i32 s[62:63], -15, v31
    v_cmp_gt_i32 s[96:97], -14, v31
    v_cmp_gt_i32 s[98:99], -13, v31
    v_cndmask_b32 v104, v104, v24, s[60:61]
    v_cndmask_b32 v105, v105, v24, s[62:63]
    v_cndmask_b32 v106, v106, v24, s[96:97]
    v_cndmask_b32 v107, v107, v24, s[98:99]
    v_cmp_gt_i32 s[60:61], 0, v31
    v_cmp_gt_i32 s[62:63], 1, v31
    v_cmp_gt_i32 s[96:97], 2, v31
    v_cmp_gt_i32 s[98:99], 3, v31
    v_cndmask_b32 v108, v108, v24, s[60:61]
    v_cndmask_b32 v109, v109, v24, s[62:63]
    v_cndmask_b32 v110, v110, v24, s[96:97]
    v_cndmask_b32 v111, v111, v24, s[98:99]
    s_nop 1
L_pm2:
    s_waitcnt lgkmcnt(4)
    v_mfma_f32_16x16x32_bf16 v[64:67], v[32:35], a[64:67], v[96:99]
    s_add_u32 m0, m0, 4096
    v_mfma_f32_16x16x32_bf16 v[64:67], v[36:39], a[68:71], v[64:67]
    v_cvt_pk_bf16_f32 v112, v80, v81
    v_cvt_pk_bf16_f32 v113, v82, v83
    v_mfma_f32_16x16x32_bf16 v[72:75], v[36:39], a[100:103], v[104:107]
    buffer_load_dwordx4 v26, s[4:7], s39 offen offset:0 sc1 lds
    v_mfma_f32_16x16x32_bf16 v[72:75], v[32:35], a[96:99], v[72:75]
    ds_read_b128 v[32:35], v25 offset:8192
    v_mfma_f32_16x16x32_bf16 v[72:75], v[40:43], a[104:107], v[72:75]
    s_add_u32 s42, s35, 32768
    ds_read_b128 v[36:39], v25 offset:9216
    v_mfma_f32_16x16x32_bf16 v[72:75], v[44:47], a[108:111], v[72:75]
    v_cvt_pk_bf16_f32 v116, v88, v89
    v_cvt_pk_bf16_f32 v117, v90, v91
    v_mfma_f32_16x16x32_bf16 v[64:67], v[44:47], a[76:79], v[64:67]
    buffer_load_dwordx4 v26, s[4:7], s39 offen offset:1024 sc1 lds
    v_mfma_f32_16x16x32_bf16 v[64:67], v[40:43], a[72:75], v[64:67]
    ds_read_b128 v[40:43], v25 offset:10240
    s_waitcnt lgkmcnt(3)
    v_mfma_f32_16x16x32_bf16 v[64:67], v[48:51], a[80:83], v[64:67]
    s_cmp_eq_u32 s42, s37
    ds_read_b128 v[44:47], v25 offset:11264
    v_mfma_f32_16x16x32_bf16 v[64:67], v[52:55], a[84:87], v[64:67]
    v_cvt_pk_bf16_f32 v114, v84, v85
    v_cvt_pk_bf16_f32 v115, v86, v87
    v_mfma_f32_16x16x32_bf16 v[72:75], v[52:55], a[116:119], v[72:75]
    buffer_load_dwordx4 v26, s[4:7], s39 offen offset:2048 sc1 lds
    v_mfma_f32_16x16x32_bf16 v[72:75], v[48:51], a[112:115], v[72:75]
    s_cselect_b32 s42, 0, s42
    ds_read_b128 v[48:51], v25 offset:12288
    v_mfma_f32_16x16x32_bf16 v[72:75], v[56:59], a[120:123], v[72:75]
    ds_read_b128 v[52:55], v25 offset:13312
    v_mfma_f32_16x16x32_bf16 v[72:75], v[60:63], a[124:127], v[72:75]
    v_cvt_pk_bf16_f32 v118, v92, v93
    v_cvt_pk_bf16_f32 v119, v94, v95
    v_mfma_f32_16x16x32_bf16 v[64:67], v[60:63], a[92:95], v[64:67]
    buffer_load_dwordx4 v26, s[4:7], s39 offen offset:3072 sc1 lds
    v_mfma_f32_16x16x32_bf16 v[64:67], v[56:59], a[88:91], v[64:67]
    ds_read_b128 v[56:59], v25 offset:14336
    s_waitcnt lgkmcnt(3)
    v_mfma_f32_16x16x32_bf16 v[68:71], v[32:35], a[64:67], v[100:103]
    s_add_u32 m0, s31, s34
    ds_read_b128 v[60:63], v25 offset:15360
    v_mfma_f32_16x16x32_bf16 v[68:71], v[36:39], a[68:71], v[68:71]
    s_waitcnt vmcnt(16)
    s_barrier
    v_mfma_f32_16x16x32_bf16 v[76:79], v[36:39], a[100:103], v[108:111]
    buffer_load_dwordx4 v27, s[4:7], s38 offen offset:0 sc1 lds
    v_mfma_f32_16x16x32_bf16 v[76:79], v[32:35], a[96:99], v[76:79]
    v_add_u32 v25, s42, v27
    ds_read_b128 v[32:35], v25 offset:0
    v_mfma_f32_16x16x32_bf16 v[76:79], v[40:43], a[104:107], v[76:79]
    s_mov_b32 s34, s42
    ds_read_b128 v[36:39], v25 offset:1024
    v_mfma_f32_16x16x32_bf16 v[76:79], v[44:47], a[108:111], v[76:79]
    v_exp_f32 v80, v64
    v_mfma_f32_16x16x32_bf16 v[68:71], v[44:47], a[76:79], v[68:71]
    buffer_load_dwordx4 v27, s[4:7], s38 offen offset:1024 sc1 lds
    v_mfma_f32_16x16x32_bf16 v[68:71], v[40:43], a[72:75], v[68:71]
    ds_read_b128 v[40:43], v25 offset:2048
    s_waitcnt lgkmcnt(3)
    v_mfma_f32_16x16x32_bf16 v[68:71], v[48:51], a[80:83], v[68:71]
    ds_read_b128 v[44:47], v25 offset:3072
    s_add_u32 s39, s39, 32768
    s_cmp_eq_u32 s39, s45
    s_cselect_b32 s39, s47, s39
    v_mfma_f32_16x16x32_bf16 v[68:71], v[52:55], a[84:87], v[68:71]
    v_exp_f32 v81, v65
    v_mfma_f32_16x16x32_bf16 v[76:79], v[52:55], a[116:119], v[76:79]
    buffer_load_dwordx4 v27, s[4:7], s38 offen offset:2048 sc1 lds
    v_mfma_f32_16x16x32_bf16 v[76:79], v[48:51], a[112:115], v[76:79]
    ds_read_b128 v[48:51], v25 offset:4096
    v_exp_f32 v82, v66
    v_mfma_f32_16x16x32_bf16 v[76:79], v[56:59], a[120:123], v[76:79]
    ds_read_b128 v[52:55], v25 offset:5120
    v_exp_f32 v83, v67
    v_mfma_f32_16x16x32_bf16 v[76:79], v[60:63], a[124:127], v[76:79]
    v_exp_f32 v88, v72
    v_mfma_f32_16x16x32_bf16 v[68:71], v[60:63], a[92:95], v[68:71]
    buffer_load_dwordx4 v27, s[4:7], s38 offen offset:3072 sc1 lds
    v_mfma_f32_16x16x32_bf16 v[68:71], v[56:59], a[88:91], v[68:71]
    ds_read_b128 v[56:59], v25 offset:6144
    ds_read_b128 v[60:63], v25 offset:7168
    s_waitcnt lgkmcnt(4)
    v_mfma_f32_16x16x32_bf16 a[128:131], v[32:35], v[112:115], a[128:131]
    s_add_u32 m0, m0, 4096
    v_max3_f32 v30, v64, v65, v66
    v_mfma_f32_16x16x32_bf16 a[192:195], v[32:35], v[116:119], a[192:195]
    v_exp_f32 v89, v73
    v_mfma_f32_16x16x32_bf16 a[196:199], v[36:39], v[116:119], a[196:199]
    buffer_load_dwordx4 v26, s[4:7], s38 offen offset:0 sc1 lds
    v_max3_f32 v30, v30, v67, v72
    v_mfma_f32_16x16x32_bf16 a[132:135], v[36:39], v[112:115], a[132:135]
    ds_read_b128 v[32:35], v25 offset:8192
    v_exp_f32 v90, v74
    v_mfma_f32_16x16x32_bf16 a[136:139], v[40:43], v[112:115], a[136:139]
    s_add_u32 s42, s34, 32768
    ds_read_b128 v[36:39], v25 offset:9216
    v_mfma_f32_16x16x32_bf16 a[200:203], v[40:43], v[116:119], a[200:203]
    v_exp_f32 v91, v75
    v_mfma_f32_16x16x32_bf16 a[204:207], v[44:47], v[116:119], a[204:207]
    buffer_load_dwordx4 v26, s[4:7], s38 offen offset:1024 sc1 lds
    v_max3_f32 v30, v30, v73, v74
    v_mfma_f32_16x16x32_bf16 a[140:143], v[44:47], v[112:115], a[140:143]
    ds_read_b128 v[40:43], v25 offset:10240
    s_waitcnt lgkmcnt(3)
    v_mfma_f32_16x16x32_bf16 a[144:147], v[48:51], v[112:115], a[144:147]
    s_cmp_eq_u32 s42, s37
    ds_read_b128 v[44:47], v25 offset:11264
    v_mfma_f32_16x16x32_bf16 a[208:211], v[48:51], v[116:119], a[208:211]
    v_exp_f32 v84, v68
    v_mfma_f32_16x16x32_bf16 a[212:215], v[52:55], v[116:119], a[212:215]
    buffer_load_dwordx4 v26, s[4:7], s38 offen offset:2048 sc1 lds
    v_max3_f32 v30, v30, v75, v68
    v_mfma_f32_16x16x32_bf16 a[148:151], v[52:55], v[112:115], a[148:151]
    s_cselect_b32 s42, 0, s42
    ds_read_b128 v[48:51], v25 offset:12288
    v_mfma_f32_16x16x32_bf16 a[152:155], v[56:59], v[112:115], a[152:155]
    ds_read_b128 v[52:55], v25 offset:13312
    v_exp_f32 v85, v69
    v_mfma_f32_16x16x32_bf16 a[216:219], v[56:59], v[116:119], a[216:219]
    v_exp_f32 v86, v70
    v_mfma_f32_16x16x32_bf16 a[220:223], v[60:63], v[116:119], a[220:223]
    buffer_load_dwordx4 v26, s[4:7], s38 offen offset:3072 sc1 lds
    v_max3_f32 v30, v30, v69, v70
    v_mfma_f32_16x16x32_bf16 a[156:159], v[60:63], v[112:115], a[156:159]
    ds_read_b128 v[56:59], v25 offset:14336
    s_waitcnt lgkmcnt(3)
    v_mfma_f32_16x16x32_bf16 a[160:163], v[32:35], v[112:115], a[160:163]
    s_add_u32 m0, s31, s35
    ds_read_b128 v[60:63], v25 offset:15360
    v_mfma_f32_16x16x32_bf16 a[224:227], v[32:35], v[116:119], a[224:227]
    s_waitcnt vmcnt(16)
    s_barrier
    v_mfma_f32_16x16x32_bf16 a[228:231], v[36:39], v[116:119], a[228:231]
    buffer_load_dwordx4 v27, s[4:7], s39 offen offset:0 sc1 lds
    v_max3_f32 v30, v30, v71, v76
    v_mfma_f32_16x16x32_bf16 a[164:167], v[36:39], v[112:115], a[164:167]
    v_add_u32 v25, s42, v23
    ds_read_b128 v[32:35], v25 offset:0
    v_mfma_f32_16x16x32_bf16 a[168:171], v[40:43], v[112:115], a[168:171]
    s_mov_b32 s35, s42
    ds_read_b128 v[36:39], v25 offset:1024
    v_mfma_f32_16x16x32_bf16 a[232:235], v[40:43], v[116:119], a[232:235]
    v_exp_f32 v87, v71
    v_mfma_f32_16x16x32_bf16 a[236:239], v[44:47], v[116:119], a[236:239]
    buffer_load_dwordx4 v27, s[4:7], s39 offen offset:1024 sc1 lds
    v_max3_f32 v30, v30, v77, v78
    v_mfma_f32_16x16x32_bf16 a[172:175], v[44:47], v[112:115], a[172:175]
    ds_read_b128 v[40:43], v25 offset:2048
    s_waitcnt lgkmcnt(3)
    v_mfma_f32_16x16x32_bf16 a[176:179], v[48:51], v[112:115], a[176:179]
    ds_read_b128 v[44:47], v25 offset:3072
    s_add_u32 s38, s38, 32768
    s_cmp_eq_u32 s38, s44
    s_cselect_b32 s38, s46, s38
    v_mfma_f32_16x16x32_bf16 a[240:243], v[48:51], v[116:119], a[240:243]
    v_exp_f32 v92, v76
    v_mfma_f32_16x16x32_bf16 a[244:247], v[52:55], v[116:119], a[244:247]
    buffer_load_dwordx4 v27, s[4:7], s39 offen offset:2048 sc1 lds
    v_max_f32 v30, v30, v79
    v_mfma_f32_16x16x32_bf16 a[180:183], v[52:55], v[112:115], a[180:183]
    ds_read_b128 v[48:51], v25 offset:4096
    v_exp_f32 v93, v77
    v_mfma_f32_16x16x32_bf16 a[184:187], v[56:59], v[112:115], a[184:187]
    ds_read_b128 v[52:55], v25 offset:5120
    v_exp_f32 v94, v78
    v_mfma_f32_16x16x32_bf16 a[248:251], v[56:59], v[116:119], a[248:251]
    v_exp_f32 v95, v79
    v_mfma_f32_16x16x32_bf16 a[252:255], v[60:63], v[116:119], a[252:255]
    buffer_load_dwordx4 v27, s[4:7], s39 offen offset:3072 sc1 lds
    v_mfma_f32_16x16x32_bf16 a[188:191], v[60:63], v[112:115], a[188:191]
    ds_read_b128 v[56:59], v25 offset:6144
    v_cmp_lt_f32 vcc, 0x41000000, v30
    v_mfma_f32_16x16x32_bf16 v[2:5], v[120:123], v[112:115], v[2:5]
    ds_read_b128 v[60:63], v25 offset:7168
    v_mfma_f32_16x16x32_bf16 v[6:9], v[120:123], v[116:119], v[6:9]
    s_lshl_b32 s40, s28, 1
    s_sub_u32 s43, 30, s40
    s_branch L_eFB
L_wt0:
    buffer_store_dwordx4 v[32:35], v27, s[4:7], s60 offen offset:0 sc1
    s_branch L_wr0
L_wt1:
    buffer_store_dwordx4 v[40:43], v27, s[4:7], s60 offen offset:1024 sc1
    s_branch L_wr1
L_wt2:
    buffer_store_dwordx4 v[48:51], v27, s[4:7], s60 offen offset:2048 sc1
    s_branch L_wr2
L_wt3:
    buffer_store_dwordx4 v[56:59], v27, s[4:7], s60 offen offset:3072 sc1
    s_branch L_wr3
L_wt4:
    buffer_store_dwordx4 v[64:67], v27, s[4:7], s60 offen offset:0 sc1
    s_branch L_wr4
L_wt5:
    buffer_store_dwordx4 v[72:75], v27, s[4:7], s60 offen offset:1024 sc1
    s_branch L_wr5
L_wt6:
    buffer_store_dwordx4 v[80:83], v27, s[4:7], s60 offen offset:2048 sc1
    s_branch L_wr6
L_wt7:
    buffer_store_dwordx4 v[88:91], v27, s[4:7], s60 offen offset:3072 sc1
    s_branch L_wr7
L_wt8:
    buffer_store_dwordx4 v[96:99], v27, s[4:7], s60 offen offset:0 sc1
    s_branch L_wr8
L_wt9:
    buffer_store_dwordx4 v[104:107], v27, s[4:7], s60 offen offset:1024 sc1
    s_branch L_wr9
L_wt10:
    buffer_store_dwordx4 v[112:115], v27, s[4:7], s60 offen offset:2048 sc1
    s_branch L_wr10
L_wt11:
    buffer_store_dwordx4 v[120:123], v27, s[4:7], s60 offen offset:3072 sc1
    s_branch L_wr11
L_wt12:
    buffer_store_dwordx4 v[128:131], v27, s[4:7], s60 offen offset:0 sc1
    s_branch L_wr12
L_wt13:
    buffer_store_dwordx4 v[136:139], v27, s[4:7], s60 offen offset:1024 sc1
    s_branch L_wr13
L_wt14:
    buffer_store_dwordx4 v[144:147], v27, s[4:7], s60 offen offset:2048 sc1
    s_branch L_wr14
L_wt15:
    buffer_store_dwordx4 v[152:155], v27, s[4:7], s60 offen offset:3072 sc1
    s_branch L_wr15
L_wt16:
    buffer_store_dwordx4 v[32:35], v27, s[4:7], s60 offen offset:0 sc1
    s_branch L_wr16
L_wt17:
    buffer_store_dwordx4 v[40:43], v27, s[4:7], s60 offen offset:1024 sc1
    s_branch L_wr17
L_wt18:
    buffer_store_dwordx4 v[48:51], v27, s[4:7], s60 offen offset:2048 sc1
    s_branch L_wr18
L_wt19:
    buffer_store_dwordx4 v[56:59], v27, s[4:7], s60 offen offset:3072 sc1
    s_branch L_wr19
L_wt20:
    buffer_store_dwordx4 v[64:67], v27, s[4:7], s60 offen offset:0 sc1
    s_branch L_wr20
L_wt21:
    buffer_store_dwordx4 v[72:75], v27, s[4:7], s60 offen offset:1024 sc1
    s_branch L_wr21
L_wt22:
    buffer_store_dwordx4 v[80:83], v27, s[4:7], s60 offen offset:2048 sc1
    s_branch L_wr22
L_wt23:
    buffer_store_dwordx4 v[88:91], v27, s[4:7], s60 offen offset:3072 sc1
    s_branch L_wr23
L_wt24:
    buffer_store_dwordx4 v[96:99], v27, s[4:7], s60 offen offset:0 sc1
    s_branch L_wr24
L_wt25:
    buffer_store_dwordx4 v[104:107], v27, s[4:7], s60 offen offset:1024 sc1
    s_branch L_wr25
L_wt26:
    buffer_store_dwordx4 v[112:115], v27, s[4:7], s60 offen offset:2048 sc1
    s_branch L_wr26
L_wt27:
    buffer_store_dwordx4 v[120:123], v27, s[4:7], s60 offen offset:3072 sc1
    s_branch L_wr27
L_wt28:
    buffer_store_dwordx4 v[128:131], v27, s[4:7], s60 offen offset:0 sc1
    s_branch L_wr28
L_wt29:
    buffer_store_dwordx4 v[136:139], v27, s[4:7], s60 offen offset:1024 sc1
    s_branch L_wr29
L_wt30:
    buffer_store_dwordx4 v[144:147], v27, s[4:7], s60 offen offset:2048 sc1
    s_branch L_wr30
L_wt31:
    buffer_store_dwordx4 v[152:155], v27, s[4:7], s60 offen offset:3072 sc1
    s_branch L_wr31
L_wt32:
    buffer_store_dwordx4 v[160:163], v27, s[4:7], s60 offen offset:0 sc1
    s_branch L_wr32
L_wt33:
    buffer_store_dwordx4 v[168:171], v27, s[4:7], s60 offen offset:1024 sc1
    s_branch L_wr33
L_wt34:
    buffer_store_dwordx4 v[176:179], v27, s[4:7], s60 offen offset:2048 sc1
    s_branch L_wr34
L_wt35:
    buffer_store_dwordx4 v[184:187], v27, s[4:7], s60 offen offset:3072 sc1
    s_branch L_wr35
L_wt36:
    buffer_store_dwordx4 v[192:195], v27, s[4:7], s60 offen offset:0 sc1
    s_branch L_wr36
L_wt37:
    buffer_store_dwordx4 v[200:203], v27, s[4:7], s60 offen offset:1024 sc1
    s_branch L_wr37
L_wt38:
    buffer_store_dwordx4 v[208:211], v27, s[4:7], s60 offen offset:2048 sc1
    s_branch L_wr38
L_wt39:
    buffer_store_dwordx4 v[216:219], v27, s[4:7], s60 offen offset:3072 sc1
    s_branch L_wr39
L_wt40:
    buffer_store_dwordx4 v[224:227], v27, s[4:7], s60 offen offset:0 sc1
    s_branch L_wr40
L_wt41:
    buffer_store_dwordx4 v[232:235], v27, s[4:7], s60 offen offset:1024 sc1
    s_branch L_wr41
L_wt42:
    buffer_store_dwordx4 v[240:243], v27, s[4:7], s60 offen offset:2048 sc1
    s_branch L_wr42
L_wt43:
    buffer_store_dwordx4 v[248:251], v27, s[4:7], s60 offen offset:3072 sc1
    s_branch L_wr43
L_wt44:
    buffer_store_dwordx4 v[48:51], v27, s[4:7], s60 offen offset:0 sc1
    s_branch L_wr44
L_wt45:
    buffer_store_dwordx4 v[56:59], v27, s[4:7], s60 offen offset:1024 sc1
    s_branch L_wr45
L_wt46:
    buffer_store_dwordx4 v[64:67], v27, s[4:7], s60 offen offset:2048 sc1
    s_branch L_wr46
L_wt47:
    buffer_store_dwordx4 v[72:75], v27, s[4:7], s60 offen offset:3072 sc1
    s_branch L_wr47
L_eA0:
    s_mov_b32 s41, 0
    s_branch L_spA
L_eA1:
    s_mov_b32 s41, 1
L_spA:
    v_max3_f32 v18, v64, v65, v66
    v_max3_f32 v19, v72, v73, v74
    v_max3_f32 v18, v18, v67, v68
    v_max3_f32 v19, v19, v75, v76
    v_max3_f32 v18, v18, v69, v70
    v_max3_f32 v19, v19, v77, v78
    v_max_f32 v18, v18, v71
    v_max_f32 v19, v19, v79
    v_mov_b32 v30, v18
    v_mov_b32 v31, v19
    s_nop 1
    v_permlane16_swap_b32 v18, v30
    v_permlane16_swap_b32 v19, v31
    s_nop 1
    v_max_f32 v18, v18, v30
    v_max_f32 v19, v19, v31
    v_mov_b32 v30, v18
    v_mov_b32 v31, v19
    s_nop 1
    v_permlane32_swap_b32 v18, v30
    v_permlane32_swap_b32 v19, v31
    s_nop 1
    v_max_f32 v18, v18, v30
    v_max_f32 v19, v19, v31
    v_max_f32 v18, 0, v18
    v_max_f32 v19, 0, v19
    v_exp_f32 v28, -v18
    v_exp_f32 v29, -v19
    s_nop 0
    v_mul_f32 v2, v2, v28
    v_mul_f32 v6, v6, v29
    v_accvgpr_read_b32 v80, a128
    v_accvgpr_read_b32 v81, a129
    v_accvgpr_read_b32 v82, a130
    v_accvgpr_read_b32 v83, a131
    v_mul_f32 v80, v80, v28
    v_mul_f32 v81, v81, v28
    v_mul_f32 v82, v82, v28
    v_mul_f32 v83, v83, v28
    v_accvgpr_write_b32 a128, v80
    v_accvgpr_write_b32 a129, v81
    v_accvgpr_write_b32 a130, v82
    v_accvgpr_write_b32 a131, v83
    v_accvgpr_read_b32 v80, a132
    v_accvgpr_read_b32 v81, a133
    v_accvgpr_read_b32 v82, a134
    v_accvgpr_read_b32 v83, a135
    v_mul_f32 v80, v80, v28
    v_mul_f32 v81, v81, v28
    v_mul_f32 v82, v82, v28
    v_mul_f32 v83, v83, v28
    v_accvgpr_write_b32 a132, v80
    v_accvgpr_write_b32 a133, v81
    v_accvgpr_write_b32 a134, v82
    v_accvgpr_write_b32 a135, v83
    v_accvgpr_read_b32 v80, a136
    v_accvgpr_read_b32 v81, a137
    v_accvgpr_read_b32 v82, a138
    v_accvgpr_read_b32 v83, a139
    v_mul_f32 v80, v80, v28
    v_mul_f32 v81, v81, v28
    v_mul_f32 v82, v82, v28
    v_mul_f32 v83, v83, v28
    v_accvgpr_write_b32 a136, v80
    v_accvgpr_write_b32 a137, v81
    v_accvgpr_write_b32 a138, v82
    v_accvgpr_write_b32 a139, v83
    v_accvgpr_read_b32 v80, a140
    v_accvgpr_read_b32 v81, a141
    v_accvgpr_read_b32 v82, a142
    v_accvgpr_read_b32 v83, a143
    v_mul_f32 v80, v80, v28
    v_mul_f32 v81, v81, v28
    v_mul_f32 v82, v82, v28
    v_mul_f32 v83, v83, v28
    v_accvgpr_write_b32 a140, v80
    v_accvgpr_write_b32 a141, v81
    v_accvgpr_write_b32 a142, v82
    v_accvgpr_write_b32 a143, v83
    v_accvgpr_read_b32 v80, a144
    v_accvgpr_read_b32 v81, a145
    v_accvgpr_read_b32 v82, a146
    v_accvgpr_read_b32 v83, a147
    v_mul_f32 v80, v80, v28
    v_mul_f32 v81, v81, v28
    v_mul_f32 v82, v82, v28
    v_mul_f32 v83, v83, v28
    v_accvgpr_write_b32 a144, v80
    v_accvgpr_write_b32 a145, v81
    v_accvgpr_write_b32 a146, v82
    v_accvgpr_write_b32 a147, v83
    v_accvgpr_read_b32 v80, a148
    v_accvgpr_read_b32 v81, a149
    v_accvgpr_read_b32 v82, a150
    v_accvgpr_read_b32 v83, a151
    v_mul_f32 v80, v80, v28
    v_mul_f32 v81, v81, v28
    v_mul_f32 v82, v82, v28
    v_mul_f32 v83, v83, v28
    v_accvgpr_write_b32 a148, v80
    v_accvgpr_write_b32 a149, v81
    v_accvgpr_write_b32 a150, v82
    v_accvgpr_write_b32 a151, v83
    v_accvgpr_read_b32 v80, a152
    v_accvgpr_read_b32 v81, a153
    v_accvgpr_read_b32 v82, a154
    v_accvgpr_read_b32 v83, a155
    v_mul_f32 v80, v80, v28
    v_mul_f32 v81, v81, v28
    v_mul_f32 v82, v82, v28
    v_mul_f32 v83, v83, v28
    v_accvgpr_write_b32 a152, v80
    v_accvgpr_write_b32 a153, v81
    v_accvgpr_write_b32 a154, v82
    v_accvgpr_write_b32 a155, v83
    v_accvgpr_read_b32 v80, a156
    v_accvgpr_read_b32 v81, a157
    v_accvgpr_read_b32 v82, a158
    v_accvgpr_read_b32 v83, a159
    v_mul_f32 v80, v80, v28
    v_mul_f32 v81, v81, v28
    v_mul_f32 v82, v82, v28
    v_mul_f32 v83, v83, v28
    v_accvgpr_write_b32 a156, v80
    v_accvgpr_write_b32 a157, v81
    v_accvgpr_write_b32 a158, v82
    v_accvgpr_write_b32 a159, v83
    v_accvgpr_read_b32 v80, a160
    v_accvgpr_read_b32 v81, a161
    v_accvgpr_read_b32 v82, a162
    v_accvgpr_read_b32 v83, a163
    v_mul_f32 v80, v80, v28
    v_mul_f32 v81, v81, v28
    v_mul_f32 v82, v82, v28
    v_mul_f32 v83, v83, v28
    v_accvgpr_write_b32 a160, v80
    v_accvgpr_write_b32 a161, v81
    v_accvgpr_write_b32 a162, v82
    v_accvgpr_write_b32 a163, v83
    v_accvgpr_read_b32 v80, a164
    v_accvgpr_read_b32 v81, a165
    v_accvgpr_read_b32 v82, a166
    v_accvgpr_read_b32 v83, a167
    v_mul_f32 v80, v80, v28
    v_mul_f32 v81, v81, v28
    v_mul_f32 v82, v82, v28
    v_mul_f32 v83, v83, v28
    v_accvgpr_write_b32 a164, v80
    v_accvgpr_write_b32 a165, v81
    v_accvgpr_write_b32 a166, v82
    v_accvgpr_write_b32 a167, v83
    v_accvgpr_read_b32 v80, a168
    v_accvgpr_read_b32 v81, a169
    v_accvgpr_read_b32 v82, a170
    v_accvgpr_read_b32 v83, a171
    v_mul_f32 v80, v80, v28
    v_mul_f32 v81, v81, v28
    v_mul_f32 v82, v82, v28
    v_mul_f32 v83, v83, v28
    v_accvgpr_write_b32 a168, v80
    v_accvgpr_write_b32 a169, v81
    v_accvgpr_write_b32 a170, v82
    v_accvgpr_write_b32 a171, v83
    v_accvgpr_read_b32 v80, a172
    v_accvgpr_read_b32 v81, a173
    v_accvgpr_read_b32 v82, a174
    v_accvgpr_read_b32 v83, a175
    v_mul_f32 v80, v80, v28
    v_mul_f32 v81, v81, v28
    v_mul_f32 v82, v82, v28
    v_mul_f32 v83, v83, v28
    v_accvgpr_write_b32 a172, v80
    v_accvgpr_write_b32 a173, v81
    v_accvgpr_write_b32 a174, v82
    v_accvgpr_write_b32 a175, v83
    v_accvgpr_read_b32 v80, a176
    v_accvgpr_read_b32 v81, a177
    v_accvgpr_read_b32 v82, a178
    v_accvgpr_read_b32 v83, a179
    v_mul_f32 v80, v80, v28
    v_mul_f32 v81, v81, v28
    v_mul_f32 v82, v82, v28
    v_mul_f32 v83, v83, v28
    v_accvgpr_write_b32 a176, v80
    v_accvgpr_write_b32 a177, v81
    v_accvgpr_write_b32 a178, v82
    v_accvgpr_write_b32 a179, v83
    v_accvgpr_read_b32 v80, a180
    v_accvgpr_read_b32 v81, a181
    v_accvgpr_read_b32 v82, a182
    v_accvgpr_read_b32 v83, a183
    v_mul_f32 v80, v80, v28
    v_mul_f32 v81, v81, v28
    v_mul_f32 v82, v82, v28
    v_mul_f32 v83, v83, v28
    v_accvgpr_write_b32 a180, v80
    v_accvgpr_write_b32 a181, v81
    v_accvgpr_write_b32 a182, v82
    v_accvgpr_write_b32 a183, v83
    v_accvgpr_read_b32 v80, a184
    v_accvgpr_read_b32 v81, a185
    v_accvgpr_read_b32 v82, a186
    v_accvgpr_read_b32 v83, a187
    v_mul_f32 v80, v80, v28
    v_mul_f32 v81, v81, v28
    v_mul_f32 v82, v82, v28
    v_mul_f32 v83, v83, v28
    v_accvgpr_write_b32 a184, v80
    v_accvgpr_write_b32 a185, v81
    v_accvgpr_write_b32 a186, v82
    v_accvgpr_write_b32 a187, v83
    v_accvgpr_read_b32 v80, a188
    v_accvgpr_read_b32 v81, a189
    v_accvgpr_read_b32 v82, a190
    v_accvgpr_read_b32 v83, a191
    v_mul_f32 v80, v80, v28
    v_mul_f32 v81, v81, v28
    v_mul_f32 v82, v82, v28
    v_mul_f32 v83, v83, v28
    v_accvgpr_write_b32 a188, v80
    v_accvgpr_write_b32 a189, v81
    v_accvgpr_write_b32 a190, v82
    v_accvgpr_write_b32 a191, v83
    v_accvgpr_read_b32 v80, a192
    v_accvgpr_read_b32 v81, a193
    v_accvgpr_read_b32 v82, a194
    v_accvgpr_read_b32 v83, a195
    v_mul_f32 v80, v80, v29
    v_mul_f32 v81, v81, v29
    v_mul_f32 v82, v82, v29
    v_mul_f32 v83, v83, v29
    v_accvgpr_write_b32 a192, v80
    v_accvgpr_write_b32 a193, v81
    v_accvgpr_write_b32 a194, v82
    v_accvgpr_write_b32 a195, v83
    v_accvgpr_read_b32 v80, a196
    v_accvgpr_read_b32 v81, a197
    v_accvgpr_read_b32 v82, a198
    v_accvgpr_read_b32 v83, a199
    v_mul_f32 v80, v80, v29
    v_mul_f32 v81, v81, v29
    v_mul_f32 v82, v82, v29
    v_mul_f32 v83, v83, v29
    v_accvgpr_write_b32 a196, v80
    v_accvgpr_write_b32 a197, v81
    v_accvgpr_write_b32 a198, v82
    v_accvgpr_write_b32 a199, v83
    v_accvgpr_read_b32 v80, a200
    v_accvgpr_read_b32 v81, a201
    v_accvgpr_read_b32 v82, a202
    v_accvgpr_read_b32 v83, a203
    v_mul_f32 v80, v80, v29
    v_mul_f32 v81, v81, v29
    v_mul_f32 v82, v82, v29
    v_mul_f32 v83, v83, v29
    v_accvgpr_write_b32 a200, v80
    v_accvgpr_write_b32 a201, v81
    v_accvgpr_write_b32 a202, v82
    v_accvgpr_write_b32 a203, v83
    v_accvgpr_read_b32 v80, a204
    v_accvgpr_read_b32 v81, a205
    v_accvgpr_read_b32 v82, a206
    v_accvgpr_read_b32 v83, a207
    v_mul_f32 v80, v80, v29
    v_mul_f32 v81, v81, v29
    v_mul_f32 v82, v82, v29
    v_mul_f32 v83, v83, v29
    v_accvgpr_write_b32 a204, v80
    v_accvgpr_write_b32 a205, v81
    v_accvgpr_write_b32 a206, v82
    v_accvgpr_write_b32 a207, v83
    v_accvgpr_read_b32 v80, a208
    v_accvgpr_read_b32 v81, a209
    v_accvgpr_read_b32 v82, a210
    v_accvgpr_read_b32 v83, a211
    v_mul_f32 v80, v80, v29
    v_mul_f32 v81, v81, v29
    v_mul_f32 v82, v82, v29
    v_mul_f32 v83, v83, v29
    v_accvgpr_write_b32 a208, v80
    v_accvgpr_write_b32 a209, v81
    v_accvgpr_write_b32 a210, v82
    v_accvgpr_write_b32 a211, v83
    v_accvgpr_read_b32 v80, a212
    v_accvgpr_read_b32 v81, a213
    v_accvgpr_read_b32 v82, a214
    v_accvgpr_read_b32 v83, a215
    v_mul_f32 v80, v80, v29
    v_mul_f32 v81, v81, v29
    v_mul_f32 v82, v82, v29
    v_mul_f32 v83, v83, v29
    v_accvgpr_write_b32 a212, v80
    v_accvgpr_write_b32 a213, v81
    v_accvgpr_write_b32 a214, v82
    v_accvgpr_write_b32 a215, v83
    v_accvgpr_read_b32 v80, a216
    v_accvgpr_read_b32 v81, a217
    v_accvgpr_read_b32 v82, a218
    v_accvgpr_read_b32 v83, a219
    v_mul_f32 v80, v80, v29
    v_mul_f32 v81, v81, v29
    v_mul_f32 v82, v82, v29
    v_mul_f32 v83, v83, v29
    v_accvgpr_write_b32 a216, v80
    v_accvgpr_write_b32 a217, v81
    v_accvgpr_write_b32 a218, v82
    v_accvgpr_write_b32 a219, v83
    v_accvgpr_read_b32 v80, a220
    v_accvgpr_read_b32 v81, a221
    v_accvgpr_read_b32 v82, a222
    v_accvgpr_read_b32 v83, a223
    v_mul_f32 v80, v80, v29
    v_mul_f32 v81, v81, v29
    v_mul_f32 v82, v82, v29
    v_mul_f32 v83, v83, v29
    v_accvgpr_write_b32 a220, v80
    v_accvgpr_write_b32 a221, v81
    v_accvgpr_write_b32 a222, v82
    v_accvgpr_write_b32 a223, v83
    v_accvgpr_read_b32 v80, a224
    v_accvgpr_read_b32 v81, a225
    v_accvgpr_read_b32 v82, a226
    v_accvgpr_read_b32 v83, a227
    v_mul_f32 v80, v80, v29
    v_mul_f32 v81, v81, v29
    v_mul_f32 v82, v82, v29
    v_mul_f32 v83, v83, v29
    v_accvgpr_write_b32 a224, v80
    v_accvgpr_write_b32 a225, v81
    v_accvgpr_write_b32 a226, v82
    v_accvgpr_write_b32 a227, v83
    v_accvgpr_read_b32 v80, a228
    v_accvgpr_read_b32 v81, a229
    v_accvgpr_read_b32 v82, a230
    v_accvgpr_read_b32 v83, a231
    v_mul_f32 v80, v80, v29
    v_mul_f32 v81, v81, v29
    v_mul_f32 v82, v82, v29
    v_mul_f32 v83, v83, v29
    v_accvgpr_write_b32 a228, v80
    v_accvgpr_write_b32 a229, v81
    v_accvgpr_write_b32 a230, v82
    v_accvgpr_write_b32 a231, v83
    v_accvgpr_read_b32 v80, a232
    v_accvgpr_read_b32 v81, a233
    v_accvgpr_read_b32 v82, a234
    v_accvgpr_read_b32 v83, a235
    v_mul_f32 v80, v80, v29
    v_mul_f32 v81, v81, v29
    v_mul_f32 v82, v82, v29
    v_mul_f32 v83, v83, v29
    v_accvgpr_write_b32 a232, v80
    v_accvgpr_write_b32 a233, v81
    v_accvgpr_write_b32 a234, v82
    v_accvgpr_write_b32 a235, v83
    v_accvgpr_read_b32 v80, a236
    v_accvgpr_read_b32 v81, a237
    v_accvgpr_read_b32 v82, a238
    v_accvgpr_read_b32 v83, a239
    v_mul_f32 v80, v80, v29
    v_mul_f32 v81, v81, v29
    v_mul_f32 v82, v82, v29
    v_mul_f32 v83, v83, v29
    v_accvgpr_write_b32 a236, v80
    v_accvgpr_write_b32 a237, v81
    v_accvgpr_write_b32 a238, v82
    v_accvgpr_write_b32 a239, v83
    v_accvgpr_read_b32 v80, a240
    v_accvgpr_read_b32 v81, a241
    v_accvgpr_read_b32 v82, a242
    v_accvgpr_read_b32 v83, a243
    v_mul_f32 v80, v80, v29
    v_mul_f32 v81, v81, v29
    v_mul_f32 v82, v82, v29
    v_mul_f32 v83, v83, v29
    v_accvgpr_write_b32 a240, v80
    v_accvgpr_write_b32 a241, v81
    v_accvgpr_write_b32 a242, v82
    v_accvgpr_write_b32 a243, v83
    v_accvgpr_read_b32 v80, a244
    v_accvgpr_read_b32 v81, a245
    v_accvgpr_read_b32 v82, a246
    v_accvgpr_read_b32 v83, a247
    v_mul_f32 v80, v80, v29
    v_mul_f32 v81, v81, v29
    v_mul_f32 v82, v82, v29
    v_mul_f32 v83, v83, v29
    v_accvgpr_write_b32 a244, v80
    v_accvgpr_write_b32 a245, v81
    v_accvgpr_write_b32 a246, v82
    v_accvgpr_write_b32 a247, v83
    v_accvgpr_read_b32 v80, a248
    v_accvgpr_read_b32 v81, a249
    v_accvgpr_read_b32 v82, a250
    v_accvgpr_read_b32 v83, a251
    v_mul_f32 v80, v80, v29
    v_mul_f32 v81, v81, v29
    v_mul_f32 v82, v82, v29
    v_mul_f32 v83, v83, v29
    v_accvgpr_write_b32 a248, v80
    v_accvgpr_write_b32 a249, v81
    v_accvgpr_write_b32 a250, v82
    v_accvgpr_write_b32 a251, v83
    v_accvgpr_read_b32 v80, a252
    v_accvgpr_read_b32 v81, a253
    v_accvgpr_read_b32 v82, a254
    v_accvgpr_read_b32 v83, a255
    v_mul_f32 v80, v80, v29
    v_mul_f32 v81, v81, v29
    v_mul_f32 v82, v82, v29
    v_mul_f32 v83, v83, v29
    v_accvgpr_write_b32 a252, v80
    v_accvgpr_write_b32 a253, v81
    v_accvgpr_write_b32 a254, v82
    v_accvgpr_write_b32 a255, v83
    v_sub_f32 v64, v64, v18
    v_sub_f32 v96, v96, v18
    v_exp_f32 v80, v64
    v_sub_f32 v65, v65, v18
    v_sub_f32 v97, v97, v18
    v_exp_f32 v81, v65
    v_sub_f32 v66, v66, v18
    v_sub_f32 v98, v98, v18
    v_exp_f32 v82, v66
    v_sub_f32 v67, v67, v18
    v_sub_f32 v99, v99, v18
    v_exp_f32 v83, v67
    v_sub_f32 v68, v68, v18
    v_sub_f32 v100, v100, v18
    v_exp_f32 v84, v68
    v_sub_f32 v69, v69, v18
    v_sub_f32 v101, v101, v18
    v_exp_f32 v85, v69
    v_sub_f32 v70, v70, v18
    v_sub_f32 v102, v102, v18
    v_exp_f32 v86, v70
    v_sub_f32 v71, v71, v18
    v_sub_f32 v103, v103, v18
    v_exp_f32 v87, v71
    v_sub_f32 v72, v72, v19
    v_sub_f32 v104, v104, v19
    v_exp_f32 v88, v72
    v_sub_f32 v73, v73, v19
    v_sub_f32 v105, v105, v19
    v_exp_f32 v89, v73
    v_sub_f32 v74, v74, v19
    v_sub_f32 v106, v106, v19
    v_exp_f32 v90, v74
    v_sub_f32 v75, v75, v19
    v_sub_f32 v107, v107, v19
    v_exp_f32 v91, v75
    v_sub_f32 v76, v76, v19
    v_sub_f32 v108, v108, v19
    v_exp_f32 v92, v76
    v_sub_f32 v77, v77, v19
    v_sub_f32 v109, v109, v19
    v_exp_f32 v93, v77
    v_sub_f32 v78, v78, v19
    v_sub_f32 v110, v110, v19
    v_exp_f32 v94, v78
    v_sub_f32 v79, v79, v19
    v_sub_f32 v111, v111, v19
    v_exp_f32 v95, v79
    v_sub_f32 v20, v20, v18
    v_sub_f32 v21, v21, v19
    s_cmp_eq_u32 s41, 0
    s_cbranch_scc1 L_rA0
    s_branch L_rA1
L_eB0:
    s_mov_b32 s41, 0
    s_branch L_spB
L_eB1:
    s_mov_b32 s41, 1
L_spB:
    v_max3_f32 v18, v64, v65, v66
    v_max3_f32 v19, v72, v73, v74
    v_max3_f32 v18, v18, v67, v68
    v_max3_f32 v19, v19, v75, v76
    v_max3_f32 v18, v18, v69, v70
    v_max3_f32 v19, v19, v77, v78
    v_max_f32 v18, v18, v71
    v_max_f32 v19, v19, v79
    v_mov_b32 v30, v18
    v_mov_b32 v31, v19
    s_nop 1
    v_permlane16_swap_b32 v18, v30
    v_permlane16_swap_b32 v19, v31
    s_nop 1
    v_max_f32 v18, v18, v30
    v_max_f32 v19, v19, v31
    v_mov_b32 v30, v18
    v_mov_b32 v31, v19
    s_nop 1
    v_permlane32_swap_b32 v18, v30
    v_permlane32_swap_b32 v19, v31
    s_nop 1
    v_max_f32 v18, v18, v30
    v_max_f32 v19, v19, v31
    v_max_f32 v18, 0, v18
    v_max_f32 v19, 0, v19
    v_exp_f32 v28, -v18
    v_exp_f32 v29, -v19
    s_nop 0
    v_mul_f32 v10, v10, v28
    v_mul_f32 v14, v14, v29
    v_mul_f32 v128, v128, v28
    v_mul_f32 v129, v129, v28
    v_mul_f32 v130, v130, v28
    v_mul_f32 v131, v131, v28
    v_mul_f32 v132, v132, v28
    v_mul_f32 v133, v133, v28
    v_mul_f32 v134, v134, v28
    v_mul_f32 v135, v135, v28
    v_mul_f32 v136, v136, v28
    v_mul_f32 v137, v137, v28
    v_mul_f32 v138, v138, v28
    v_mul_f32 v139, v139, v28
    v_mul_f32 v140, v140, v28
    v_mul_f32 v141, v141, v28
    v_mul_f32 v142, v142, v28
    v_mul_f32 v143, v143, v28
    v_mul_f32 v144, v144, v28
    v_mul_f32 v145, v145, v28
    v_mul_f32 v146, v146, v28
    v_mul_f32 v147, v147, v28
    v_mul_f32 v148, v148, v28
    v_mul_f32 v149, v149, v28
    v_mul_f32 v150, v150, v28
    v_mul_f32 v151, v151, v28
    v_mul_f32 v152, v152, v28
    v_mul_f32 v153, v153, v28
    v_mul_f32 v154, v154, v28
    v_mul_f32 v155, v155, v28
    v_mul_f32 v156, v156, v28
    v_mul_f32 v157, v157, v28
    v_mul_f32 v158, v158, v28
    v_mul_f32 v159, v159, v28
    v_mul_f32 v160, v160, v28
    v_mul_f32 v161, v161, v28
    v_mul_f32 v162, v162, v28
    v_mul_f32 v163, v163, v28
    v_mul_f32 v164, v164, v28
    v_mul_f32 v165, v165, v28
    v_mul_f32 v166, v166, v28
    v_mul_f32 v167, v167, v28
    v_mul_f32 v168, v168, v28
    v_mul_f32 v169, v169, v28
    v_mul_f32 v170, v170, v28
    v_mul_f32 v171, v171, v28
    v_mul_f32 v172, v172, v28
    v_mul_f32 v173, v173, v28
    v_mul_f32 v174, v174, v28
    v_mul_f32 v175, v175, v28
    v_mul_f32 v176, v176, v28
    v_mul_f32 v177, v177, v28
    v_mul_f32 v178, v178, v28
    v_mul_f32 v179, v179, v28
    v_mul_f32 v180, v180, v28
    v_mul_f32 v181, v181, v28
    v_mul_f32 v182, v182, v28
    v_mul_f32 v183, v183, v28
    v_mul_f32 v184, v184, v28
    v_mul_f32 v185, v185, v28
    v_mul_f32 v186, v186, v28
    v_mul_f32 v187, v187, v28
    v_mul_f32 v188, v188, v28
    v_mul_f32 v189, v189, v28
    v_mul_f32 v190, v190, v28
    v_mul_f32 v191, v191, v28
    v_mul_f32 v192, v192, v29
    v_mul_f32 v193, v193, v29
    v_mul_f32 v194, v194, v29
    v_mul_f32 v195, v195, v29
    v_mul_f32 v196, v196, v29
    v_mul_f32 v197, v197, v29
    v_mul_f32 v198, v198, v29
    v_mul_f32 v199, v199, v29
    v_mul_f32 v200, v200, v29
    v_mul_f32 v201, v201, v29
    v_mul_f32 v202, v202, v29
    v_mul_f32 v203, v203, v29
    v_mul_f32 v204, v204, v29
    v_mul_f32 v205, v205, v29
    v_mul_f32 v206, v206, v29
    v_mul_f32 v207, v207, v29
    v_mul_f32 v208, v208, v29
    v_mul_f32 v209, v209, v29
    v_mul_f32 v210, v210, v29
    v_mul_f32 v211, v211, v29
    v_mul_f32 v212, v212, v29
    v_mul_f32 v213, v213, v29
    v_mul_f32 v214, v214, v29
    v_mul_f32 v215, v215, v29
    v_mul_f32 v216, v216, v29
    v_mul_f32 v217, v217, v29
    v_mul_f32 v218, v218, v29
    v_mul_f32 v219, v219, v29
    v_mul_f32 v220, v220, v29
    v_mul_f32 v221, v221, v29
    v_mul_f32 v222, v222, v29
    v_mul_f32 v223, v223, v29
    v_mul_f32 v224, v224, v29
    v_mul_f32 v225, v225, v29
    v_mul_f32 v226, v226, v29
    v_mul_f32 v227, v227, v29
    v_mul_f32 v228, v228, v29
    v_mul_f32 v229, v229, v29
    v_mul_f32 v230, v230, v29
    v_mul_f32 v231, v231, v29
    v_mul_f32 v232, v232, v29
    v_mul_f32 v233, v233, v29
    v_mul_f32 v234, v234, v29
    v_mul_f32 v235, v235, v29
    v_mul_f32 v236, v236, v29
    v_mul_f32 v237, v237, v29
    v_mul_f32 v238, v238, v29
    v_mul_f32 v239, v239, v29
    v_mul_f32 v240, v240, v29
    v_mul_f32 v241, v241, v29
    v_mul_f32 v242, v242, v29
    v_mul_f32 v243, v243, v29
    v_mul_f32 v244, v244, v29
    v_mul_f32 v245, v245, v29
    v_mul_f32 v246, v246, v29
    v_mul_f32 v247, v247, v29
    v_mul_f32 v248, v248, v29
    v_mul_f32 v249, v249, v29
    v_mul_f32 v250, v250, v29
    v_mul_f32 v251, v251, v29
    v_mul_f32 v252, v252, v29
    v_mul_f32 v253, v253, v29
    v_mul_f32 v254, v254, v29
    v_mul_f32 v255, v255, v29
    v_sub_f32 v64, v64, v18
    v_sub_f32 v96, v96, v18
    v_exp_f32 v80, v64
    v_sub_f32 v65, v65, v18
    v_sub_f32 v97, v97, v18
    v_exp_f32 v81, v65
    v_sub_f32 v66, v66, v18
    v_sub_f32 v98, v98, v18
    v_exp_f32 v82, v66
    v_sub_f32 v67, v67, v18
    v_sub_f32 v99, v99, v18
    v_exp_f32 v83, v67
    v_sub_f32 v68, v68, v18
    v_sub_f32 v100, v100, v18
    v_exp_f32 v84, v68
    v_sub_f32 v69, v69, v18
    v_sub_f32 v101, v101, v18
    v_exp_f32 v85, v69
    v_sub_f32 v70, v70, v18
    v_sub_f32 v102, v102, v18
    v_exp_f32 v86, v70
    v_sub_f32 v71, v71, v18
    v_sub_f32 v103, v103, v18
    v_exp_f32 v87, v71
    v_sub_f32 v72, v72, v19
    v_sub_f32 v104, v104, v19
    v_exp_f32 v88, v72
    v_sub_f32 v73, v73, v19
    v_sub_f32 v105, v105, v19
    v_exp_f32 v89, v73
    v_sub_f32 v74, v74, v19
    v_sub_f32 v106, v106, v19
    v_exp_f32 v90, v74
    v_sub_f32 v75, v75, v19
    v_sub_f32 v107, v107, v19
    v_exp_f32 v91, v75
    v_sub_f32 v76, v76, v19
    v_sub_f32 v108, v108, v19
    v_exp_f32 v92, v76
    v_sub_f32 v77, v77, v19
    v_sub_f32 v109, v109, v19
    v_exp_f32 v93, v77
    v_sub_f32 v78, v78, v19
    v_sub_f32 v110, v110, v19
    v_exp_f32 v94, v78
    v_sub_f32 v79, v79, v19
    v_sub_f32 v111, v111, v19
    v_exp_f32 v95, v79
    v_sub_f32 v20, v20, v18
    v_sub_f32 v21, v21, v19
    s_cmp_eq_u32 s41, 0
    s_cbranch_scc1 L_rB0
    s_branch L_rB1
L_eFA:
    s_mov_b32 s41, 0
    s_branch L_spF
L_eFB:
    s_mov_b32 s41, 1
L_spF:
    v_max3_f32 v18, v64, v65, v66
    v_max3_f32 v19, v72, v73, v74
    v_max3_f32 v18, v18, v67, v68
    v_max3_f32 v19, v19, v75, v76
    v_max3_f32 v18, v18, v69, v70
    v_max3_f32 v19, v19, v77, v78
    v_max_f32 v18, v18, v71
    v_max_f32 v19, v19, v79
    v_mov_b32 v30, v18
    v_mov_b32 v31, v19
    s_nop 1
    v_permlane16_swap_b32 v18, v30
    v_permlane16_swap_b32 v19, v31
    s_nop 1
    v_max_f32 v18, v18, v30
    v_max_f32 v19, v19, v31
    v_mov_b32 v30, v18
    v_mov_b32 v31, v19
    s_nop 1
    v_permlane32_swap_b32 v18, v30
    v_permlane32_swap_b32 v19, v31
    s_nop 1
    v_max_f32 v18, v18, v30
    v_max_f32 v19, v19, v31
    v_sub_f32 v64, v64, v18
    v_sub_f32 v96, v96, v18
    v_exp_f32 v80, v64
    v_sub_f32 v65, v65, v18
    v_sub_f32 v97, v97, v18
    v_exp_f32 v81, v65
    v_sub_f32 v66, v66, v18
    v_sub_f32 v98, v98, v18
    v_exp_f32 v82, v66
    v_sub_f32 v67, v67, v18
    v_sub_f32 v99, v99, v18
    v_exp_f32 v83, v67
    v_sub_f32 v68, v68, v18
    v_sub_f32 v100, v100, v18
    v_exp_f32 v84, v68
    v_sub_f32 v69, v69, v18
    v_sub_f32 v101, v101, v18
    v_exp_f32 v85, v69
    v_sub_f32 v70, v70, v18
    v_sub_f32 v102, v102, v18
    v_exp_f32 v86, v70
    v_sub_f32 v71, v71, v18
    v_sub_f32 v103, v103, v18
    v_exp_f32 v87, v71
    v_sub_f32 v72, v72, v19
    v_sub_f32 v104, v104, v19
    v_exp_f32 v88, v72
    v_sub_f32 v73, v73, v19
    v_sub_f32 v105, v105, v19
    v_exp_f32 v89, v73
    v_sub_f32 v74, v74, v19
    v_sub_f32 v106, v106, v19
    v_exp_f32 v90, v74
    v_sub_f32 v75, v75, v19
    v_sub_f32 v107, v107, v19
    v_exp_f32 v91, v75
    v_sub_f32 v76, v76, v19
    v_sub_f32 v108, v108, v19
    v_exp_f32 v92, v76
    v_sub_f32 v77, v77, v19
    v_sub_f32 v109, v109, v19
    v_exp_f32 v93, v77
    v_sub_f32 v78, v78, v19
    v_sub_f32 v110, v110, v19
    v_exp_f32 v94, v78
    v_sub_f32 v79, v79, v19
    v_sub_f32 v111, v111, v19
    v_exp_f32 v95, v79
    v_sub_f32 v20, v20, v18
    v_sub_f32 v21, v21, v19
    s_cmp_eq_u32 s41, 0
    s_cbranch_scc1 L_segA
    s_branch L_segB
L_segB:
    s_cmp_eq_u32 s43, 0
    s_cbranch_scc1 L_tail
    s_cmp_eq_u32 s43, 2
    s_cbranch_scc1 L_coldB0
    s_sub_u32 s43, s43, 2
    s_sub_i32 s48, s48, s43
    s_sub_u32 s43, s43, 1
    s_waitcnt lgkmcnt(4)
    v_mfma_f32_16x16x32_bf16 v[64:67], v[32:35], a[64:67], v[96:99]
.p2align 3
L_hotB:
    s_add_u32 m0, m0, 4096
    v_mfma_f32_16x16x32_bf16 v[64:67], v[36:39], a[68:71], v[64:67]
    v_cvt_pk_bf16_f32 v112, v80, v81
    v_cvt_pk_bf16_f32 v113, v82, v83
    v_mfma_f32_16x16x32_bf16 v[72:75], v[36:39], a[100:103], v[104:107]
    buffer_load_dwordx4 v26, s[4:7], s39 offen offset:0 sc1 lds
    v_mfma_f32_16x16x32_bf16 v[72:75], v[32:35], a[96:99], v[72:75]
    ds_read_b128 v[32:35], v25 offset:8192
    v_mfma_f32_16x16x32_bf16 v[72:75], v[40:43], a[104:107], v[72:75]
    s_add_u32 s42, s35, 32768
    ds_read_b128 v[36:39], v25 offset:9216
    v_mfma_f32_16x16x32_bf16 v[72:75], v[44:47], a[108:111], v[72:75]
    v_cvt_pk_bf16_f32 v116, v88, v89
    v_cvt_pk_bf16_f32 v117, v90, v91
    v_mfma_f32_16x16x32_bf16 v[64:67], v[44:47], a[76:79], v[64:67]
    buffer_load_dwordx4 v26, s[4:7], s39 offen offset:1024 sc1 lds
    v_mfma_f32_16x16x32_bf16 v[64:67], v[40:43], a[72:75], v[64:67]
    ds_read_b128 v[40:43], v25 offset:10240
    s_waitcnt lgkmcnt(3)
    v_mfma_f32_16x16x32_bf16 v[64:67], v[48:51], a[80:83], v[64:67]
    s_cmp_eq_u32 s42, s37
    ds_read_b128 v[44:47], v25 offset:11264
    v_mfma_f32_16x16x32_bf16 v[64:67], v[52:55], a[84:87], v[64:67]
    v_cvt_pk_bf16_f32 v114, v84, v85
    v_cvt_pk_bf16_f32 v115, v86, v87
    v_mfma_f32_16x16x32_bf16 v[72:75], v[52:55], a[116:119], v[72:75]
    buffer_load_dwordx4 v26, s[4:7], s39 offen offset:2048 sc1 lds
    v_mfma_f32_16x16x32_bf16 v[72:75], v[48:51], a[112:115], v[72:75]
    s_cselect_b32 s42, 0, s42
    ds_read_b128 v[48:51], v25 offset:12288
    v_mfma_f32_16x16x32_bf16 v[72:75], v[56:59], a[120:123], v[72:75]
    ds_read_b128 v[52:55], v25 offset:13312
    v_mfma_f32_16x16x32_bf16 v[72:75], v[60:63], a[124:127], v[72:75]
    v_cvt_pk_bf16_f32 v118, v92, v93
    v_cvt_pk_bf16_f32 v119, v94, v95
    v_mfma_f32_16x16x32_bf16 v[64:67], v[60:63], a[92:95], v[64:67]
    buffer_load_dwordx4 v26, s[4:7], s39 offen offset:3072 sc1 lds
    v_mfma_f32_16x16x32_bf16 v[64:67], v[56:59], a[88:91], v[64:67]
    ds_read_b128 v[56:59], v25 offset:14336
    s_waitcnt lgkmcnt(3)
    v_mfma_f32_16x16x32_bf16 v[68:71], v[32:35], a[64:67], v[100:103]
    s_add_u32 m0, s31, s34
    ds_read_b128 v[60:63], v25 offset:15360
    v_mfma_f32_16x16x32_bf16 v[68:71], v[36:39], a[68:71], v[68:71]
    s_waitcnt vmcnt(16)
    s_barrier
    v_mfma_f32_16x16x32_bf16 v[76:79], v[36:39], a[100:103], v[108:111]
    buffer_load_dwordx4 v27, s[4:7], s38 offen offset:0 sc1 lds
    v_mfma_f32_16x16x32_bf16 v[76:79], v[32:35], a[96:99], v[76:79]
    v_add_u32 v25, s42, v23
    ds_read_b128 v[32:35], v25 offset:0
    v_mfma_f32_16x16x32_bf16 v[76:79], v[40:43], a[104:107], v[76:79]
    s_mov_b32 s34, s42
    ds_read_b128 v[36:39], v25 offset:1024
    v_mfma_f32_16x16x32_bf16 v[76:79], v[44:47], a[108:111], v[76:79]
    v_exp_f32 v80, v64
    v_mfma_f32_16x16x32_bf16 v[68:71], v[44:47], a[76:79], v[68:71]
    buffer_load_dwordx4 v27, s[4:7], s38 offen offset:1024 sc1 lds
    v_mfma_f32_16x16x32_bf16 v[68:71], v[40:43], a[72:75], v[68:71]
    ds_read_b128 v[40:43], v25 offset:2048
    s_waitcnt lgkmcnt(3)
    v_mfma_f32_16x16x32_bf16 v[68:71], v[48:51], a[80:83], v[68:71]
    ds_read_b128 v[44:47], v25 offset:3072
    s_add_u32 s39, s39, 32768
    v_mfma_f32_16x16x32_bf16 v[68:71], v[52:55], a[84:87], v[68:71]
    v_exp_f32 v81, v65
    v_mfma_f32_16x16x32_bf16 v[76:79], v[52:55], a[116:119], v[76:79]
    buffer_load_dwordx4 v27, s[4:7], s38 offen offset:2048 sc1 lds
    v_mfma_f32_16x16x32_bf16 v[76:79], v[48:51], a[112:115], v[76:79]
    ds_read_b128 v[48:51], v25 offset:4096
    v_exp_f32 v82, v66
    v_mfma_f32_16x16x32_bf16 v[76:79], v[56:59], a[120:123], v[76:79]
    ds_read_b128 v[52:55], v25 offset:5120
    v_exp_f32 v83, v67
    v_mfma_f32_16x16x32_bf16 v[76:79], v[60:63], a[124:127], v[76:79]
    v_exp_f32 v88, v72
    v_mfma_f32_16x16x32_bf16 v[68:71], v[60:63], a[92:95], v[68:71]
    buffer_load_dwordx4 v27, s[4:7], s38 offen offset:3072 sc1 lds
    v_mfma_f32_16x16x32_bf16 v[68:71], v[56:59], a[88:91], v[68:71]
    ds_read_b128 v[56:59], v25 offset:6144
    ds_read_b128 v[60:63], v25 offset:7168
    s_waitcnt lgkmcnt(4)
    v_mfma_f32_16x16x32_bf16 v[128:131], v[32:35], v[112:115], v[128:131]
    s_add_u32 m0, m0, 4096
    v_max3_f32 v30, v64, v65, v66
    v_mfma_f32_16x16x32_bf16 v[192:195], v[32:35], v[116:119], v[192:195]
    v_exp_f32 v89, v73
    v_mfma_f32_16x16x32_bf16 v[196:199], v[36:39], v[116:119], v[196:199]
    buffer_load_dwordx4 v26, s[4:7], s38 offen offset:0 sc1 lds
    v_max3_f32 v30, v30, v67, v72
    v_mfma_f32_16x16x32_bf16 v[132:135], v[36:39], v[112:115], v[132:135]
    ds_read_b128 v[32:35], v25 offset:8192
    v_exp_f32 v90, v74
    v_mfma_f32_16x16x32_bf16 v[136:139], v[40:43], v[112:115], v[136:139]
    s_add_u32 s42, s34, 32768
    ds_read_b128 v[36:39], v25 offset:9216
    v_mfma_f32_16x16x32_bf16 v[200:203], v[40:43], v[116:119], v[200:203]
    v_exp_f32 v91, v75
    v_mfma_f32_16x16x32_bf16 v[204:207], v[44:47], v[116:119], v[204:207]
    buffer_load_dwordx4 v26, s[4:7], s38 offen offset:1024 sc1 lds
    v_max3_f32 v30, v30, v73, v74
    v_mfma_f32_16x16x32_bf16 v[140:143], v[44:47], v[112:115], v[140:143]
    ds_read_b128 v[40:43], v25 offset:10240
    s_waitcnt lgkmcnt(3)
    v_mfma_f32_16x16x32_bf16 v[144:147], v[48:51], v[112:115], v[144:147]
    s_cmp_eq_u32 s42, s37
    ds_read_b128 v[44:47], v25 offset:11264
    v_mfma_f32_16x16x32_bf16 v[208:211], v[48:51], v[116:119], v[208:211]
    v_exp_f32 v84, v68
    v_mfma_f32_16x16x32_bf16 v[212:215], v[52:55], v[116:119], v[212:215]
    buffer_load_dwordx4 v26, s[4:7], s38 offen offset:2048 sc1 lds
    v_max3_f32 v30, v30, v75, v68
    v_mfma_f32_16x16x32_bf16 v[148:151], v[52:55], v[112:115], v[148:151]
    s_cselect_b32 s42, 0, s42
    ds_read_b128 v[48:51], v25 offset:12288
    v_mfma_f32_16x16x32_bf16 v[152:155], v[56:59], v[112:115], v[152:155]
    ds_read_b128 v[52:55], v25 offset:13312
    v_exp_f32 v85, v69
    v_mfma_f32_16x16x32_bf16 v[216:219], v[56:59], v[116:119], v[216:219]
    v_exp_f32 v86, v70
    v_mfma_f32_16x16x32_bf16 v[220:223], v[60:63], v[116:119], v[220:223]
    buffer_load_dwordx4 v26, s[4:7], s38 offen offset:3072 sc1 lds
    v_max3_f32 v30, v30, v69, v70
    v_mfma_f32_16x16x32_bf16 v[156:159], v[60:63], v[112:115], v[156:159]
    ds_read_b128 v[56:59], v25 offset:14336
    s_waitcnt lgkmcnt(3)
    v_mfma_f32_16x16x32_bf16 v[160:163], v[32:35], v[112:115], v[160:163]
    s_add_u32 m0, s31, s35
    ds_read_b128 v[60:63], v25 offset:15360
    v_mfma_f32_16x16x32_bf16 v[224:227], v[32:35], v[116:119], v[224:227]
    s_waitcnt vmcnt(16)
    s_barrier
    v_mfma_f32_16x16x32_bf16 v[228:231], v[36:39], v[116:119], v[228:231]
    buffer_load_dwordx4 v27, s[4:7], s39 offen offset:0 sc1 lds
    v_max3_f32 v30, v30, v71, v76
    v_mfma_f32_16x16x32_bf16 v[164:167], v[36:39], v[112:115], v[164:167]
    v_add_u32 v25, s42, v23
    ds_read_b128 v[32:35], v25 offset:0
    v_mfma_f32_16x16x32_bf16 v[168:171], v[40:43], v[112:115], v[168:171]
    s_mov_b32 s35, s42
    ds_read_b128 v[36:39], v25 offset:1024
    v_mfma_f32_16x16x32_bf16 v[232:235], v[40:43], v[116:119], v[232:235]
    v_exp_f32 v87, v71
    v_mfma_f32_16x16x32_bf16 v[236:239], v[44:47], v[116:119], v[236:239]
    buffer_load_dwordx4 v27, s[4:7], s39 offen offset:1024 sc1 lds
    v_max3_f32 v30, v30, v77, v78
    v_mfma_f32_16x16x32_bf16 v[172:175], v[44:47], v[112:115], v[172:175]
    ds_read_b128 v[40:43], v25 offset:2048
    s_waitcnt lgkmcnt(3)
    v_mfma_f32_16x16x32_bf16 v[176:179], v[48:51], v[112:115], v[176:179]
    ds_read_b128 v[44:47], v25 offset:3072
    s_add_u32 s38, s38, 32768
    v_mfma_f32_16x16x32_bf16 v[240:243], v[48:51], v[116:119], v[240:243]
    v_exp_f32 v92, v76
    v_mfma_f32_16x16x32_bf16 v[244:247], v[52:55], v[116:119], v[244:247]
    buffer_load_dwordx4 v27, s[4:7], s39 offen offset:2048 sc1 lds
    v_max_f32 v30, v30, v79
    v_mfma_f32_16x16x32_bf16 v[180:183], v[52:55], v[112:115], v[180:183]
    ds_read_b128 v[48:51], v25 offset:4096
    v_exp_f32 v93, v77
    v_mfma_f32_16x16x32_bf16 v[184:187], v[56:59], v[112:115], v[184:187]
    ds_read_b128 v[52:55], v25 offset:5120
    v_exp_f32 v94, v78
    v_mfma_f32_16x16x32_bf16 v[248:251], v[56:59], v[116:119], v[248:251]
    v_exp_f32 v95, v79
    v_mfma_f32_16x16x32_bf16 v[252:255], v[60:63], v[116:119], v[252:255]
    buffer_load_dwordx4 v27, s[4:7], s39 offen offset:3072 sc1 lds
    v_mfma_f32_16x16x32_bf16 v[188:191], v[60:63], v[112:115], v[188:191]
    ds_read_b128 v[56:59], v25 offset:6144
    v_cmp_lt_f32 vcc, 0x41000000, v30
    v_mfma_f32_16x16x32_bf16 v[10:13], v[120:123], v[112:115], v[10:13]
    ds_read_b128 v[60:63], v25 offset:7168
    v_mfma_f32_16x16x32_bf16 v[14:17], v[120:123], v[116:119], v[14:17]
    s_cbranch_vccnz L_eB0
L_rB0:
    s_sub_u32 s43, s43, 1
    s_waitcnt lgkmcnt(4)
    v_mfma_f32_16x16x32_bf16 v[64:67], v[32:35], a[64:67], v[96:99]
    s_cbranch_scc0 L_hotB
L_coldB0:
    s_mov_b32 s43, 1
L_coldB:
    s_sub_i32 s48, s48, 1
    s_cmp_le_i32 s48, 0
    s_cbranch_scc0 L_pm3
    s_lshl_b32 s40, s48, 5
    v_add_u32 v31, s40, v22
    v_mov_b32 v24, 0xf149f2ca
    s_nop 3
    v_cmp_gt_i32 s[60:61], 0, v31
    v_cmp_gt_i32 s[62:63], 1, v31
    v_cmp_gt_i32 s[96:97], 2, v31
    v_cmp_gt_i32 s[98:99], 3, v31
    v_cndmask_b32 v96, v96, v24, s[60:61]
    v_cndmask_b32 v97, v97, v24, s[62:63]
    v_cndmask_b32 v98, v98, v24, s[96:97]
    v_cndmask_b32 v99, v99, v24, s[98:99]
    v_cmp_gt_i32 s[60:61], 16, v31
    v_cmp_gt_i32 s[62:63], 17, v31
    v_cmp_gt_i32 s[96:97], 18, v31
    v_cmp_gt_i32 s[98:99], 19, v31
    v_cndmask_b32 v100, v100, v24, s[60:61]
    v_cndmask_b32 v101, v101, v24, s[62:63]
    v_cndmask_b32 v102, v102, v24, s[96:97]
    v_cndmask_b32 v103, v103, v24, s[98:99]
    v_cmp_gt_i32 s[60:61], -16, v31
    v_cmp_gt_i32 s[62:63], -15, v31
    v_cmp_gt_i32 s[96:97], -14, v31
    v_cmp_gt_i32 s[98:99], -13, v31
    v_cndmask_b32 v104, v104, v24, s[60:61]
    v_cndmask_b32 v105, v105, v24, s[62:63]
    v_cndmask_b32 v106, v106, v24, s[96:97]
    v_cndmask_b32 v107, v107, v24, s[98:99]
    v_cmp_gt_i32 s[60:61], 0, v31
    v_cmp_gt_i32 s[62:63], 1, v31
    v_cmp_gt_i32 s[96:97], 2, v31
    v_cmp_gt_i32 s[98:99], 3, v31
    v_cndmask_b32 v108, v108, v24, s[60:61]
    v_cndmask_b32 v109, v109, v24, s[62:63]
    v_cndmask_b32 v110, v110, v24, s[96:97]
    v_cndmask_b32 v111, v111, v24, s[98:99]
    s_nop 1
L_pm3:
    s_waitcnt lgkmcnt(4)
    v_mfma_f32_16x16x32_bf16 v[64:67], v[32:35], a[64:67], v[96:99]
    s_add_u32 m0, m0, 4096
    v_mfma_f32_16x16x32_bf16 v[64:67], v[36:39], a[68:71], v[64:67]
    v_cvt_pk_bf16_f32 v112, v80, v81
    v_cvt_pk_bf16_f32 v113, v82, v83
    v_mfma_f32_16x16x32_bf16 v[72:75], v[36:39], a[100:103], v[104:107]
    buffer_load_dwordx4 v26, s[4:7], s39 offen offset:0 sc1 lds
    v_mfma_f32_16x16x32_bf16 v[72:75], v[32:35], a[96:99], v[72:75]
    ds_read_b128 v[32:35], v25 offset:8192
    v_mfma_f32_16x16x32_bf16 v[72:75], v[40:43], a[104:107], v[72:75]
    s_add_u32 s42, s35, 32768
    ds_read_b128 v[36:39], v25 offset:9216
    v_mfma_f32_16x16x32_bf16 v[72:75], v[44:47], a[108:111], v[72:75]
    v_cvt_pk_bf16_f32 v116, v88, v89
    v_cvt_pk_bf16_f32 v117, v90, v91
    v_mfma_f32_16x16x32_bf16 v[64:67], v[44:47], a[76:79], v[64:67]
    buffer_load_dwordx4 v26, s[4:7], s39 offen offset:1024 sc1 lds
    v_mfma_f32_16x16x32_bf16 v[64:67], v[40:43], a[72:75], v[64:67]
    ds_read_b128 v[40:43], v25 offset:10240
    s_waitcnt lgkmcnt(3)
    v_mfma_f32_16x16x32_bf16 v[64:67], v[48:51], a[80:83], v[64:67]
    s_cmp_eq_u32 s42, s37
    ds_read_b128 v[44:47], v25 offset:11264
    v_mfma_f32_16x16x32_bf16 v[64:67], v[52:55], a[84:87], v[64:67]
    v_cvt_pk_bf16_f32 v114, v84, v85
    v_cvt_pk_bf16_f32 v115, v86, v87
    v_mfma_f32_16x16x32_bf16 v[72:75], v[52:55], a[116:119], v[72:75]
    buffer_load_dwordx4 v26, s[4:7], s39 offen offset:2048 sc1 lds
    v_mfma_f32_16x16x32_bf16 v[72:75], v[48:51], a[112:115], v[72:75]
    s_cselect_b32 s42, 0, s42
    ds_read_b128 v[48:51], v25 offset:12288
    v_mfma_f32_16x16x32_bf16 v[72:75], v[56:59], a[120:123], v[72:75]
    ds_read_b128 v[52:55], v25 offset:13312
    v_mfma_f32_16x16x32_bf16 v[72:75], v[60:63], a[124:127], v[72:75]
    v_cvt_pk_bf16_f32 v118, v92, v93
    v_cvt_pk_bf16_f32 v119, v94, v95
    v_mfma_f32_16x16x32_bf16 v[64:67], v[60:63], a[92:95], v[64:67]
    buffer_load_dwordx4 v26, s[4:7], s39 offen offset:3072 sc1 lds
    v_mfma_f32_16x16x32_bf16 v[64:67], v[56:59], a[88:91], v[64:67]
    ds_read_b128 v[56:59], v25 offset:14336
    s_waitcnt lgkmcnt(3)
    v_mfma_f32_16x16x32_bf16 v[68:71], v[32:35], a[64:67], v[100:103]
    s_add_u32 m0, s31, s34
    ds_read_b128 v[60:63], v25 offset:15360
    v_mfma_f32_16x16x32_bf16 v[68:71], v[36:39], a[68:71], v[68:71]
    s_waitcnt vmcnt(16)
    s_barrier
    v_mfma_f32_16x16x32_bf16 v[76:79], v[36:39], a[100:103], v[108:111]
    buffer_load_dwordx4 v27, s[4:7], s38 offen offset:0 sc1 lds
    v_mfma_f32_16x16x32_bf16 v[76:79], v[32:35], a[96:99], v[76:79]
    v_add_u32 v25, s42, v23
    ds_read_b128 v[32:35], v25 offset:0
    v_mfma_f32_16x16x32_bf16 v[76:79], v[40:43], a[104:107], v[76:79]
    s_mov_b32 s34, s42
    ds_read_b128 v[36:39], v25 offset:1024
    v_mfma_f32_16x16x32_bf16 v[76:79], v[44:47], a[108:111], v[76:79]
    v_exp_f32 v80, v64
    v_mfma_f32_16x16x32_bf16 v[68:71], v[44:47], a[76:79], v[68:71]
    buffer_load_dwordx4 v27, s[4:7], s38 offen offset:1024 sc1 lds
    v_mfma_f32_16x16x32_bf16 v[68:71], v[40:43], a[72:75], v[68:71]
    ds_read_b128 v[40:43], v25 offset:2048
    s_waitcnt lgkmcnt(3)
    v_mfma_f32_16x16x32_bf16 v[68:71], v[48:51], a[80:83], v[68:71]
    ds_read_b128 v[44:47], v25 offset:3072
    s_add_u32 s39, s39, 32768
    s_cmp_eq_u32 s39, s45
    s_cselect_b32 s39, s47, s39
    v_mfma_f32_16x16x32_bf16 v[68:71], v[52:55], a[84:87], v[68:71]
    v_exp_f32 v81, v65
    v_mfma_f32_16x16x32_bf16 v[76:79], v[52:55], a[116:119], v[76:79]
    buffer_load_dwordx4 v27, s[4:7], s38 offen offset:2048 sc1 lds
    v_mfma_f32_16x16x32_bf16 v[76:79], v[48:51], a[112:115], v[76:79]
    ds_read_b128 v[48:51], v25 offset:4096
    v_exp_f32 v82, v66
    v_mfma_f32_16x16x32_bf16 v[76:79], v[56:59], a[120:123], v[76:79]
    ds_read_b128 v[52:55], v25 offset:5120
    v_exp_f32 v83, v67
    v_mfma_f32_16x16x32_bf16 v[76:79], v[60:63], a[124:127], v[76:79]
    v_exp_f32 v88, v72
    v_mfma_f32_16x16x32_bf16 v[68:71], v[60:63], a[92:95], v[68:71]
    buffer_load_dwordx4 v27, s[4:7], s38 offen offset:3072 sc1 lds
    v_mfma_f32_16x16x32_bf16 v[68:71], v[56:59], a[88:91], v[68:71]
    ds_read_b128 v[56:59], v25 offset:6144
    ds_read_b128 v[60:63], v25 offset:7168
    s_waitcnt lgkmcnt(4)
    v_mfma_f32_16x16x32_bf16 v[128:131], v[32:35], v[112:115], v[128:131]
    s_add_u32 m0, m0, 4096
    v_max3_f32 v30, v64, v65, v66
    v_mfma_f32_16x16x32_bf16 v[192:195], v[32:35], v[116:119], v[192:195]
    v_exp_f32 v89, v73
    v_mfma_f32_16x16x32_bf16 v[196:199], v[36:39], v[116:119], v[196:199]
    buffer_load_dwordx4 v26, s[4:7], s38 offen offset:0 sc1 lds
    v_max3_f32 v30, v30, v67, v72
    v_mfma_f32_16x16x32_bf16 v[132:135], v[36:39], v[112:115], v[132:135]
    ds_read_b128 v[32:35], v25 offset:8192
    v_exp_f32 v90, v74
    v_mfma_f32_16x16x32_bf16 v[136:139], v[40:43], v[112:115], v[136:139]
    s_add_u32 s42, s34, 32768
    ds_read_b128 v[36:39], v25 offset:9216
    v_mfma_f32_16x16x32_bf16 v[200:203], v[40:43], v[116:119], v[200:203]
    v_exp_f32 v91, v75
    v_mfma_f32_16x16x32_bf16 v[204:207], v[44:47], v[116:119], v[204:207]
    buffer_load_dwordx4 v26, s[4:7], s38 offen offset:1024 sc1 lds
    v_max3_f32 v30, v30, v73, v74
    v_mfma_f32_16x16x32_bf16 v[140:143], v[44:47], v[112:115], v[140:143]
    ds_read_b128 v[40:43], v25 offset:10240
    s_waitcnt lgkmcnt(3)
    v_mfma_f32_16x16x32_bf16 v[144:147], v[48:51], v[112:115], v[144:147]
    s_cmp_eq_u32 s42, s37
    ds_read_b128 v[44:47], v25 offset:11264
    v_mfma_f32_16x16x32_bf16 v[208:211], v[48:51], v[116:119], v[208:211]
    v_exp_f32 v84, v68
    v_mfma_f32_16x16x32_bf16 v[212:215], v[52:55], v[116:119], v[212:215]
    buffer_load_dwordx4 v26, s[4:7], s38 offen offset:2048 sc1 lds
    v_max3_f32 v30, v30, v75, v68
    v_mfma_f32_16x16x32_bf16 v[148:151], v[52:55], v[112:115], v[148:151]
    s_cselect_b32 s42, 0, s42
    ds_read_b128 v[48:51], v25 offset:12288
    v_mfma_f32_16x16x32_bf16 v[152:155], v[56:59], v[112:115], v[152:155]
    ds_read_b128 v[52:55], v25 offset:13312
    v_exp_f32 v85, v69
    v_mfma_f32_16x16x32_bf16 v[216:219], v[56:59], v[116:119], v[216:219]
    v_exp_f32 v86, v70
    v_mfma_f32_16x16x32_bf16 v[220:223], v[60:63], v[116:119], v[220:223]
    buffer_load_dwordx4 v26, s[4:7], s38 offen offset:3072 sc1 lds
    v_max3_f32 v30, v30, v69, v70
    v_mfma_f32_16x16x32_bf16 v[156:159], v[60:63], v[112:115], v[156:159]
    ds_read_b128 v[56:59], v25 offset:14336
    s_waitcnt lgkmcnt(3)
    v_mfma_f32_16x16x32_bf16 v[160:163], v[32:35], v[112:115], v[160:163]
    s_add_u32 m0, s31, s35
    ds_read_b128 v[60:63], v25 offset:15360
    v_mfma_f32_16x16x32_bf16 v[224:227], v[32:35], v[116:119], v[224:227]
    s_waitcnt vmcnt(16)
    s_barrier
    v_mfma_f32_16x16x32_bf16 v[228:231], v[36:39], v[116:119], v[228:231]
    buffer_load_dwordx4 v27, s[4:7], s39 offen offset:0 sc1 lds
    v_max3_f32 v30, v30, v71, v76
    v_mfma_f32_16x16x32_bf16 v[164:167], v[36:39], v[112:115], v[164:167]
    v_add_u32 v25, s42, v23
    ds_read_b128 v[32:35], v25 offset:0
    v_mfma_f32_16x16x32_bf16 v[168:171], v[40:43], v[112:115], v[168:171]
    s_mov_b32 s35, s42
    ds_read_b128 v[36:39], v25 offset:1024
    v_mfma_f32_16x16x32_bf16 v[232:235], v[40:43], v[116:119], v[232:235]
    v_exp_f32 v87, v71
    v_mfma_f32_16x16x32_bf16 v[236:239], v[44:47], v[116:119], v[236:239]
    buffer_load_dwordx4 v27, s[4:7], s39 offen offset:1024 sc1 lds
    v_max3_f32 v30, v30, v77, v78
    v_mfma_f32_16x16x32_bf16 v[172:175], v[44:47], v[112:115], v[172:175]
    ds_read_b128 v[40:43], v25 offset:2048
    s_waitcnt lgkmcnt(3)
    v_mfma_f32_16x16x32_bf16 v[176:179], v[48:51], v[112:115], v[176:179]
    ds_read_b128 v[44:47], v25 offset:3072
    s_add_u32 s38, s38, 32768
    s_cmp_eq_u32 s38, s44
    s_cselect_b32 s38, s46, s38
    v_mfma_f32_16x16x32_bf16 v[240:243], v[48:51], v[116:119], v[240:243]
    v_exp_f32 v92, v76
    v_mfma_f32_16x16x32_bf16 v[244:247], v[52:55], v[116:119], v[244:247]
    buffer_load_dwordx4 v27, s[4:7], s39 offen offset:2048 sc1 lds
    v_max_f32 v30, v30, v79
    v_mfma_f32_16x16x32_bf16 v[180:183], v[52:55], v[112:115], v[180:183]
    ds_read_b128 v[48:51], v25 offset:4096
    v_exp_f32 v93, v77
    v_mfma_f32_16x16x32_bf16 v[184:187], v[56:59], v[112:115], v[184:187]
    ds_read_b128 v[52:55], v25 offset:5120
    v_exp_f32 v94, v78
    v_mfma_f32_16x16x32_bf16 v[248:251], v[56:59], v[116:119], v[248:251]
    v_exp_f32 v95, v79
    v_mfma_f32_16x16x32_bf16 v[252:255], v[60:63], v[116:119], v[252:255]
    buffer_load_dwordx4 v27, s[4:7], s39 offen offset:3072 sc1 lds
    v_mfma_f32_16x16x32_bf16 v[188:191], v[60:63], v[112:115], v[188:191]
    ds_read_b128 v[56:59], v25 offset:6144
    v_cmp_lt_f32 vcc, 0x41000000, v30
    v_mfma_f32_16x16x32_bf16 v[10:13], v[120:123], v[112:115], v[10:13]
    ds_read_b128 v[60:63], v25 offset:7168
    v_mfma_f32_16x16x32_bf16 v[14:17], v[120:123], v[116:119], v[14:17]
    s_cbranch_vccnz L_eB1
L_rB1:
    s_sub_u32 s43, s43, 1
    s_cbranch_scc0 L_coldB
L_tail:
    v_cvt_pk_bf16_f32 v112, v80, v81
    v_cvt_pk_bf16_f32 v113, v82, v83
    v_cvt_pk_bf16_f32 v116, v88, v89
    v_cvt_pk_bf16_f32 v117, v90, v91
    v_cvt_pk_bf16_f32 v114, v84, v85
    v_cvt_pk_bf16_f32 v115, v86, v87
    v_cvt_pk_bf16_f32 v118, v92, v93
    v_cvt_pk_bf16_f32 v119, v94, v95
    s_nop 1
    v_mfma_f32_16x16x32_bf16 v[10:13], v[120:123], v[112:115], v[10:13]
    v_mfma_f32_16x16x32_bf16 v[14:17], v[120:123], v[116:119], v[14:17]
    v_lshrrev_b32 v30, 3, v1
    v_and_b32 v31, 6, v30
    v_mul_u32_u24 v30, 896, v30
    v_and_b32 v24, 7, v1
    v_xor_b32 v31, v31, v24
    v_lshl_add_u32 v124, v31, 4, v30
    v_add_u32 v125, 6144, v124
    v_add_u32 v126, 12288, v124
    v_add_u32 v127, 18432, v124
    s_mov_b32 s8, s88
    s_and_b32 s9, s89, 0xffff
    s_mov_b32 s10, 3670016
    s_mov_b32 s11, 0x00020000
    s_mov_b32 s12, s90
    s_and_b32 s13, s91, 0xffff
    s_mov_b32 s14, 1605632
    s_mov_b32 s15, 0x00020000
    s_lshl_b32 s40, s27, 8
    s_lshl_b32 s41, s24, 6
    s_add_u32 s40, s40, s41
    s_mul_i32 s46, s40, 896
    s_lshr_b32 s47, s46, 1
    s_mul_i32 s48, s28, 37
    s_lshr_b32 s48, s48, 8
    s_mul_i32 s48, s48, 7
    s_sub_u32 s48, s28, s48
    s_lshl_b32 s41, s48, 7
    s_add_u32 s49, s46, s41
    s_add_u32 s50, s47, s41
    s_add_u32 s30, s47, 896
    s_add_u32 s33, s32, 32768
    s_lshl_b32 s40, s24, 10
    s_add_u32 s40, s40, 49152
    v_add_u32 v28, s40, v27
    v_xor_b32 v29, 2048, v28
    v_mov_b32 v96, v20
    v_mov_b32 v97, v21
    v_mov_b32 v98, v10
    v_mov_b32 v99, v14
    s_waitcnt vmcnt(0) lgkmcnt(0)
    s_barrier
    ds_write_b128 v28, v[96:99]
    v_add_u32 v25, 98304, v23
    ds_read_b128 v[32:35], v25 offset:0
    ds_read_b128 v[36:39], v25 offset:1024
    ds_read_b128 v[40:43], v25 offset:2048
    ds_read_b128 v[44:47], v25 offset:3072
    ds_read_b128 v[48:51], v25 offset:4096
    ds_read_b128 v[52:55], v25 offset:5120
    ds_read_b128 v[56:59], v25 offset:6144
    ds_read_b128 v[60:63], v25 offset:7168
    s_waitcnt lgkmcnt(4)
    v_mfma_f32_16x16x32_bf16 v[128:131], v[32:35], v[112:115], v[128:131]
    s_add_u32 m0, s31, 0
    s_nop 0
    buffer_load_dwordx4 v124, s[8:11], s49 offen offset:0 lds
    v_mfma_f32_16x16x32_bf16 v[192:195], v[32:35], v[116:119], v[192:195]
    v_mfma_f32_16x16x32_bf16 v[196:199], v[36:39], v[116:119], v[196:199]
    buffer_load_dwordx4 v125, s[8:11], s49 offen offset:1024 lds
    v_mfma_f32_16x16x32_bf16 v[132:135], v[36:39], v[112:115], v[132:135]
    ds_read_b128 v[32:35], v25 offset:8192
    v_mfma_f32_16x16x32_bf16 v[136:139], v[40:43], v[112:115], v[136:139]
    ds_read_b128 v[36:39], v25 offset:9216
    v_mfma_f32_16x16x32_bf16 v[200:203], v[40:43], v[116:119], v[200:203]
    buffer_load_dwordx4 v126, s[8:11], s49 offen offset:2048 lds
    v_mfma_f32_16x16x32_bf16 v[204:207], v[44:47], v[116:119], v[204:207]
    v_mfma_f32_16x16x32_bf16 v[140:143], v[44:47], v[112:115], v[140:143]
    ds_read_b128 v[40:43], v25 offset:10240
    s_waitcnt lgkmcnt(3)
    v_mfma_f32_16x16x32_bf16 v[144:147], v[48:51], v[112:115], v[144:147]
    ds_read_b128 v[44:47], v25 offset:11264
    buffer_load_dwordx4 v127, s[8:11], s49 offen offset:3072 lds
    v_mfma_f32_16x16x32_bf16 v[208:211], v[48:51], v[116:119], v[208:211]
    v_mfma_f32_16x16x32_bf16 v[212:215], v[52:55], v[116:119], v[212:215]
    s_add_u32 m0, m0, 4096
    s_add_u32 s36, s49, 28672
    buffer_load_dwordx4 v124, s[8:11], s36 offen offset:0 lds
    v_mfma_f32_16x16x32_bf16 v[148:151], v[52:55], v[112:115], v[148:151]
    ds_read_b128 v[48:51], v25 offset:12288
    v_mfma_f32_16x16x32_bf16 v[152:155], v[56:59], v[112:115], v[152:155]
    ds_read_b128 v[52:55], v25 offset:13312
    v_mfma_f32_16x16x32_bf16 v[216:219], v[56:59], v[116:119], v[216:219]
    buffer_load_dwordx4 v125, s[8:11], s36 offen offset:1024 lds
    v_mfma_f32_16x16x32_bf16 v[220:223], v[60:63], v[116:119], v[220:223]
    v_mfma_f32_16x16x32_bf16 v[156:159], v[60:63], v[112:115], v[156:159]
    ds_read_b128 v[56:59], v25 offset:14336
    s_waitcnt lgkmcnt(3)
    v_mfma_f32_16x16x32_bf16 v[160:163], v[32:35], v[112:115], v[160:163]
    ds_read_b128 v[60:63], v25 offset:15360
    buffer_load_dwordx4 v126, s[8:11], s36 offen offset:2048 lds
    v_mfma_f32_16x16x32_bf16 v[224:227], v[32:35], v[116:119], v[224:227]
    v_mfma_f32_16x16x32_bf16 v[228:231], v[36:39], v[116:119], v[228:231]
    buffer_load_dwordx4 v127, s[8:11], s36 offen offset:3072 lds
    s_barrier
    ds_read_b128 v[100:103], v29
    v_mfma_f32_16x16x32_bf16 v[164:167], v[36:39], v[112:115], v[164:167]
    v_mfma_f32_16x16x32_bf16 v[168:171], v[40:43], v[112:115], v[168:171]
    v_mfma_f32_16x16x32_bf16 v[232:235], v[40:43], v[116:119], v[232:235]
    s_add_u32 m0, s33, 0
    s_add_u32 s49, s49, 128
    buffer_load_dwordx4 v124, s[12:15], s50 offen offset:0 lds
    v_mfma_f32_16x16x32_bf16 v[236:239], v[44:47], v[116:119], v[236:239]
    v_mfma_f32_16x16x32_bf16 v[172:175], v[44:47], v[112:115], v[172:175]
    s_waitcnt lgkmcnt(1)
    v_mfma_f32_16x16x32_bf16 v[176:179], v[48:51], v[112:115], v[176:179]
    buffer_load_dwordx4 v125, s[12:15], s50 offen offset:1024 lds
    v_mfma_f32_16x16x32_bf16 v[240:243], v[48:51], v[116:119], v[240:243]
    v_mfma_f32_16x16x32_bf16 v[244:247], v[52:55], v[116:119], v[244:247]
    buffer_load_dwordx4 v126, s[12:15], s50 offen offset:2048 lds
    v_mfma_f32_16x16x32_bf16 v[180:183], v[52:55], v[112:115], v[180:183]
    v_mfma_f32_16x16x32_bf16 v[184:187], v[56:59], v[112:115], v[184:187]
    v_mfma_f32_16x16x32_bf16 v[248:251], v[56:59], v[116:119], v[248:251]
    buffer_load_dwordx4 v127, s[12:15], s50 offen offset:3072 lds
    s_add_u32 s50, s50, 128
    s_cmp_eq_u32 s50, s30
    s_cselect_b32 s50, s47, s50
    s_cselect_b32 s49, s46, s49
    v_mfma_f32_16x16x32_bf16 v[252:255], v[60:63], v[116:119], v[252:255]
    v_mfma_f32_16x16x32_bf16 v[188:191], v[60:63], v[112:115], v[188:191]
    s_waitcnt lgkmcnt(0)
    buffer_load_dwordx4 v[64:67], v27, s[4:7], s51 offen offset:0 sc1
    buffer_load_dwordx4 v[68:71], v27, s[4:7], s51 offen offset:1024 sc1
    buffer_load_dwordx4 v[72:75], v27, s[4:7], s51 offen offset:2048 sc1
    buffer_load_dwordx4 v[76:79], v27, s[4:7], s51 offen offset:3072 sc1
    buffer_load_dwordx4 v[80:83], v26, s[4:7], s51 offen offset:0 sc1
    buffer_load_dwordx4 v[84:87], v26, s[4:7], s51 offen offset:1024 sc1
    buffer_load_dwordx4 v[88:91], v26, s[4:7], s51 offen offset:2048 sc1
    buffer_load_dwordx4 v[92:95], v26, s[4:7], s51 offen offset:3072 sc1
    s_barrier
    s_lshl_b32 s40, s25, 15
    s_add_u32 s40, s40, 49152
    v_add_u32 v25, s40, v27
    s_mul_i32 s40, s25, 81920
    s_add_u32 s40, s40, 65536
    v_add_u32 v22, s40, v27
    s_cmp_eq_u32 s26, 0
    s_cbranch_scc1 L_cX
    ds_write_b128 v25, v[128:131] offset:0
    ds_write_b128 v25, v[132:135] offset:1024
    ds_write_b128 v25, v[136:139] offset:2048
    ds_write_b128 v25, v[140:143] offset:3072
    ds_write_b128 v25, v[144:147] offset:4096
    ds_write_b128 v25, v[148:151] offset:5120
    ds_write_b128 v25, v[152:155] offset:6144
    ds_write_b128 v25, v[156:159] offset:7168
    ds_write_b128 v25, v[160:163] offset:8192
    ds_write_b128 v25, v[164:167] offset:9216
    ds_write_b128 v25, v[168:171] offset:10240
    ds_write_b128 v25, v[172:175] offset:11264
    ds_write_b128 v25, v[176:179] offset:12288
    ds_write_b128 v25, v[180:183] offset:13312
    ds_write_b128 v25, v[184:187] offset:14336
    ds_write_b128 v25, v[188:191] offset:15360
    ds_write_b128 v22, v[192:195] offset:0
    ds_write_b128 v22, v[196:199] offset:1024
    ds_write_b128 v22, v[200:203] offset:2048
    ds_write_b128 v22, v[204:207] offset:3072
    ds_write_b128 v22, v[208:211] offset:4096
    ds_write_b128 v22, v[212:215] offset:5120
    ds_write_b128 v22, v[216:219] offset:6144
    ds_write_b128 v22, v[220:223] offset:7168
    ds_write_b128 v22, v[224:227] offset:8192
    ds_write_b128 v22, v[228:231] offset:9216
    ds_write_b128 v22, v[232:235] offset:10240
    ds_write_b128 v22, v[236:239] offset:11264
    ds_write_b128 v22, v[240:243] offset:12288
    ds_write_b128 v22, v[244:247] offset:13312
    ds_write_b128 v22, v[248:251] offset:14336
    ds_write_b128 v22, v[252:255] offset:15360
    v_rcp_f32 v104, v2
    v_rcp_f32 v106, v6
    s_waitcnt lgkmcnt(0)
    s_barrier
    v_mov_b32 v105, v104
    v_mov_b32 v107, v106
    s_add_u32 m0, s31, 98304
    s_nop 0
    buffer_load_dwordx4 v124, s[8:11], s49 offen offset:0 lds
    v_accvgpr_read_b32 v32, a128
    v_accvgpr_read_b32 v33, a129
    v_accvgpr_read_b32 v34, a130
    v_accvgpr_read_b32 v35, a131
    v_pk_mul_f32 v[32:33], v[32:33], v[104:105]
    v_pk_mul_f32 v[34:35], v[34:35], v[104:105]
    v_cvt_pk_bf16_f32 v128, v32, v33
    v_cvt_pk_bf16_f32 v129, v34, v35
    v_accvgpr_read_b32 v36, a132
    v_accvgpr_read_b32 v37, a133
    v_accvgpr_read_b32 v38, a134
    v_accvgpr_read_b32 v39, a135
    v_pk_mul_f32 v[36:37], v[36:37], v[104:105]
    v_pk_mul_f32 v[38:39], v[38:39], v[104:105]
    v_cvt_pk_bf16_f32 v130, v36, v37
    v_cvt_pk_bf16_f32 v131, v38, v39
    buffer_load_dwordx4 v125, s[8:11], s49 offen offset:1024 lds
    v_accvgpr_read_b32 v40, a136
    v_accvgpr_read_b32 v41, a137
    v_accvgpr_read_b32 v42, a138
    v_accvgpr_read_b32 v43, a139
    v_pk_mul_f32 v[40:41], v[40:41], v[104:105]
    v_pk_mul_f32 v[42:43], v[42:43], v[104:105]
    v_cvt_pk_bf16_f32 v132, v40, v41
    v_cvt_pk_bf16_f32 v133, v42, v43
    v_accvgpr_read_b32 v44, a140
    v_accvgpr_read_b32 v45, a141
    v_accvgpr_read_b32 v46, a142
    v_accvgpr_read_b32 v47, a143
    v_pk_mul_f32 v[44:45], v[44:45], v[104:105]
    v_pk_mul_f32 v[46:47], v[46:47], v[104:105]
    v_cvt_pk_bf16_f32 v134, v44, v45
    v_cvt_pk_bf16_f32 v135, v46, v47
    buffer_load_dwordx4 v126, s[8:11], s49 offen offset:2048 lds
    v_accvgpr_read_b32 v32, a144
    v_accvgpr_read_b32 v33, a145
    v_accvgpr_read_b32 v34, a146
    v_accvgpr_read_b32 v35, a147
    v_pk_mul_f32 v[32:33], v[32:33], v[104:105]
    v_pk_mul_f32 v[34:35], v[34:35], v[104:105]
    v_cvt_pk_bf16_f32 v136, v32, v33
    v_cvt_pk_bf16_f32 v137, v34, v35
    v_accvgpr_read_b32 v36, a148
    v_accvgpr_read_b32 v37, a149
    v_accvgpr_read_b32 v38, a150
    v_accvgpr_read_b32 v39, a151
    v_pk_mul_f32 v[36:37], v[36:37], v[104:105]
    v_pk_mul_f32 v[38:39], v[38:39], v[104:105]
    v_cvt_pk_bf16_f32 v138, v36, v37
    v_cvt_pk_bf16_f32 v139, v38, v39
    buffer_load_dwordx4 v127, s[8:11], s49 offen offset:3072 lds
    v_accvgpr_read_b32 v40, a152
    v_accvgpr_read_b32 v41, a153
    v_accvgpr_read_b32 v42, a154
    v_accvgpr_read_b32 v43, a155
    v_pk_mul_f32 v[40:41], v[40:41], v[104:105]
    v_pk_mul_f32 v[42:43], v[42:43], v[104:105]
    v_cvt_pk_bf16_f32 v140, v40, v41
    v_cvt_pk_bf16_f32 v141, v42, v43
    v_accvgpr_read_b32 v44, a156
    v_accvgpr_read_b32 v45, a157
    v_accvgpr_read_b32 v46, a158
    v_accvgpr_read_b32 v47, a159
    v_pk_mul_f32 v[44:45], v[44:45], v[104:105]
    v_pk_mul_f32 v[46:47], v[46:47], v[104:105]
    v_cvt_pk_bf16_f32 v142, v44, v45
    v_cvt_pk_bf16_f32 v143, v46, v47
    s_add_u32 m0, m0, 4096
    s_add_u32 s36, s49, 28672
    buffer_load_dwordx4 v124, s[8:11], s36 offen offset:0 lds
    v_accvgpr_read_b32 v32, a160
    v_accvgpr_read_b32 v33, a161
    v_accvgpr_read_b32 v34, a162
    v_accvgpr_read_b32 v35, a163
    v_pk_mul_f32 v[32:33], v[32:33], v[104:105]
    v_pk_mul_f32 v[34:35], v[34:35], v[104:105]
    v_cvt_pk_bf16_f32 v144, v32, v33
    v_cvt_pk_bf16_f32 v145, v34, v35
    v_accvgpr_read_b32 v36, a164
    v_accvgpr_read_b32 v37, a165
    v_accvgpr_read_b32 v38, a166
    v_accvgpr_read_b32 v39, a167
    v_pk_mul_f32 v[36:37], v[36:37], v[104:105]
    v_pk_mul_f32 v[38:39], v[38:39], v[104:105]
    v_cvt_pk_bf16_f32 v146, v36, v37
    v_cvt_pk_bf16_f32 v147, v38, v39
    buffer_load_dwordx4 v125, s[8:11], s36 offen offset:1024 lds
    v_accvgpr_read_b32 v40, a168
    v_accvgpr_read_b32 v41, a169
    v_accvgpr_read_b32 v42, a170
    v_accvgpr_read_b32 v43, a171
    v_pk_mul_f32 v[40:41], v[40:41], v[104:105]
    v_pk_mul_f32 v[42:43], v[42:43], v[104:105]
    v_cvt_pk_bf16_f32 v148, v40, v41
    v_cvt_pk_bf16_f32 v149, v42, v43
    v_accvgpr_read_b32 v44, a172
    v_accvgpr_read_b32 v45, a173
    v_accvgpr_read_b32 v46, a174
    v_accvgpr_read_b32 v47, a175
    v_pk_mul_f32 v[44:45], v[44:45], v[104:105]
    v_pk_mul_f32 v[46:47], v[46:47], v[104:105]
    v_cvt_pk_bf16_f32 v150, v44, v45
    v_cvt_pk_bf16_f32 v151, v46, v47
    buffer_load_dwordx4 v126, s[8:11], s36 offen offset:2048 lds
    v_accvgpr_read_b32 v32, a176
    v_accvgpr_read_b32 v33, a177
    v_accvgpr_read_b32 v34, a178
    v_accvgpr_read_b32 v35, a179
    v_pk_mul_f32 v[32:33], v[32:33], v[104:105]
    v_pk_mul_f32 v[34:35], v[34:35], v[104:105]
    v_cvt_pk_bf16_f32 v152, v32, v33
    v_cvt_pk_bf16_f32 v153, v34, v35
    v_accvgpr_read_b32 v36, a180
    v_accvgpr_read_b32 v37, a181
    v_accvgpr_read_b32 v38, a182
    v_accvgpr_read_b32 v39, a183
    v_pk_mul_f32 v[36:37], v[36:37], v[104:105]
    v_pk_mul_f32 v[38:39], v[38:39], v[104:105]
    v_cvt_pk_bf16_f32 v154, v36, v37
    v_cvt_pk_bf16_f32 v155, v38, v39
    buffer_load_dwordx4 v127, s[8:11], s36 offen offset:3072 lds
    v_accvgpr_read_b32 v40, a184
    v_accvgpr_read_b32 v41, a185
    v_accvgpr_read_b32 v42, a186
    v_accvgpr_read_b32 v43, a187
    v_pk_mul_f32 v[40:41], v[40:41], v[104:105]
    v_pk_mul_f32 v[42:43], v[42:43], v[104:105]
    v_cvt_pk_bf16_f32 v156, v40, v41
    v_cvt_pk_bf16_f32 v157, v42, v43
    v_accvgpr_read_b32 v44, a188
    v_accvgpr_read_b32 v45, a189
    v_accvgpr_read_b32 v46, a190
    v_accvgpr_read_b32 v47, a191
    v_pk_mul_f32 v[44:45], v[44:45], v[104:105]
    v_pk_mul_f32 v[46:47], v[46:47], v[104:105]
    v_cvt_pk_bf16_f32 v158, v44, v45
    v_cvt_pk_bf16_f32 v159, v46, v47
    s_add_u32 m0, s33, 98304
    s_add_u32 s49, s49, 128
    buffer_load_dwordx4 v124, s[12:15], s50 offen offset:0 lds
    v_accvgpr_read_b32 v32, a192
    v_accvgpr_read_b32 v33, a193
    v_accvgpr_read_b32 v34, a194
    v_accvgpr_read_b32 v35, a195
    v_pk_mul_f32 v[32:33], v[32:33], v[106:107]
    v_pk_mul_f32 v[34:35], v[34:35], v[106:107]
    v_cvt_pk_bf16_f32 v160, v32, v33
    v_cvt_pk_bf16_f32 v161, v34, v35
    v_accvgpr_read_b32 v36, a196
    v_accvgpr_read_b32 v37, a197
    v_accvgpr_read_b32 v38, a198
    v_accvgpr_read_b32 v39, a199
    v_pk_mul_f32 v[36:37], v[36:37], v[106:107]
    v_pk_mul_f32 v[38:39], v[38:39], v[106:107]
    v_cvt_pk_bf16_f32 v162, v36, v37
    v_cvt_pk_bf16_f32 v163, v38, v39
    buffer_load_dwordx4 v125, s[12:15], s50 offen offset:1024 lds
    v_accvgpr_read_b32 v40, a200
    v_accvgpr_read_b32 v41, a201
    v_accvgpr_read_b32 v42, a202
    v_accvgpr_read_b32 v43, a203
    v_pk_mul_f32 v[40:41], v[40:41], v[106:107]
    v_pk_mul_f32 v[42:43], v[42:43], v[106:107]
    v_cvt_pk_bf16_f32 v164, v40, v41
    v_cvt_pk_bf16_f32 v165, v42, v43
    v_accvgpr_read_b32 v44, a204
    v_accvgpr_read_b32 v45, a205
    v_accvgpr_read_b32 v46, a206
    v_accvgpr_read_b32 v47, a207
    v_pk_mul_f32 v[44:45], v[44:45], v[106:107]
    v_pk_mul_f32 v[46:47], v[46:47], v[106:107]
    v_cvt_pk_bf16_f32 v166, v44, v45
    v_cvt_pk_bf16_f32 v167, v46, v47
    buffer_load_dwordx4 v126, s[12:15], s50 offen offset:2048 lds
    v_accvgpr_read_b32 v32, a208
    v_accvgpr_read_b32 v33, a209
    v_accvgpr_read_b32 v34, a210
    v_accvgpr_read_b32 v35, a211
    v_pk_mul_f32 v[32:33], v[32:33], v[106:107]
    v_pk_mul_f32 v[34:35], v[34:35], v[106:107]
    v_cvt_pk_bf16_f32 v168, v32, v33
    v_cvt_pk_bf16_f32 v169, v34, v35
    v_accvgpr_read_b32 v36, a212
    v_accvgpr_read_b32 v37, a213
    v_accvgpr_read_b32 v38, a214
    v_accvgpr_read_b32 v39, a215
    v_pk_mul_f32 v[36:37], v[36:37], v[106:107]
    v_pk_mul_f32 v[38:39], v[38:39], v[106:107]
    v_cvt_pk_bf16_f32 v170, v36, v37
    v_cvt_pk_bf16_f32 v171, v38, v39
    buffer_load_dwordx4 v127, s[12:15], s50 offen offset:3072 lds
    s_add_u32 s50, s50, 128
    s_cmp_eq_u32 s50, s30
    s_cselect_b32 s50, s47, s50
    s_cselect_b32 s49, s46, s49
    v_accvgpr_read_b32 v40, a216
    v_accvgpr_read_b32 v41, a217
    v_accvgpr_read_b32 v42, a218
    v_accvgpr_read_b32 v43, a219
    v_pk_mul_f32 v[40:41], v[40:41], v[106:107]
    v_pk_mul_f32 v[42:43], v[42:43], v[106:107]
    v_cvt_pk_bf16_f32 v172, v40, v41
    v_cvt_pk_bf16_f32 v173, v42, v43
    v_accvgpr_read_b32 v44, a220
    v_accvgpr_read_b32 v45, a221
    v_accvgpr_read_b32 v46, a222
    v_accvgpr_read_b32 v47, a223
    v_pk_mul_f32 v[44:45], v[44:45], v[106:107]
    v_pk_mul_f32 v[46:47], v[46:47], v[106:107]
    v_cvt_pk_bf16_f32 v174, v44, v45
    v_cvt_pk_bf16_f32 v175, v46, v47
    v_accvgpr_read_b32 v32, a224
    v_accvgpr_read_b32 v33, a225
    v_accvgpr_read_b32 v34, a226
    v_accvgpr_read_b32 v35, a227
    v_pk_mul_f32 v[32:33], v[32:33], v[106:107]
    v_pk_mul_f32 v[34:35], v[34:35], v[106:107]
    v_cvt_pk_bf16_f32 v176, v32, v33
    v_cvt_pk_bf16_f32 v177, v34, v35
    v_accvgpr_read_b32 v36, a228
    v_accvgpr_read_b32 v37, a229
    v_accvgpr_read_b32 v38, a230
    v_accvgpr_read_b32 v39, a231
    v_pk_mul_f32 v[36:37], v[36:37], v[106:107]
    v_pk_mul_f32 v[38:39], v[38:39], v[106:107]
    v_cvt_pk_bf16_f32 v178, v36, v37
    v_cvt_pk_bf16_f32 v179, v38, v39
    v_accvgpr_read_b32 v40, a232
    v_accvgpr_read_b32 v41, a233
    v_accvgpr_read_b32 v42, a234
    v_accvgpr_read_b32 v43, a235
    v_pk_mul_f32 v[40:41], v[40:41], v[106:107]
    v_pk_mul_f32 v[42:43], v[42:43], v[106:107]
    v_cvt_pk_bf16_f32 v180, v40, v41
    v_cvt_pk_bf16_f32 v181, v42, v43
    v_accvgpr_read_b32 v44, a236
    v_accvgpr_read_b32 v45, a237
    v_accvgpr_read_b32 v46, a238
    v_accvgpr_read_b32 v47, a239
    v_pk_mul_f32 v[44:45], v[44:45], v[106:107]
    v_pk_mul_f32 v[46:47], v[46:47], v[106:107]
    v_cvt_pk_bf16_f32 v182, v44, v45
    v_cvt_pk_bf16_f32 v183, v46, v47
    v_accvgpr_read_b32 v32, a240
    v_accvgpr_read_b32 v33, a241
    v_accvgpr_read_b32 v34, a242
    v_accvgpr_read_b32 v35, a243
    v_pk_mul_f32 v[32:33], v[32:33], v[106:107]
    v_pk_mul_f32 v[34:35], v[34:35], v[106:107]
    v_cvt_pk_bf16_f32 v184, v32, v33
    v_cvt_pk_bf16_f32 v185, v34, v35
    v_accvgpr_read_b32 v36, a244
    v_accvgpr_read_b32 v37, a245
    v_accvgpr_read_b32 v38, a246
    v_accvgpr_read_b32 v39, a247
    v_pk_mul_f32 v[36:37], v[36:37], v[106:107]
    v_pk_mul_f32 v[38:39], v[38:39], v[106:107]
    v_cvt_pk_bf16_f32 v186, v36, v37
    v_cvt_pk_bf16_f32 v187, v38, v39
    v_accvgpr_read_b32 v40, a248
    v_accvgpr_read_b32 v41, a249
    v_accvgpr_read_b32 v42, a250
    v_accvgpr_read_b32 v43, a251
    v_pk_mul_f32 v[40:41], v[40:41], v[106:107]
    v_pk_mul_f32 v[42:43], v[42:43], v[106:107]
    v_cvt_pk_bf16_f32 v188, v40, v41
    v_cvt_pk_bf16_f32 v189, v42, v43
    v_accvgpr_read_b32 v44, a252
    v_accvgpr_read_b32 v45, a253
    v_accvgpr_read_b32 v46, a254
    v_accvgpr_read_b32 v47, a255
    v_pk_mul_f32 v[44:45], v[44:45], v[106:107]
    v_pk_mul_f32 v[46:47], v[46:47], v[106:107]
    v_cvt_pk_bf16_f32 v190, v44, v45
    v_cvt_pk_bf16_f32 v191, v46, v47
    s_branch L_cjoin
L_cX:
    v_min_f32 v18, v96, v100
    v_min_f32 v19, v97, v101
    v_sub_f32 v104, v18, v96
    v_sub_f32 v106, v19, v97
    v_sub_f32 v108, v18, v100
    v_sub_f32 v110, v19, v101
    v_exp_f32 v104, v104
    v_exp_f32 v106, v106
    v_exp_f32 v108, v108
    v_exp_f32 v110, v110
    v_mul_f32 v18, v104, v98
    v_mul_f32 v19, v106, v99
    v_fmac_f32 v18, v108, v102
    v_fmac_f32 v19, v110, v103
    v_rcp_f32 v18, v18
    v_rcp_f32 v19, v19
    s_nop 0
    s_nop 0
    v_mul_f32 v104, v104, v18
    v_mul_f32 v106, v106, v19
    v_mul_f32 v108, v108, v18
    v_mul_f32 v110, v110, v19
    v_mov_b32 v105, v104
    v_mov_b32 v107, v106
    v_mov_b32 v109, v108
    v_mov_b32 v111, v110
    s_add_u32 m0, s31, 98304
    s_nop 0
    buffer_load_dwordx4 v124, s[8:11], s49 offen offset:0 lds
    v_pk_mul_f32 v[128:129], v[128:129], v[104:105]
    v_pk_mul_f32 v[130:131], v[130:131], v[104:105]
    v_pk_mul_f32 v[132:133], v[132:133], v[104:105]
    v_pk_mul_f32 v[134:135], v[134:135], v[104:105]
    v_pk_mul_f32 v[136:137], v[136:137], v[104:105]
    buffer_load_dwordx4 v125, s[8:11], s49 offen offset:1024 lds
    v_pk_mul_f32 v[138:139], v[138:139], v[104:105]
    v_pk_mul_f32 v[140:141], v[140:141], v[104:105]
    v_pk_mul_f32 v[142:143], v[142:143], v[104:105]
    v_pk_mul_f32 v[144:145], v[144:145], v[104:105]
    v_pk_mul_f32 v[146:147], v[146:147], v[104:105]
    buffer_load_dwordx4 v126, s[8:11], s49 offen offset:2048 lds
    v_pk_mul_f32 v[148:149], v[148:149], v[104:105]
    v_pk_mul_f32 v[150:151], v[150:151], v[104:105]
    v_pk_mul_f32 v[152:153], v[152:153], v[104:105]
    v_pk_mul_f32 v[154:155], v[154:155], v[104:105]
    v_pk_mul_f32 v[156:157], v[156:157], v[104:105]
    buffer_load_dwordx4 v127, s[8:11], s49 offen offset:3072 lds
    v_pk_mul_f32 v[158:159], v[158:159], v[104:105]
    v_pk_mul_f32 v[160:161], v[160:161], v[104:105]
    v_pk_mul_f32 v[162:163], v[162:163], v[104:105]
    v_pk_mul_f32 v[164:165], v[164:165], v[104:105]
    v_pk_mul_f32 v[166:167], v[166:167], v[104:105]
    s_add_u32 m0, m0, 4096
    s_add_u32 s36, s49, 28672
    buffer_load_dwordx4 v124, s[8:11], s36 offen offset:0 lds
    v_pk_mul_f32 v[168:169], v[168:169], v[104:105]
    v_pk_mul_f32 v[170:171], v[170:171], v[104:105]
    v_pk_mul_f32 v[172:173], v[172:173], v[104:105]
    v_pk_mul_f32 v[174:175], v[174:175], v[104:105]
    v_pk_mul_f32 v[176:177], v[176:177], v[104:105]
    buffer_load_dwordx4 v125, s[8:11], s36 offen offset:1024 lds
    v_pk_mul_f32 v[178:179], v[178:179], v[104:105]
    v_pk_mul_f32 v[180:181], v[180:181], v[104:105]
    v_pk_mul_f32 v[182:183], v[182:183], v[104:105]
    v_pk_mul_f32 v[184:185], v[184:185], v[104:105]
    v_pk_mul_f32 v[186:187], v[186:187], v[104:105]
    buffer_load_dwordx4 v126, s[8:11], s36 offen offset:2048 lds
    v_pk_mul_f32 v[188:189], v[188:189], v[104:105]
    v_pk_mul_f32 v[190:191], v[190:191], v[104:105]
    v_pk_mul_f32 v[192:193], v[192:193], v[106:107]
    v_pk_mul_f32 v[194:195], v[194:195], v[106:107]
    v_pk_mul_f32 v[196:197], v[196:197], v[106:107]
    buffer_load_dwordx4 v127, s[8:11], s36 offen offset:3072 lds
    v_pk_mul_f32 v[198:199], v[198:199], v[106:107]
    v_pk_mul_f32 v[200:201], v[200:201], v[106:107]
    v_pk_mul_f32 v[202:203], v[202:203], v[106:107]
    v_pk_mul_f32 v[204:205], v[204:205], v[106:107]
    v_pk_mul_f32 v[206:207], v[206:207], v[106:107]
    s_add_u32 m0, s33, 98304
    s_add_u32 s49, s49, 128
    buffer_load_dwordx4 v124, s[12:15], s50 offen offset:0 lds
    v_pk_mul_f32 v[208:209], v[208:209], v[106:107]
    v_pk_mul_f32 v[210:211], v[210:211], v[106:107]
    v_pk_mul_f32 v[212:213], v[212:213], v[106:107]
    v_pk_mul_f32 v[214:215], v[214:215], v[106:107]
    v_pk_mul_f32 v[216:217], v[216:217], v[106:107]
    buffer_load_dwordx4 v125, s[12:15], s50 offen offset:1024 lds
    v_pk_mul_f32 v[218:219], v[218:219], v[106:107]
    v_pk_mul_f32 v[220:221], v[220:221], v[106:107]
    v_pk_mul_f32 v[222:223], v[222:223], v[106:107]
    v_pk_mul_f32 v[224:225], v[224:225], v[106:107]
    v_pk_mul_f32 v[226:227], v[226:227], v[106:107]
    buffer_load_dwordx4 v126, s[12:15], s50 offen offset:2048 lds
    v_pk_mul_f32 v[228:229], v[228:229], v[106:107]
    v_pk_mul_f32 v[230:231], v[230:231], v[106:107]
    v_pk_mul_f32 v[232:233], v[232:233], v[106:107]
    v_pk_mul_f32 v[234:235], v[234:235], v[106:107]
    v_pk_mul_f32 v[236:237], v[236:237], v[106:107]
    buffer_load_dwordx4 v127, s[12:15], s50 offen offset:3072 lds
    s_add_u32 s50, s50, 128
    s_cmp_eq_u32 s50, s30
    s_cselect_b32 s50, s47, s50
    s_cselect_b32 s49, s46, s49
    v_pk_mul_f32 v[238:239], v[238:239], v[106:107]
    v_pk_mul_f32 v[240:241], v[240:241], v[106:107]
    v_pk_mul_f32 v[242:243], v[242:243], v[106:107]
    v_pk_mul_f32 v[244:245], v[244:245], v[106:107]
    v_pk_mul_f32 v[246:247], v[246:247], v[106:107]
    v_pk_mul_f32 v[248:249], v[248:249], v[106:107]
    v_pk_mul_f32 v[250:251], v[250:251], v[106:107]
    v_pk_mul_f32 v[252:253], v[252:253], v[106:107]
    v_pk_mul_f32 v[254:255], v[254:255], v[106:107]
    s_barrier
    ds_read_b128 v[32:35], v25 offset:0
    ds_read_b128 v[36:39], v25 offset:1024
    ds_read_b128 v[40:43], v25 offset:2048
    ds_read_b128 v[44:47], v25 offset:3072
    ds_read_b128 v[48:51], v25 offset:4096
    ds_read_b128 v[52:55], v25 offset:5120
    ds_read_b128 v[56:59], v25 offset:6144
    ds_read_b128 v[60:63], v25 offset:7168
    s_waitcnt lgkmcnt(7)
    v_pk_fma_f32 v[128:129], v[32:33], v[108:109], v[128:129]
    v_pk_fma_f32 v[130:131], v[34:35], v[108:109], v[130:131]
    ds_read_b128 v[32:35], v25 offset:8192
    v_cvt_pk_bf16_f32 v128, v128, v129
    v_cvt_pk_bf16_f32 v129, v130, v131
    s_waitcnt lgkmcnt(7)
    v_pk_fma_f32 v[132:133], v[36:37], v[108:109], v[132:133]
    v_pk_fma_f32 v[134:135], v[38:39], v[108:109], v[134:135]
    ds_read_b128 v[36:39], v25 offset:9216
    v_cvt_pk_bf16_f32 v130, v132, v133
    v_cvt_pk_bf16_f32 v131, v134, v135
    s_waitcnt lgkmcnt(7)
    v_pk_fma_f32 v[136:137], v[40:41], v[108:109], v[136:137]
    v_pk_fma_f32 v[138:139], v[42:43], v[108:109], v[138:139]
    ds_read_b128 v[40:43], v25 offset:10240
    v_cvt_pk_bf16_f32 v132, v136, v137
    v_cvt_pk_bf16_f32 v133, v138, v139
    s_waitcnt lgkmcnt(7)
    v_pk_fma_f32 v[140:141], v[44:45], v[108:109], v[140:141]
    v_pk_fma_f32 v[142:143], v[46:47], v[108:109], v[142:143]
    ds_read_b128 v[44:47], v25 offset:11264
    v_cvt_pk_bf16_f32 v134, v140, v141
    v_cvt_pk_bf16_f32 v135, v142, v143
    s_waitcnt lgkmcnt(7)
    v_pk_fma_f32 v[144:145], v[48:49], v[108:109], v[144:145]
    v_pk_fma_f32 v[146:147], v[50:51], v[108:109], v[146:147]
    ds_read_b128 v[48:51], v25 offset:12288
    v_cvt_pk_bf16_f32 v136, v144, v145
    v_cvt_pk_bf16_f32 v137, v146, v147
    s_waitcnt lgkmcnt(7)
    v_pk_fma_f32 v[148:149], v[52:53], v[108:109], v[148:149]
    v_pk_fma_f32 v[150:151], v[54:55], v[108:109], v[150:151]
    ds_read_b128 v[52:55], v25 offset:13312
    v_cvt_pk_bf16_f32 v138, v148, v149
    v_cvt_pk_bf16_f32 v139, v150, v151
    s_waitcnt lgkmcnt(7)
    v_pk_fma_f32 v[152:153], v[56:57], v[108:109], v[152:153]
    v_pk_fma_f32 v[154:155], v[58:59], v[108:109], v[154:155]
    ds_read_b128 v[56:59], v25 offset:14336
    v_cvt_pk_bf16_f32 v140, v152, v153
    v_cvt_pk_bf16_f32 v141, v154, v155
    s_waitcnt lgkmcnt(7)
    v_pk_fma_f32 v[156:157], v[60:61], v[108:109], v[156:157]
    v_pk_fma_f32 v[158:159], v[62:63], v[108:109], v[158:159]
    ds_read_b128 v[60:63], v25 offset:15360
    v_cvt_pk_bf16_f32 v142, v156, v157
    v_cvt_pk_bf16_f32 v143, v158, v159
    s_waitcnt lgkmcnt(7)
    v_pk_fma_f32 v[160:161], v[32:33], v[108:109], v[160:161]
    v_pk_fma_f32 v[162:163], v[34:35], v[108:109], v[162:163]
    ds_read_b128 v[32:35], v22 offset:0
    v_cvt_pk_bf16_f32 v144, v160, v161
    v_cvt_pk_bf16_f32 v145, v162, v163
    s_waitcnt lgkmcnt(7)
    v_pk_fma_f32 v[164:165], v[36:37], v[108:109], v[164:165]
    v_pk_fma_f32 v[166:167], v[38:39], v[108:109], v[166:167]
    ds_read_b128 v[36:39], v22 offset:1024
    v_cvt_pk_bf16_f32 v146, v164, v165
    v_cvt_pk_bf16_f32 v147, v166, v167
    s_waitcnt lgkmcnt(7)
    v_pk_fma_f32 v[168:169], v[40:41], v[108:109], v[168:169]
    v_pk_fma_f32 v[170:171], v[42:43], v[108:109], v[170:171]
    ds_read_b128 v[40:43], v22 offset:2048
    v_cvt_pk_bf16_f32 v148, v168, v169
    v_cvt_pk_bf16_f32 v149, v170, v171
    s_waitcnt lgkmcnt(7)
    v_pk_fma_f32 v[172:173], v[44:45], v[108:109], v[172:173]
    v_pk_fma_f32 v[174:175], v[46:47], v[108:109], v[174:175]
    ds_read_b128 v[44:47], v22 offset:3072
    v_cvt_pk_bf16_f32 v150, v172, v173
    v_cvt_pk_bf16_f32 v151, v174, v175
    s_waitcnt lgkmcnt(7)
    v_pk_fma_f32 v[176:177], v[48:49], v[108:109], v[176:177]
    v_pk_fma_f32 v[178:179], v[50:51], v[108:109], v[178:179]
    ds_read_b128 v[48:51], v22 offset:4096
    v_cvt_pk_bf16_f32 v152, v176, v177
    v_cvt_pk_bf16_f32 v153, v178, v179
    s_waitcnt lgkmcnt(7)
    v_pk_fma_f32 v[180:181], v[52:53], v[108:109], v[180:181]
    v_pk_fma_f32 v[182:183], v[54:55], v[108:109], v[182:183]
    ds_read_b128 v[52:55], v22 offset:5120
    v_cvt_pk_bf16_f32 v154, v180, v181
    v_cvt_pk_bf16_f32 v155, v182, v183
    s_waitcnt lgkmcnt(7)
    v_pk_fma_f32 v[184:185], v[56:57], v[108:109], v[184:185]
    v_pk_fma_f32 v[186:187], v[58:59], v[108:109], v[186:187]
    ds_read_b128 v[56:59], v22 offset:6144
    v_cvt_pk_bf16_f32 v156, v184, v185
    v_cvt_pk_bf16_f32 v157, v186, v187
    s_waitcnt lgkmcnt(7)
    v_pk_fma_f32 v[188:189], v[60:61], v[108:109], v[188:189]
    v_pk_fma_f32 v[190:191], v[62:63], v[108:109], v[190:191]
    ds_read_b128 v[60:63], v22 offset:7168
    v_cvt_pk_bf16_f32 v158, v188, v189
    v_cvt_pk_bf16_f32 v159, v190, v191
    s_waitcnt lgkmcnt(7)
    v_pk_fma_f32 v[192:193], v[32:33], v[110:111], v[192:193]
    v_pk_fma_f32 v[194:195], v[34:35], v[110:111], v[194:195]
    ds_read_b128 v[32:35], v22 offset:8192
    v_cvt_pk_bf16_f32 v160, v192, v193
    v_cvt_pk_bf16_f32 v161, v194, v195
    s_waitcnt lgkmcnt(7)
    v_pk_fma_f32 v[196:197], v[36:37], v[110:111], v[196:197]
    v_pk_fma_f32 v[198:199], v[38:39], v[110:111], v[198:199]
    ds_read_b128 v[36:39], v22 offset:9216
    v_cvt_pk_bf16_f32 v162, v196, v197
    v_cvt_pk_bf16_f32 v163, v198, v199
    s_waitcnt lgkmcnt(7)
    v_pk_fma_f32 v[200:201], v[40:41], v[110:111], v[200:201]
    v_pk_fma_f32 v[202:203], v[42:43], v[110:111], v[202:203]
    ds_read_b128 v[40:43], v22 offset:10240
    v_cvt_pk_bf16_f32 v164, v200, v201
    v_cvt_pk_bf16_f32 v165, v202, v203
    s_waitcnt lgkmcnt(7)
    v_pk_fma_f32 v[204:205], v[44:45], v[110:111], v[204:205]
    v_pk_fma_f32 v[206:207], v[46:47], v[110:111], v[206:207]
    ds_read_b128 v[44:47], v22 offset:11264
    v_cvt_pk_bf16_f32 v166, v204, v205
    v_cvt_pk_bf16_f32 v167, v206, v207
    s_waitcnt lgkmcnt(7)
    v_pk_fma_f32 v[208:209], v[48:49], v[110:111], v[208:209]
    v_pk_fma_f32 v[210:211], v[50:51], v[110:111], v[210:211]
    ds_read_b128 v[48:51], v22 offset:12288
    v_cvt_pk_bf16_f32 v168, v208, v209
    v_cvt_pk_bf16_f32 v169, v210, v211
    s_waitcnt lgkmcnt(7)
    v_pk_fma_f32 v[212:213], v[52:53], v[110:111], v[212:213]
    v_pk_fma_f32 v[214:215], v[54:55], v[110:111], v[214:215]
    ds_read_b128 v[52:55], v22 offset:13312
    v_cvt_pk_bf16_f32 v170, v212, v213
    v_cvt_pk_bf16_f32 v171, v214, v215
    s_waitcnt lgkmcnt(7)
    v_pk_fma_f32 v[216:217], v[56:57], v[110:111], v[216:217]
    v_pk_fma_f32 v[218:219], v[58:59], v[110:111], v[218:219]
    ds_read_b128 v[56:59], v22 offset:14336
    v_cvt_pk_bf16_f32 v172, v216, v217
    v_cvt_pk_bf16_f32 v173, v218, v219
    s_waitcnt lgkmcnt(7)
    v_pk_fma_f32 v[220:221], v[60:61], v[110:111], v[220:221]
    v_pk_fma_f32 v[222:223], v[62:63], v[110:111], v[222:223]
    ds_read_b128 v[60:63], v22 offset:15360
    v_cvt_pk_bf16_f32 v174, v220, v221
    v_cvt_pk_bf16_f32 v175, v222, v223
    s_waitcnt lgkmcnt(7)
    v_pk_fma_f32 v[224:225], v[32:33], v[110:111], v[224:225]
    v_pk_fma_f32 v[226:227], v[34:35], v[110:111], v[226:227]
    v_cvt_pk_bf16_f32 v176, v224, v225
    v_cvt_pk_bf16_f32 v177, v226, v227
    s_waitcnt lgkmcnt(6)
    v_pk_fma_f32 v[228:229], v[36:37], v[110:111], v[228:229]
    v_pk_fma_f32 v[230:231], v[38:39], v[110:111], v[230:231]
    v_cvt_pk_bf16_f32 v178, v228, v229
    v_cvt_pk_bf16_f32 v179, v230, v231
    s_waitcnt lgkmcnt(5)
    v_pk_fma_f32 v[232:233], v[40:41], v[110:111], v[232:233]
    v_pk_fma_f32 v[234:235], v[42:43], v[110:111], v[234:235]
    v_cvt_pk_bf16_f32 v180, v232, v233
    v_cvt_pk_bf16_f32 v181, v234, v235
    s_waitcnt lgkmcnt(4)
    v_pk_fma_f32 v[236:237], v[44:45], v[110:111], v[236:237]
    v_pk_fma_f32 v[238:239], v[46:47], v[110:111], v[238:239]
    v_cvt_pk_bf16_f32 v182, v236, v237
    v_cvt_pk_bf16_f32 v183, v238, v239
    s_waitcnt lgkmcnt(3)
    v_pk_fma_f32 v[240:241], v[48:49], v[110:111], v[240:241]
    v_pk_fma_f32 v[242:243], v[50:51], v[110:111], v[242:243]
    v_cvt_pk_bf16_f32 v184, v240, v241
    v_cvt_pk_bf16_f32 v185, v242, v243
    s_waitcnt lgkmcnt(2)
    v_pk_fma_f32 v[244:245], v[52:53], v[110:111], v[244:245]
    v_pk_fma_f32 v[246:247], v[54:55], v[110:111], v[246:247]
    v_cvt_pk_bf16_f32 v186, v244, v245
    v_cvt_pk_bf16_f32 v187, v246, v247
    s_waitcnt lgkmcnt(1)
    v_pk_fma_f32 v[248:249], v[56:57], v[110:111], v[248:249]
    v_pk_fma_f32 v[250:251], v[58:59], v[110:111], v[250:251]
    v_cvt_pk_bf16_f32 v188, v248, v249
    v_cvt_pk_bf16_f32 v189, v250, v251
    s_waitcnt lgkmcnt(0)
    v_pk_fma_f32 v[252:253], v[60:61], v[110:111], v[252:253]
    v_pk_fma_f32 v[254:255], v[62:63], v[110:111], v[254:255]
    v_cvt_pk_bf16_f32 v190, v252, v253
    v_cvt_pk_bf16_f32 v191, v254, v255
L_cjoin:
    v_lshrrev_b32 v30, 2, v1
    v_lshlrev_b32 v30, 7, v30
    v_and_b32 v31, 3, v1
    v_lshl_add_u32 v30, v31, 3, v30
    v_bfe_u32 v31, v1, 3, 2
    v_xor_b32 v24, 0, v31
    v_lshl_add_u32 v8, v24, 5, v30
    v_xor_b32 v24, 1, v31
    v_lshl_add_u32 v9, v24, 5, v30
    v_xor_b32 v24, 2, v31
    v_lshl_add_u32 v10, v24, 5, v30
    v_xor_b32 v24, 3, v31
    v_lshl_add_u32 v11, v24, 5, v30
    s_waitcnt vmcnt(12)
    s_barrier
    s_mul_i32 s40, s29, 458752
    s_lshl_b32 s41, s27, 10
    s_add_u32 s40, s40, s41
    s_add_u32 s34, s40, 35651584
    s_add_u32 s51, s34, 458752
    s_lshl_b32 s41, s48, 16
    s_add_u32 s38, s34, s41
    s_mov_b32 s39, 0x40000000
    s_mov_b32 s35, 0
    s_mov_b32 s42, 49152
    s_mov_b32 s37, 98304
    s_lshl_b32 s45, s28, 7
    s_add_u32 s45, s45, 83888128
    v_mov_b32 v28, 28
    v_mov_b32 v29, 1
    ds_read_b64_tr_b16 v[32:33], v8 offset:0
    ds_read_b64_tr_b16 v[34:35], v8 offset:2048
    ds_read_b64_tr_b16 v[36:37], v8 offset:4096
    ds_read_b64_tr_b16 v[38:39], v8 offset:6144
    ds_read_b64_tr_b16 v[40:41], v8 offset:8192
    ds_read_b64_tr_b16 v[42:43], v8 offset:10240
    ds_read_b64_tr_b16 v[44:45], v8 offset:12288
    ds_read_b64_tr_b16 v[46:47], v8 offset:14336
    ds_read_b64_tr_b16 v[48:49], v8 offset:16384
    ds_read_b64_tr_b16 v[50:51], v8 offset:18432
    ds_read_b64_tr_b16 v[52:53], v8 offset:20480
    ds_read_b64_tr_b16 v[54:55], v8 offset:22528
    s_mov_b32 s43, 0
    v_mov_b32 v24, 0
.p2align 3
L_p5:
    s_waitcnt lgkmcnt(8)
    v_mfma_f32_16x16x32_bf16 v[192:195], v[32:35], v[128:131], 0
    ds_read_b64_tr_b16 v[56:57], v8 offset:24576
    ds_read_b64_tr_b16 v[58:59], v8 offset:26624
    v_mfma_f32_16x16x32_bf16 v[192:195], v[36:39], v[132:135], v[192:195]
    ds_read_b64_tr_b16 v[60:61], v8 offset:28672
    ds_read_b64_tr_b16 v[62:63], v8 offset:30720
    v_mfma_f32_16x16x32_bf16 v[200:203], v[36:39], v[164:167], 0
    s_sub_u32 s40, s35, 49152
    s_cselect_b32 s40, s37, s40
    v_mfma_f32_16x16x32_bf16 v[200:203], v[32:35], v[160:163], v[200:203]
    s_add_u32 s41, s39, 0
    s_waitcnt lgkmcnt(8)
    v_mfma_f32_16x16x32_bf16 v[200:203], v[40:43], v[168:171], v[200:203]
    ds_read_b64_tr_b16 v[32:33], v8 offset:32768
    ds_read_b64_tr_b16 v[34:35], v8 offset:34816
    v_mfma_f32_16x16x32_bf16 v[200:203], v[44:47], v[172:175], v[200:203]
    ds_read_b64_tr_b16 v[36:37], v8 offset:36864
    ds_read_b64_tr_b16 v[38:39], v8 offset:38912
    v_mfma_f32_16x16x32_bf16 v[192:195], v[44:47], v[140:143], v[192:195]
    buffer_store_dwordx4 v[232:235], v27, s[4:7], s41 offen sc1
    v_mfma_f32_16x16x32_bf16 v[192:195], v[40:43], v[136:139], v[192:195]
    s_add_u32 s41, s39, 16384
    s_waitcnt lgkmcnt(8)
    v_mfma_f32_16x16x32_bf16 v[192:195], v[48:51], v[144:147], v[192:195]
    ds_read_b64_tr_b16 v[40:41], v8 offset:40960
    ds_read_b64_tr_b16 v[42:43], v8 offset:43008
    v_mfma_f32_16x16x32_bf16 v[192:195], v[52:55], v[148:151], v[192:195]
    ds_read_b64_tr_b16 v[44:45], v8 offset:45056
    ds_read_b64_tr_b16 v[46:47], v8 offset:47104
    v_mfma_f32_16x16x32_bf16 v[200:203], v[52:55], v[180:183], v[200:203]
    buffer_store_dwordx4 v[236:239], v27, s[4:7], s41 offen sc1
    v_mfma_f32_16x16x32_bf16 v[200:203], v[48:51], v[176:179], v[200:203]
    v_cvt_pk_bf16_f32 v228, v216, v217
    s_waitcnt lgkmcnt(8)
    v_mfma_f32_16x16x32_bf16 v[200:203], v[56:59], v[184:187], v[200:203]
    ds_read_b64_tr_b16 v[48:49], v9 offset:0
    ds_read_b64_tr_b16 v[50:51], v9 offset:2048
    v_mfma_f32_16x16x32_bf16 v[200:203], v[60:63], v[188:191], v[200:203]
    ds_read_b64_tr_b16 v[52:53], v9 offset:4096
    ds_read_b64_tr_b16 v[54:55], v9 offset:6144
    v_mfma_f32_16x16x32_bf16 v[192:195], v[60:63], v[156:159], v[192:195]
    v_cvt_pk_bf16_f32 v224, v208, v209
    v_cvt_pk_bf16_f32 v225, v210, v211
    v_mfma_f32_16x16x32_bf16 v[192:195], v[56:59], v[152:155], v[192:195]
    v_cvt_pk_bf16_f32 v229, v218, v219
    s_waitcnt lgkmcnt(8)
    v_mfma_f32_16x16x32_bf16 v[192:195], v[32:35], v[64:67], v[192:195]
    ds_read_b64_tr_b16 v[56:57], v9 offset:8192
    ds_read_b64_tr_b16 v[58:59], v9 offset:10240
    v_mfma_f32_16x16x32_bf16 v[192:195], v[36:39], v[68:71], v[192:195]
    ds_read_b64_tr_b16 v[60:61], v9 offset:12288
    ds_read_b64_tr_b16 v[62:63], v9 offset:14336
    v_mfma_f32_16x16x32_bf16 v[200:203], v[36:39], v[84:87], v[200:203]
    v_cvt_pk_bf16_f32 v226, v212, v213
    v_cvt_pk_bf16_f32 v227, v214, v215
    v_mfma_f32_16x16x32_bf16 v[200:203], v[32:35], v[80:83], v[200:203]
    s_sub_u32 s44, s40, s35
    s_waitcnt lgkmcnt(8)
    v_mfma_f32_16x16x32_bf16 v[200:203], v[40:43], v[88:91], v[200:203]
    ds_read_b64_tr_b16 v[32:33], v9 offset:16384
    ds_read_b64_tr_b16 v[34:35], v9 offset:18432
    v_mfma_f32_16x16x32_bf16 v[200:203], v[44:47], v[92:95], v[200:203]
    ds_read_b64_tr_b16 v[36:37], v9 offset:20480
    ds_read_b64_tr_b16 v[38:39], v9 offset:22528
    v_mfma_f32_16x16x32_bf16 v[192:195], v[44:47], v[76:79], v[192:195]
    v_cvt_pk_bf16_f32 v230, v220, v221
    v_cvt_pk_bf16_f32 v231, v222, v223
    v_mfma_f32_16x16x32_bf16 v[192:195], v[40:43], v[72:75], v[192:195]
    s_add_u32 s41, s39, 32768
    s_waitcnt lgkmcnt(8)
    v_mfma_f32_16x16x32_bf16 v[196:199], v[48:51], v[128:131], 0
    ds_read_b64_tr_b16 v[40:41], v9 offset:24576
    ds_read_b64_tr_b16 v[42:43], v9 offset:26624
    v_mfma_f32_16x16x32_bf16 v[196:199], v[52:55], v[132:135], v[196:199]
    ds_read_b64_tr_b16 v[44:45], v9 offset:28672
    ds_read_b64_tr_b16 v[46:47], v9 offset:30720
    v_mfma_f32_16x16x32_bf16 v[204:207], v[52:55], v[164:167], 0
    buffer_store_dwordx4 v[224:227], v27, s[4:7], s41 offen sc1
    v_mfma_f32_16x16x32_bf16 v[204:207], v[48:51], v[160:163], v[204:207]
    s_add_u32 s41, s39, 49152
    s_waitcnt lgkmcnt(8)
    v_mfma_f32_16x16x32_bf16 v[204:207], v[56:59], v[168:171], v[204:207]
    ds_read_b64_tr_b16 v[48:49], v9 offset:32768
    ds_read_b64_tr_b16 v[50:51], v9 offset:34816
    v_mfma_f32_16x16x32_bf16 v[204:207], v[60:63], v[172:175], v[204:207]
    ds_read_b64_tr_b16 v[52:53], v9 offset:36864
    ds_read_b64_tr_b16 v[54:55], v9 offset:38912
    v_mfma_f32_16x16x32_bf16 v[196:199], v[60:63], v[140:143], v[196:199]
    buffer_store_dwordx4 v[228:231], v27, s[4:7], s41 offen sc1
    v_mfma_f32_16x16x32_bf16 v[196:199], v[56:59], v[136:139], v[196:199]
    s_add_u32 m0, s31, s42
    s_waitcnt lgkmcnt(8)
    v_mfma_f32_16x16x32_bf16 v[196:199], v[32:35], v[144:147], v[196:199]
    ds_read_b64_tr_b16 v[56:57], v9 offset:40960
    ds_read_b64_tr_b16 v[58:59], v9 offset:43008
    v_mfma_f32_16x16x32_bf16 v[196:199], v[36:39], v[148:151], v[196:199]
    ds_read_b64_tr_b16 v[60:61], v9 offset:45056
    ds_read_b64_tr_b16 v[62:63], v9 offset:47104
    v_mfma_f32_16x16x32_bf16 v[204:207], v[36:39], v[180:183], v[204:207]
    buffer_load_dwordx4 v124, s[8:11], s49 offen offset:0 lds
    v_mfma_f32_16x16x32_bf16 v[204:207], v[32:35], v[176:179], v[204:207]
    v_add_u32 v8, s44, v8
    s_waitcnt lgkmcnt(8)
    v_mfma_f32_16x16x32_bf16 v[204:207], v[40:43], v[184:187], v[204:207]
    ds_read_b64_tr_b16 v[32:33], v10 offset:0
    ds_read_b64_tr_b16 v[34:35], v10 offset:2048
    v_mfma_f32_16x16x32_bf16 v[204:207], v[44:47], v[188:191], v[204:207]
    ds_read_b64_tr_b16 v[36:37], v10 offset:4096
    ds_read_b64_tr_b16 v[38:39], v10 offset:6144
    v_mfma_f32_16x16x32_bf16 v[196:199], v[44:47], v[156:159], v[196:199]
    buffer_load_dwordx4 v125, s[8:11], s49 offen offset:1024 lds
    v_mfma_f32_16x16x32_bf16 v[196:199], v[40:43], v[152:155], v[196:199]
    v_add_u32 v9, s44, v9
    s_waitcnt lgkmcnt(8)
    v_mfma_f32_16x16x32_bf16 v[196:199], v[48:51], v[64:67], v[196:199]
    ds_read_b64_tr_b16 v[40:41], v10 offset:8192
    ds_read_b64_tr_b16 v[42:43], v10 offset:10240
    v_mfma_f32_16x16x32_bf16 v[196:199], v[52:55], v[68:71], v[196:199]
    ds_read_b64_tr_b16 v[44:45], v10 offset:12288
    ds_read_b64_tr_b16 v[46:47], v10 offset:14336
    v_mfma_f32_16x16x32_bf16 v[204:207], v[52:55], v[84:87], v[204:207]
    buffer_load_dwordx4 v126, s[8:11], s49 offen offset:2048 lds
    v_mfma_f32_16x16x32_bf16 v[204:207], v[48:51], v[80:83], v[204:207]
    s_mov_b32 s39, s38
    s_waitcnt lgkmcnt(8)
    v_mfma_f32_16x16x32_bf16 v[204:207], v[56:59], v[88:91], v[204:207]
    ds_read_b64_tr_b16 v[48:49], v10 offset:16384
    ds_read_b64_tr_b16 v[50:51], v10 offset:18432
    v_mfma_f32_16x16x32_bf16 v[204:207], v[60:63], v[92:95], v[204:207]
    ds_read_b64_tr_b16 v[52:53], v10 offset:20480
    ds_read_b64_tr_b16 v[54:55], v10 offset:22528
    v_mfma_f32_16x16x32_bf16 v[196:199], v[60:63], v[76:79], v[196:199]
    buffer_load_dwordx4 v127, s[8:11], s49 offen offset:3072 lds
    v_mfma_f32_16x16x32_bf16 v[196:199], v[56:59], v[72:75], v[196:199]
    s_add_u32 m0, m0, 4096
    s_waitcnt lgkmcnt(8)
    v_mfma_f32_16x16x32_bf16 v[208:211], v[32:35], v[128:131], 0
    ds_read_b64_tr_b16 v[56:57], v10 offset:24576
    ds_read_b64_tr_b16 v[58:59], v10 offset:26624
    v_mfma_f32_16x16x32_bf16 v[208:211], v[36:39], v[132:135], v[208:211]
    ds_read_b64_tr_b16 v[60:61], v10 offset:28672
    ds_read_b64_tr_b16 v[62:63], v10 offset:30720
    s_add_u32 s36, s49, 28672
    v_mfma_f32_16x16x32_bf16 v[216:219], v[36:39], v[164:167], 0
    buffer_load_dwordx4 v124, s[8:11], s36 offen offset:0 lds
    v_mfma_f32_16x16x32_bf16 v[216:219], v[32:35], v[160:163], v[216:219]
    s_add_u32 s38, s38, 65536
    s_waitcnt lgkmcnt(8)
    v_mfma_f32_16x16x32_bf16 v[216:219], v[40:43], v[168:171], v[216:219]
    ds_read_b64_tr_b16 v[32:33], v10 offset:32768
    ds_read_b64_tr_b16 v[34:35], v10 offset:34816
    v_mfma_f32_16x16x32_bf16 v[216:219], v[44:47], v[172:175], v[216:219]
    ds_read_b64_tr_b16 v[36:37], v10 offset:36864
    ds_read_b64_tr_b16 v[38:39], v10 offset:38912
    v_mfma_f32_16x16x32_bf16 v[208:211], v[44:47], v[140:143], v[208:211]
    buffer_load_dwordx4 v125, s[8:11], s36 offen offset:1024 lds
    v_mfma_f32_16x16x32_bf16 v[208:211], v[40:43], v[136:139], v[208:211]
    v_cvt_pk_bf16_f32 v232, v192, v193
    s_waitcnt lgkmcnt(8)
    v_mfma_f32_16x16x32_bf16 v[208:211], v[48:51], v[144:147], v[208:211]
    ds_read_b64_tr_b16 v[40:41], v10 offset:40960
    ds_read_b64_tr_b16 v[42:43], v10 offset:43008
    v_mfma_f32_16x16x32_bf16 v[208:211], v[52:55], v[148:151], v[208:211]
    ds_read_b64_tr_b16 v[44:45], v10 offset:45056
    ds_read_b64_tr_b16 v[46:47], v10 offset:47104
    v_mfma_f32_16x16x32_bf16 v[216:219], v[52:55], v[180:183], v[216:219]
    buffer_load_dwordx4 v126, s[8:11], s36 offen offset:2048 lds
    v_mfma_f32_16x16x32_bf16 v[216:219], v[48:51], v[176:179], v[216:219]
    v_cvt_pk_bf16_f32 v233, v194, v195
    s_waitcnt lgkmcnt(8)
    v_mfma_f32_16x16x32_bf16 v[216:219], v[56:59], v[184:187], v[216:219]
    ds_read_b64_tr_b16 v[48:49], v11 offset:0
    ds_read_b64_tr_b16 v[50:51], v11 offset:2048
    v_mfma_f32_16x16x32_bf16 v[216:219], v[60:63], v[188:191], v[216:219]
    ds_read_b64_tr_b16 v[52:53], v11 offset:4096
    ds_read_b64_tr_b16 v[54:55], v11 offset:6144
    v_mfma_f32_16x16x32_bf16 v[208:211], v[60:63], v[156:159], v[208:211]
    buffer_load_dwordx4 v127, s[8:11], s36 offen offset:3072 lds
    v_mfma_f32_16x16x32_bf16 v[208:211], v[56:59], v[152:155], v[208:211]
    s_add_u32 m0, s33, s42
    s_waitcnt lgkmcnt(8)
    v_mfma_f32_16x16x32_bf16 v[208:211], v[32:35], v[64:67], v[208:211]
    ds_read_b64_tr_b16 v[56:57], v11 offset:8192
    ds_read_b64_tr_b16 v[58:59], v11 offset:10240
    v_mfma_f32_16x16x32_bf16 v[208:211], v[36:39], v[68:71], v[208:211]
    ds_read_b64_tr_b16 v[60:61], v11 offset:12288
    ds_read_b64_tr_b16 v[62:63], v11 offset:14336
    s_add_u32 s49, s49, 128
    v_mfma_f32_16x16x32_bf16 v[216:219], v[36:39], v[84:87], v[216:219]
    buffer_load_dwordx4 v124, s[12:15], s50 offen offset:0 lds
    v_mfma_f32_16x16x32_bf16 v[216:219], v[32:35], v[80:83], v[216:219]
    v_cvt_pk_bf16_f32 v234, v196, v197
    s_waitcnt lgkmcnt(8)
    v_mfma_f32_16x16x32_bf16 v[216:219], v[40:43], v[88:91], v[216:219]
    ds_read_b64_tr_b16 v[32:33], v11 offset:16384
    ds_read_b64_tr_b16 v[34:35], v11 offset:18432
    v_mfma_f32_16x16x32_bf16 v[216:219], v[44:47], v[92:95], v[216:219]
    ds_read_b64_tr_b16 v[36:37], v11 offset:20480
    ds_read_b64_tr_b16 v[38:39], v11 offset:22528
    v_mfma_f32_16x16x32_bf16 v[208:211], v[44:47], v[76:79], v[208:211]
    buffer_load_dwordx4 v125, s[12:15], s50 offen offset:1024 lds
    v_mfma_f32_16x16x32_bf16 v[208:211], v[40:43], v[72:75], v[208:211]
    v_cvt_pk_bf16_f32 v235, v198, v199
    s_waitcnt lgkmcnt(8)
    v_mfma_f32_16x16x32_bf16 v[212:215], v[48:51], v[128:131], 0
    ds_read_b64_tr_b16 v[40:41], v11 offset:24576
    ds_read_b64_tr_b16 v[42:43], v11 offset:26624
    v_mfma_f32_16x16x32_bf16 v[212:215], v[52:55], v[132:135], v[212:215]
    ds_read_b64_tr_b16 v[44:45], v11 offset:28672
    ds_read_b64_tr_b16 v[46:47], v11 offset:30720
    v_mfma_f32_16x16x32_bf16 v[220:223], v[52:55], v[164:167], 0
    buffer_load_dwordx4 v126, s[12:15], s50 offen offset:2048 lds
    v_mfma_f32_16x16x32_bf16 v[220:223], v[48:51], v[160:163], v[220:223]
    v_cvt_pk_bf16_f32 v236, v200, v201
    s_waitcnt lgkmcnt(8)
    v_mfma_f32_16x16x32_bf16 v[220:223], v[56:59], v[168:171], v[220:223]
    ds_read_b64_tr_b16 v[48:49], v11 offset:32768
    ds_read_b64_tr_b16 v[50:51], v11 offset:34816
    v_mfma_f32_16x16x32_bf16 v[220:223], v[60:63], v[172:175], v[220:223]
    ds_read_b64_tr_b16 v[52:53], v11 offset:36864
    ds_read_b64_tr_b16 v[54:55], v11 offset:38912
    v_mfma_f32_16x16x32_bf16 v[212:215], v[60:63], v[140:143], v[212:215]
    buffer_load_dwordx4 v127, s[12:15], s50 offen offset:3072 lds
    v_mfma_f32_16x16x32_bf16 v[212:215], v[56:59], v[136:139], v[212:215]
    s_add_u32 s50, s50, 128
    s_cmp_eq_u32 s50, s30
    s_cselect_b32 s50, s47, s50
    s_cselect_b32 s49, s46, s49
    s_waitcnt lgkmcnt(8)
    v_mfma_f32_16x16x32_bf16 v[212:215], v[32:35], v[144:147], v[212:215]
    ds_read_b64_tr_b16 v[56:57], v11 offset:40960
    ds_read_b64_tr_b16 v[58:59], v11 offset:43008
    v_mfma_f32_16x16x32_bf16 v[212:215], v[36:39], v[148:151], v[212:215]
    ds_read_b64_tr_b16 v[60:61], v11 offset:45056
    ds_read_b64_tr_b16 v[62:63], v11 offset:47104
    v_mfma_f32_16x16x32_bf16 v[220:223], v[36:39], v[180:183], v[220:223]
    s_waitcnt vmcnt(12)
    s_barrier
    v_mfma_f32_16x16x32_bf16 v[220:223], v[32:35], v[176:179], v[220:223]
    v_add_u32 v10, s44, v10
    s_waitcnt lgkmcnt(8)
    v_mfma_f32_16x16x32_bf16 v[220:223], v[40:43], v[184:187], v[220:223]
    ds_read_b64_tr_b16 v[32:33], v8 offset:0
    ds_read_b64_tr_b16 v[34:35], v8 offset:2048
    s_cmp_lg_u32 s24, 0
    s_cbranch_scc1 L_sk0
    s_mov_b64 exec, 1
    buffer_atomic_add v29, v28, s[4:7], s45 offen
    s_mov_b64 exec, -1
L_sk0:
    v_mfma_f32_16x16x32_bf16 v[220:223], v[44:47], v[188:191], v[220:223]
    ds_read_b64_tr_b16 v[36:37], v8 offset:4096
    ds_read_b64_tr_b16 v[38:39], v8 offset:6144
    v_mfma_f32_16x16x32_bf16 v[212:215], v[44:47], v[156:159], v[212:215]
    v_cvt_pk_bf16_f32 v237, v202, v203
    v_cvt_pk_bf16_f32 v238, v204, v205
    v_mfma_f32_16x16x32_bf16 v[212:215], v[40:43], v[152:155], v[212:215]
    v_add_u32 v11, s44, v11
    s_waitcnt lgkmcnt(8)
    v_mfma_f32_16x16x32_bf16 v[212:215], v[48:51], v[64:67], v[212:215]
    ds_read_b64_tr_b16 v[40:41], v8 offset:8192
    ds_read_b64_tr_b16 v[42:43], v8 offset:10240
    s_mov_b32 s42, s35
    v_mfma_f32_16x16x32_bf16 v[212:215], v[52:55], v[68:71], v[212:215]
    ds_read_b64_tr_b16 v[44:45], v8 offset:12288
    ds_read_b64_tr_b16 v[46:47], v8 offset:14336
    s_mov_b32 s35, s40
    v_mfma_f32_16x16x32_bf16 v[220:223], v[52:55], v[84:87], v[220:223]
    s_cmp_eq_u32 s38, s51
    s_cselect_b32 s38, s34, s38
    v_mfma_f32_16x16x32_bf16 v[220:223], v[48:51], v[80:83], v[220:223]
    v_cvt_pk_bf16_f32 v239, v206, v207
    s_waitcnt lgkmcnt(8)
    v_mfma_f32_16x16x32_bf16 v[220:223], v[56:59], v[88:91], v[220:223]
    ds_read_b64_tr_b16 v[48:49], v8 offset:16384
    ds_read_b64_tr_b16 v[50:51], v8 offset:18432
    v_and_b32 v28, 28, v24
    v_mfma_f32_16x16x32_bf16 v[220:223], v[60:63], v[92:95], v[220:223]
    ds_read_b64_tr_b16 v[52:53], v8 offset:20480
    ds_read_b64_tr_b16 v[54:55], v8 offset:22528
    v_add_u32 v24, 4, v24
    v_mfma_f32_16x16x32_bf16 v[212:215], v[60:63], v[76:79], v[212:215]
    s_cmp_ge_u32 s43, 4
    s_cselect_b32 s49, 0x40000000, s49
    s_cselect_b32 s50, 0x40000000, s50
    v_mfma_f32_16x16x32_bf16 v[212:215], v[56:59], v[72:75], v[212:215]
    s_add_u32 s43, s43, 1
    s_cmp_lt_u32 s43, 7
    s_cbranch_scc1 L_p5
    s_load_dwordx2 s[84:85], s[0:1], 0
    s_load_dwordx4 s[88:91], s[0:1], 80
    v_mov_b32 v3, 32
    v_and_b32 v5, 7, v1
    v_lshlrev_b32 v5, 2, v5
    s_cmp_lg_u32 s24, 0
    s_cbranch_scc1 L_tk0
    v_mov_b32 v2, 1
    s_mov_b64 exec, 1
    buffer_atomic_add v2, v3, s[4:7], s45 offen sc0
    s_mov_b64 exec, -1
    buffer_load_dword v4, v5, s[4:7], s45 offen sc1
L_tk0:
    s_add_u32 s41, s39, 0
    buffer_store_dwordx4 v[232:235], v27, s[4:7], s41 offen sc1
    s_add_u32 s41, s39, 16384
    buffer_store_dwordx4 v[236:239], v27, s[4:7], s41 offen sc1
    v_cvt_pk_bf16_f32 v224, v208, v209
    v_cvt_pk_bf16_f32 v225, v210, v211
    v_cvt_pk_bf16_f32 v226, v212, v213
    v_cvt_pk_bf16_f32 v227, v214, v215
    v_cvt_pk_bf16_f32 v228, v216, v217
    v_cvt_pk_bf16_f32 v229, v218, v219
    v_cvt_pk_bf16_f32 v230, v220, v221
    v_cvt_pk_bf16_f32 v231, v222, v223
    s_add_u32 s41, s39, 32768
    buffer_store_dwordx4 v[224:227], v27, s[4:7], s41 offen sc1
    s_add_u32 s41, s39, 49152
    buffer_store_dwordx4 v[228:231], v27, s[4:7], s41 offen sc1
    v_and_b32 v30, 15, v1
    v_mul_u32_u24 v30, 896, v30
    v_lshrrev_b32 v31, 4, v1
    v_lshlrev_b32 v31, 3, v31
    v_add_u32 v30, v30, v31
    v_mov_b32 v25, 0
    s_waitcnt lgkmcnt(0)
    s_mov_b32 s8, s84
    s_and_b32 s9, s85, 0xffff
    s_mov_b32 s10, 1835008
    s_mov_b32 s11, 0x00020000
    s_mov_b32 s12, s88
    s_and_b32 s13, s89, 0xffff
    s_mov_b32 s14, 896
    s_mov_b32 s15, 0x00020000
    s_mov_b32 s16, s90
    s_and_b32 s17, s91, 0xffff
    s_mov_b32 s18, 1835008
    s_mov_b32 s19, 0x00020000
    s_waitcnt vmcnt(0)
    s_barrier
    s_cmp_lg_u32 s24, 0
    s_cbranch_scc1 L_rw
    s_mov_b64 exec, 1
    buffer_atomic_add v29, v28, s[4:7], s45 offen
    s_mov_b64 exec, -1
L_rloop:
    s_cmp_lg_u32 s24, 0
    s_cbranch_scc1 L_rw
    v_readfirstlane_b32 s40, v2
    s_mov_b32 s3, 0
    s_cmp_ge_u32 s40, 28
    s_cbranch_scc1 L_rpost
    s_lshr_b32 s41, s40, 2
L_pl3:
    v_readlane_b32 s98, v4, s41
    s_add_u32 s3, s3, 1
    s_cmp_ge_u32 s98, 16
    s_cbranch_scc1 L_rpost
    s_cmp_ge_u32 s3, 0x400000
    s_cbranch_scc1 L_rpost
    buffer_load_dword v4, v5, s[4:7], s45 offen sc1
    s_waitcnt vmcnt(0)
    s_branch L_pl3
L_rpost:
    v_mov_b32 v24, s40
    ds_write_b32 v25, v24
    s_waitcnt lgkmcnt(0)
L_rw:
    s_barrier
    ds_read_b32 v24, v25
    v_add_u32 v25, 4, v25
    s_waitcnt lgkmcnt(0)
    v_readfirstlane_b32 s40, v24
    s_nop 3
    s_cmp_ge_u32 s40, 28
    s_cbranch_scc1 L_fin
    s_mov_b32 s35, s40
    s_lshl_b32 s41, s28, 1
    s_sub_u32 s42, 62, s41
    s_bitcmp1_b32 s40, 1
    s_cselect_b32 s41, s42, s41
    s_and_b32 s42, s40, 1
    s_add_u32 s29, s41, s42
    s_lshr_b32 s40, s40, 2
    s_add_u32 s40, s40, s48
    s_sub_u32 s41, s40, 7
    s_cselect_b32 s40, s40, s41
    s_lshl_b32 s40, s40, 2
    s_add_u32 s40, s40, s24
    s_mul_i32 s41, s29, 28
    s_add_u32 s41, s41, s40
    s_lshl_b32 s38, s41, 14
    s_add_u32 s38, s38, 35651584
    s_lshr_b32 s44, s40, 1
    s_lshl_b32 s44, s44, 6
    s_lshl_b32 s41, s29, 1
    s_add_u32 s41, s41, s25
    s_mul_i32 s46, s41, 14336
    s_add_u32 s46, s46, s44
    buffer_load_dwordx4 v[32:35], v27, s[4:7], s38 offen offset:0 sc1
    buffer_load_dwordx4 v[36:39], v27, s[4:7], s38 offen offset:1024 sc1
    buffer_load_dwordx4 v[40:43], v27, s[4:7], s38 offen offset:2048 sc1
    buffer_load_dwordx4 v[44:47], v27, s[4:7], s38 offen offset:3072 sc1
    s_add_u32 s38, s38, 4096
    buffer_load_dwordx4 v[48:51], v27, s[4:7], s38 offen offset:0 sc1
    buffer_load_dwordx4 v[52:55], v27, s[4:7], s38 offen offset:1024 sc1
    buffer_load_dwordx4 v[56:59], v27, s[4:7], s38 offen offset:2048 sc1
    buffer_load_dwordx4 v[60:63], v27, s[4:7], s38 offen offset:3072 sc1
    s_add_u32 s38, s38, 4096
    buffer_load_dwordx4 v[64:67], v27, s[4:7], s38 offen offset:0 sc1
    buffer_load_dwordx4 v[68:71], v27, s[4:7], s38 offen offset:1024 sc1
    buffer_load_dwordx4 v[72:75], v27, s[4:7], s38 offen offset:2048 sc1
    buffer_load_dwordx4 v[76:79], v27, s[4:7], s38 offen offset:3072 sc1
    s_add_u32 s38, s38, 4096
    buffer_load_dwordx4 v[80:83], v27, s[4:7], s38 offen offset:0 sc1
    buffer_load_dwordx4 v[84:87], v27, s[4:7], s38 offen offset:1024 sc1
    buffer_load_dwordx4 v[88:91], v27, s[4:7], s38 offen offset:2048 sc1
    buffer_load_dwordx4 v[92:95], v27, s[4:7], s38 offen offset:3072 sc1
    buffer_load_dwordx2 v[96:97], v30, s[8:11], s46 offen
    buffer_load_dwordx2 v[98:99], v30, s[8:11], s46 offen offset:32
    buffer_load_dwordx2 v[100:101], v31, s[12:15], s44 offen
    buffer_load_dwordx2 v[102:103], v31, s[12:15], s44 offen offset:32
    s_cmp_lg_u32 s24, 0
    s_cbranch_scc1 L_tk1
    s_cmp_ge_u32 s35, 24
    s_cbranch_scc1 L_tk1
    v_mov_b32 v2, 1
    s_mov_b64 exec, 1
    buffer_atomic_add v2, v3, s[4:7], s45 offen sc0
    s_mov_b64 exec, -1
    buffer_load_dword v4, v5, s[4:7], s45 offen sc1
L_tk1:
    s_waitcnt vmcnt(19)
    v_lshlrev_b32 v192, 16, v32
    v_and_b32 v193, 0xffff0000, v32
    v_lshlrev_b32 v194, 16, v33
    v_and_b32 v195, 0xffff0000, v33
    v_lshlrev_b32 v196, 16, v34
    v_and_b32 v197, 0xffff0000, v34
    v_lshlrev_b32 v198, 16, v35
    v_and_b32 v199, 0xffff0000, v35
    s_waitcnt vmcnt(18)
    v_lshlrev_b32 v28, 16, v36
    v_and_b32 v29, 0xffff0000, v36
    v_pk_add_f32 v[192:193], v[192:193], v[28:29]
    v_lshlrev_b32 v28, 16, v37
    v_and_b32 v29, 0xffff0000, v37
    v_pk_add_f32 v[194:195], v[194:195], v[28:29]
    v_lshlrev_b32 v28, 16, v38
    v_and_b32 v29, 0xffff0000, v38
    v_pk_add_f32 v[196:197], v[196:197], v[28:29]
    v_lshlrev_b32 v28, 16, v39
    v_and_b32 v29, 0xffff0000, v39
    v_pk_add_f32 v[198:199], v[198:199], v[28:29]
    s_waitcnt vmcnt(17)
    v_lshlrev_b32 v28, 16, v40
    v_and_b32 v29, 0xffff0000, v40
    v_pk_add_f32 v[192:193], v[192:193], v[28:29]
    v_lshlrev_b32 v28, 16, v41
    v_and_b32 v29, 0xffff0000, v41
    v_pk_add_f32 v[194:195], v[194:195], v[28:29]
    v_lshlrev_b32 v28, 16, v42
    v_and_b32 v29, 0xffff0000, v42
    v_pk_add_f32 v[196:197], v[196:197], v[28:29]
    v_lshlrev_b32 v28, 16, v43
    v_and_b32 v29, 0xffff0000, v43
    v_pk_add_f32 v[198:199], v[198:199], v[28:29]
    s_waitcnt vmcnt(16)
    v_lshlrev_b32 v28, 16, v44
    v_and_b32 v29, 0xffff0000, v44
    v_pk_add_f32 v[192:193], v[192:193], v[28:29]
    v_lshlrev_b32 v28, 16, v45
    v_and_b32 v29, 0xffff0000, v45
    v_pk_add_f32 v[194:195], v[194:195], v[28:29]
    v_lshlrev_b32 v28, 16, v46
    v_and_b32 v29, 0xffff0000, v46
    v_pk_add_f32 v[196:197], v[196:197], v[28:29]
    v_lshlrev_b32 v28, 16, v47
    v_and_b32 v29, 0xffff0000, v47
    v_pk_add_f32 v[198:199], v[198:199], v[28:29]
    s_waitcnt vmcnt(15)
    v_lshlrev_b32 v28, 16, v48
    v_and_b32 v29, 0xffff0000, v48
    v_pk_add_f32 v[192:193], v[192:193], v[28:29]
    v_lshlrev_b32 v28, 16, v49
    v_and_b32 v29, 0xffff0000, v49
    v_pk_add_f32 v[194:195], v[194:195], v[28:29]
    v_lshlrev_b32 v28, 16, v50
    v_and_b32 v29, 0xffff0000, v50
    v_pk_add_f32 v[196:197], v[196:197], v[28:29]
    v_lshlrev_b32 v28, 16, v51
    v_and_b32 v29, 0xffff0000, v51
    v_pk_add_f32 v[198:199], v[198:199], v[28:29]
    s_waitcnt vmcnt(14)
    v_lshlrev_b32 v28, 16, v52
    v_and_b32 v29, 0xffff0000, v52
    v_pk_add_f32 v[192:193], v[192:193], v[28:29]
    v_lshlrev_b32 v28, 16, v53
    v_and_b32 v29, 0xffff0000, v53
    v_pk_add_f32 v[194:195], v[194:195], v[28:29]
    v_lshlrev_b32 v28, 16, v54
    v_and_b32 v29, 0xffff0000, v54
    v_pk_add_f32 v[196:197], v[196:197], v[28:29]
    v_lshlrev_b32 v28, 16, v55
    v_and_b32 v29, 0xffff0000, v55
    v_pk_add_f32 v[198:199], v[198:199], v[28:29]
    s_waitcnt vmcnt(13)
    v_lshlrev_b32 v28, 16, v56
    v_and_b32 v29, 0xffff0000, v56
    v_pk_add_f32 v[192:193], v[192:193], v[28:29]
    v_lshlrev_b32 v28, 16, v57
    v_and_b32 v29, 0xffff0000, v57
    v_pk_add_f32 v[194:195], v[194:195], v[28:29]
    v_lshlrev_b32 v28, 16, v58
    v_and_b32 v29, 0xffff0000, v58
    v_pk_add_f32 v[196:197], v[196:197], v[28:29]
    v_lshlrev_b32 v28, 16, v59
    v_and_b32 v29, 0xffff0000, v59
    v_pk_add_f32 v[198:199], v[198:199], v[28:29]
    s_waitcnt vmcnt(12)
    v_lshlrev_b32 v28, 16, v60
    v_and_b32 v29, 0xffff0000, v60
    v_pk_add_f32 v[192:193], v[192:193], v[28:29]
    v_lshlrev_b32 v28, 16, v61
    v_and_b32 v29, 0xffff0000, v61
    v_pk_add_f32 v[194:195], v[194:195], v[28:29]
    v_lshlrev_b32 v28, 16, v62
    v_and_b32 v29, 0xffff0000, v62
    v_pk_add_f32 v[196:197], v[196:197], v[28:29]
    v_lshlrev_b32 v28, 16, v63
    v_and_b32 v29, 0xffff0000, v63
    v_pk_add_f32 v[198:199], v[198:199], v[28:29]
    s_waitcnt vmcnt(11)
    v_lshlrev_b32 v28, 16, v64
    v_and_b32 v29, 0xffff0000, v64
    v_pk_add_f32 v[192:193], v[192:193], v[28:29]
    v_lshlrev_b32 v28, 16, v65
    v_and_b32 v29, 0xffff0000, v65
    v_pk_add_f32 v[194:195], v[194:195], v[28:29]
    v_lshlrev_b32 v28, 16, v66
    v_and_b32 v29, 0xffff0000, v66
    v_pk_add_f32 v[196:197], v[196:197], v[28:29]
    v_lshlrev_b32 v28, 16, v67
    v_and_b32 v29, 0xffff0000, v67
    v_pk_add_f32 v[198:199], v[198:199], v[28:29]
    s_waitcnt vmcnt(10)
    v_lshlrev_b32 v28, 16, v68
    v_and_b32 v29, 0xffff0000, v68
    v_pk_add_f32 v[192:193], v[192:193], v[28:29]
    v_lshlrev_b32 v28, 16, v69
    v_and_b32 v29, 0xffff0000, v69
    v_pk_add_f32 v[194:195], v[194:195], v[28:29]
    v_lshlrev_b32 v28, 16, v70
    v_and_b32 v29, 0xffff0000, v70
    v_pk_add_f32 v[196:197], v[196:197], v[28:29]
    v_lshlrev_b32 v28, 16, v71
    v_and_b32 v29, 0xffff0000, v71
    v_pk_add_f32 v[198:199], v[198:199], v[28:29]
    s_waitcnt vmcnt(9)
    v_lshlrev_b32 v28, 16, v72
    v_and_b32 v29, 0xffff0000, v72
    v_pk_add_f32 v[192:193], v[192:193], v[28:29]
    v_lshlrev_b32 v28, 16, v73
    v_and_b32 v29, 0xffff0000, v73
    v_pk_add_f32 v[194:195], v[194:195], v[28:29]
    v_lshlrev_b32 v28, 16, v74
    v_and_b32 v29, 0xffff0000, v74
    v_pk_add_f32 v[196:197], v[196:197], v[28:29]
    v_lshlrev_b32 v28, 16, v75
    v_and_b32 v29, 0xffff0000, v75
    v_pk_add_f32 v[198:199], v[198:199], v[28:29]
    s_waitcnt vmcnt(8)
    v_lshlrev_b32 v28, 16, v76
    v_and_b32 v29, 0xffff0000, v76
    v_pk_add_f32 v[192:193], v[192:193], v[28:29]
    v_lshlrev_b32 v28, 16, v77
    v_and_b32 v29, 0xffff0000, v77
    v_pk_add_f32 v[194:195], v[194:195], v[28:29]
    v_lshlrev_b32 v28, 16, v78
    v_and_b32 v29, 0xffff0000, v78
    v_pk_add_f32 v[196:197], v[196:197], v[28:29]
    v_lshlrev_b32 v28, 16, v79
    v_and_b32 v29, 0xffff0000, v79
    v_pk_add_f32 v[198:199], v[198:199], v[28:29]
    s_waitcnt vmcnt(7)
    v_lshlrev_b32 v28, 16, v80
    v_and_b32 v29, 0xffff0000, v80
    v_pk_add_f32 v[192:193], v[192:193], v[28:29]
    v_lshlrev_b32 v28, 16, v81
    v_and_b32 v29, 0xffff0000, v81
    v_pk_add_f32 v[194:195], v[194:195], v[28:29]
    v_lshlrev_b32 v28, 16, v82
    v_and_b32 v29, 0xffff0000, v82
    v_pk_add_f32 v[196:197], v[196:197], v[28:29]
    v_lshlrev_b32 v28, 16, v83
    v_and_b32 v29, 0xffff0000, v83
    v_pk_add_f32 v[198:199], v[198:199], v[28:29]
    s_waitcnt vmcnt(6)
    v_lshlrev_b32 v28, 16, v84
    v_and_b32 v29, 0xffff0000, v84
    v_pk_add_f32 v[192:193], v[192:193], v[28:29]
    v_lshlrev_b32 v28, 16, v85
    v_and_b32 v29, 0xffff0000, v85
    v_pk_add_f32 v[194:195], v[194:195], v[28:29]
    v_lshlrev_b32 v28, 16, v86
    v_and_b32 v29, 0xffff0000, v86
    v_pk_add_f32 v[196:197], v[196:197], v[28:29]
    v_lshlrev_b32 v28, 16, v87
    v_and_b32 v29, 0xffff0000, v87
    v_pk_add_f32 v[198:199], v[198:199], v[28:29]
    s_waitcnt vmcnt(5)
    v_lshlrev_b32 v28, 16, v88
    v_and_b32 v29, 0xffff0000, v88
    v_pk_add_f32 v[192:193], v[192:193], v[28:29]
    v_lshlrev_b32 v28, 16, v89
    v_and_b32 v29, 0xffff0000, v89
    v_pk_add_f32 v[194:195], v[194:195], v[28:29]
    v_lshlrev_b32 v28, 16, v90
    v_and_b32 v29, 0xffff0000, v90
    v_pk_add_f32 v[196:197], v[196:197], v[28:29]
    v_lshlrev_b32 v28, 16, v91
    v_and_b32 v29, 0xffff0000, v91
    v_pk_add_f32 v[198:199], v[198:199], v[28:29]
    s_waitcnt vmcnt(4)
    v_lshlrev_b32 v28, 16, v92
    v_and_b32 v29, 0xffff0000, v92
    v_pk_add_f32 v[192:193], v[192:193], v[28:29]
    v_lshlrev_b32 v28, 16, v93
    v_and_b32 v29, 0xffff0000, v93
    v_pk_add_f32 v[194:195], v[194:195], v[28:29]
    v_lshlrev_b32 v28, 16, v94
    v_and_b32 v29, 0xffff0000, v94
    v_pk_add_f32 v[196:197], v[196:197], v[28:29]
    v_lshlrev_b32 v28, 16, v95
    v_and_b32 v29, 0xffff0000, v95
    v_pk_add_f32 v[198:199], v[198:199], v[28:29]
    s_waitcnt vmcnt(2)
    v_lshlrev_b32 v28, 16, v96
    v_and_b32 v29, 0xffff0000, v96
    v_pk_add_f32 v[192:193], v[192:193], v[28:29]
    v_lshlrev_b32 v28, 16, v97
    v_and_b32 v29, 0xffff0000, v97
    v_pk_add_f32 v[194:195], v[194:195], v[28:29]
    v_lshlrev_b32 v28, 16, v98
    v_and_b32 v29, 0xffff0000, v98
    v_pk_add_f32 v[196:197], v[196:197], v[28:29]
    v_lshlrev_b32 v28, 16, v99
    v_and_b32 v29, 0xffff0000, v99
    v_pk_add_f32 v[198:199], v[198:199], v[28:29]
    s_waitcnt vmcnt(0)
    v_lshlrev_b32 v28, 16, v100
    v_and_b32 v29, 0xffff0000, v100
    v_pk_add_f32 v[192:193], v[192:193], v[28:29]
    v_lshlrev_b32 v28, 16, v101
    v_and_b32 v29, 0xffff0000, v101
    v_pk_add_f32 v[194:195], v[194:195], v[28:29]
    v_lshlrev_b32 v28, 16, v102
    v_and_b32 v29, 0xffff0000, v102
    v_pk_add_f32 v[196:197], v[196:197], v[28:29]
    v_lshlrev_b32 v28, 16, v103
    v_and_b32 v29, 0xffff0000, v103
    v_pk_add_f32 v[198:199], v[198:199], v[28:29]
    v_cvt_pk_bf16_f32 v200, v192, v193
    v_cvt_pk_bf16_f32 v201, v194, v195
    v_cvt_pk_bf16_f32 v202, v196, v197
    v_cvt_pk_bf16_f32 v203, v198, v199
    buffer_store_dwordx2 v[200:201], v30, s[16:19], s46 offen
    buffer_store_dwordx2 v[202:203], v30, s[16:19], s46 offen offset:32
    s_cmp_ge_u32 s35, 24
    s_cbranch_scc1 L_fin
    s_waitcnt vmcnt(2)
    s_branch L_rloop
L_fin:
L_end:
    s_endpgm
.section .rodata,"a"
.p2align 6
.amdhsa_kernel parallel_sum__compressed_kv_cla__dense_activation_squared_relu__prompt_kernel
  .amdhsa_next_free_vgpr 512
  .amdhsa_next_free_sgpr 102
  .amdhsa_accum_offset 256
  .amdhsa_group_segment_fixed_size 0
  .amdhsa_kernarg_size 112
  .amdhsa_user_sgpr_count 2
  .amdhsa_user_sgpr_kernarg_segment_ptr 1
  .amdhsa_system_sgpr_workgroup_id_x 1
.end_amdhsa_kernel
```
